```python
import torch

def _softmax(x, axis=-1):
    return torch.softmax(x, dim=axis)

def _gelu(x):
    return torch.nn.functional.gelu(x, approximate='tanh')

def _silu(x):
    return torch.nn.functional.silu(x)

def _sigmoid(x):
    return torch.sigmoid(x)

def _layernorm(x, axis=-1, eps=1e-05):
    m = x.mean(dim=axis, keepdim=True)
    v = x.var(dim=axis, keepdim=True, unbiased=False)
    return (x - m) / torch.sqrt(v + eps)

def _scatter_add(tgt, idx, src, axis=0):
    return tgt.clone().index_add_(axis, idx, src)

def _segment_sum(src, seg, n):
    out = torch.zeros((n,) + src.shape[1:], dtype=src.dtype)
    return out.index_add_(0, seg, src)

def _pad(x, pw):
    flat = tuple((v for pair in reversed(pw) for v in pair))
    return torch.nn.functional.pad(x, flat)
kernel_name = 'gated_mix__memory_aug_recurrent_mem_tr__glu_gated_glu__prompt'

def setup_inputs():

    _w = lambda a: (lambda t: t.to(torch.bfloat16) if t.is_floating_point() else t)(torch.as_tensor(a))

    def _A_setup():
        B, S, Dm = (1, 2048, 512)
        H, Dh = (32, 128)
        M, seg = (8, 32)
        seg = min(seg, S)
        S = S // seg * seg
        return {'x': _w((lambda *s: torch.randn(*s, dtype=torch.bfloat16) * 0.05)(B, S, Dm)), 'mem0': _w((lambda *s: torch.randn(*s, dtype=torch.bfloat16) * 0.8)(B, M, Dm)), 'Wq': _w((lambda *s: torch.randn(*s, dtype=torch.bfloat16) * 3.2)(Dm, H, Dh) * Dm ** (-0.5)), 'Wk': _w((lambda *s: torch.randn(*s, dtype=torch.bfloat16) * 3.2)(Dm, H, Dh) * Dm ** (-0.5)), 'Wv': _w((lambda *s: torch.randn(*s, dtype=torch.bfloat16) * 0.8)(Dm, H, Dh) * Dm ** (-0.5)), 'Wo': _w((lambda *s: torch.randn(*s, dtype=torch.bfloat16) * 0.8)(H, Dh, Dm) * (H * Dh) ** (-0.5)), 'seg_len': seg}
    _A_in = _A_setup()

    def _B_setup():
        B, S, D, F = (1, 2048, 512, 1376)
        return {'x': _w((lambda *s: torch.randn(*s, dtype=torch.bfloat16) * 0.05)(B, S, D)), 'w_gate': _w((lambda *s: torch.randn(*s, dtype=torch.bfloat16) * 0.8)(D, F)), 'w_up': _w((lambda *s: torch.randn(*s, dtype=torch.bfloat16) * 0.05)(D, F)), 'w_down': _w((lambda *s: torch.randn(*s, dtype=torch.bfloat16) * 0.05)(F, D))}
    _B_in = _B_setup()
    return {'A_x': _A_in['x'], 'A_mem0': _A_in['mem0'], 'A_Wq': _A_in['Wq'], 'A_Wk': _A_in['Wk'], 'A_Wv': _A_in['Wv'], 'A_Wo': _A_in['Wo'], 'A_seg_len': _A_in['seg_len'], 'B_x': _B_in['x'], 'B_w_gate': _B_in['w_gate'], 'B_w_up': _B_in['w_up'], 'B_w_down': _B_in['w_down'], 'gate_w': _w((lambda *s: torch.randn(*s, dtype=torch.bfloat16) * 0.05)(512) * 16.0)}

def reference(A_x, A_mem0, A_Wq, A_Wk, A_Wv, A_Wo, A_seg_len, B_x, B_w_gate, B_w_up, B_w_down, gate_w):

    def _A_ref(x, mem0, Wq, Wk, Wv, Wo, seg_len):
        B, S, Dm = x.shape
        H, Dh = (Wq.shape[1], Wq.shape[2])
        M = mem0.shape[1]
        scale = Dh ** (-0.5)
        n_seg = S // seg_len
        L = M + seg_len
        idx = torch.arange(L)
        mask = (idx[:, None] < M) | (idx[:, None] >= idx[None, :])
        mem = mem0
        outs = []
        for s in range(n_seg):
            xs = x[:, s * seg_len:(s + 1) * seg_len, :].clone()
            h = torch.concatenate([mem, xs], axis=1)
            q = torch.einsum('btd,dhe->bhte', h, Wq)
            k = torch.einsum('btd,dhe->bhte', h, Wk)
            v = torch.einsum('btd,dhe->bhte', h, Wv)
            scores = torch.einsum('bhqe,bhke->bhqk', q, k) * scale
            scores = torch.where(mask[None, None], scores, -1000000000.0)
            p = _softmax(scores, axis=-1)
            o = torch.einsum('bhqk,bhke->bhqe', p, v)
            o = torch.einsum('bhte,hed->btd', o, Wo)
            mem = o[:, :M, :].clone()
            outs.append(o[:, M:, :])
        return torch.concatenate(outs, axis=1)

    def _B_ref(x, w_gate, w_up, w_down):
        g = torch.einsum('bsd,df->bsf', x, w_gate)
        u = torch.einsum('bsd,df->bsf', x, w_up)
        h = _sigmoid(g) * u
        return torch.einsum('bsf,fd->bsd', h, w_down)
    x = A_x
    g = _sigmoid((x * gate_w).sum(-1, keepdims=True))
    a = _A_ref(x, A_mem0, A_Wq, A_Wk, A_Wv, A_Wo, A_seg_len)
    b = _B_ref(x, B_w_gate, B_w_up, B_w_down)
    return g * a + (1 - g) * b
```

```asm
; @launch grid=(256,1,1) block=(256,1,1) lds=163840
.amdgcn_target "amdgcn-amd-amdhsa--gfx950"
.text
.globl gated_mix__memory_aug_recurrent_mem_tr__glu_gated_glu__prompt_kernel
.p2align 8
.type gated_mix__memory_aug_recurrent_mem_tr__glu_gated_glu__prompt_kernel,@function
gated_mix__memory_aug_recurrent_mem_tr__glu_gated_glu__prompt_kernel:
s_cmp_ge_u32 s2, 256
s_cbranch_scc1 L_exit
s_load_dwordx2 s[8:9], s[0:1], 104
s_load_dwordx2 s[48:49], s[0:1], 112
s_load_dword s3, s[0:1], 0
s_getreg_b32 s10, hwreg(HW_REG_XCC_ID)
s_and_b32 s10, s10, 7
v_lshrrev_b32 v1, 6, v0
v_and_b32 v0, 63, v0
v_readfirstlane_b32 s21, v1
s_lshl_b32 s11, s10, 4
s_cmp_eq_u32 s11, 0
s_cselect_b32 s11, 128, s11
s_waitcnt lgkmcnt(0)
s_cmp_lg_u32 s21, 0
s_cbranch_scc1 L_noadd
v_mov_b32 v2, s11
v_mov_b32 v3, 1
s_mov_b64 exec, 1
global_atomic_add v4, v2, v3, s[8:9] sc0
s_mov_b64 exec, -1
L_noadd:
s_getpc_b64 s[4:5]
L_pc:
s_mov_b32 s6, L_af - L_pc
s_cmp_le_u32 s10, 2
s_cselect_b32 s6, L_kv - L_pc, s6
s_cmp_eq_u32 s10, 0
s_cselect_b32 s6, L_chain - L_pc, s6
s_mov_b32 s7, L_code_end - L_pc - 4
s_lshl_b32 s3, s21, 12
s_add_u32 s6, s6, s3
v_lshlrev_b32 v5, 6, v0
v_add_u32 v5, s6, v5
v_min_u32 v6, s7, v5
v_mov_b32 v7, 0
v_lshl_add_u64 v[6:7], v[6:7], 0, s[4:5]
global_load_dword v255, v[6:7], off
v_add_u32 v5, 0x4000, v5
v_min_u32 v6, s7, v5
v_mov_b32 v7, 0
v_lshl_add_u64 v[6:7], v[6:7], 0, s[4:5]
global_load_dword v255, v[6:7], off
s_cmp_eq_u32 s10, 0
s_cbranch_scc1 L_chain
s_cmp_le_u32 s10, 2
s_cbranch_scc1 L_kv
s_branch L_af
L_exit:
s_waitcnt vmcnt(0)
s_endpgm
L_chain:
s_mov_b32 s26, 0
s_load_dwordx2 s[76:77], s[0:1], 16
s_load_dwordx2 s[64:65], s[0:1], 24
s_load_dwordx2 s[84:85], s[0:1], 32
s_load_dwordx2 s[88:89], s[0:1], 40
s_load_dwordx2 s[72:73], s[0:1], 8
v_lshrrev_b32 v52, 4, v0
v_and_b32 v53, 15, v0
v_lshlrev_b32 v54, 2, v52
v_xor_b32 v54, v54, v53
v_lshrrev_b32 v55, 1, v52
v_lshlrev_b32 v55, 17, v55
v_and_b32 v56, 1, v52
v_lshl_add_u32 v55, v56, 13, v55
v_lshl_add_u32 v104, v54, 4, v55
v_xor_b32 v105, 32, v104
s_lshr_b32 s27, s21, 1
s_lshl_b32 s27, s27, 3
v_xor_b32 v54, s27, v0
v_lshlrev_b32 v106, 4, v54
v_xor_b32 v107, 64, v106
s_lshl_b32 s71, s21, 12
s_lshr_b32 s68, s21, 1
s_lshl_b32 s68, s68, 18
s_and_b32 s27, s21, 1
s_lshl_b32 s27, s27, 16
s_add_u32 s68, s68, s27
s_waitcnt lgkmcnt(0)
s_mov_b32 s76, s76
s_and_b32 s77, s77, 0xffff
s_mov_b32 s78, 4194304
s_mov_b32 s79, 0x00020000
s_mov_b32 s64, s64
s_and_b32 s65, s65, 0xffff
s_mov_b32 s66, 4194304
s_mov_b32 s67, 0x00020000
s_mov_b32 s84, s84
s_and_b32 s85, s85, 0xffff
s_mov_b32 s86, 4194304
s_mov_b32 s87, 0x00020000
s_mov_b32 s88, s88
s_and_b32 s89, s89, 0xffff
s_mov_b32 s90, 4194304
s_mov_b32 s91, 0x00020000
s_cmp_lg_u32 s21, 0
s_cbranch_scc1 L_norank_c
s_waitcnt vmcnt(2)
v_mov_b32 v2, 0
s_mov_b64 exec, 1
ds_write_b32 v2, v4
s_waitcnt lgkmcnt(0)
s_mov_b64 exec, -1
L_norank_c:
s_barrier
v_mov_b32 v2, 0
ds_read_b32 v4, v2
s_waitcnt lgkmcnt(0)
v_readfirstlane_b32 s20, v4
s_barrier
s_cmp_ge_u32 s20, 32
s_cbranch_scc1 L_overflow
s_lshl_b32 s27, s20, 8
s_add_u32 s68, s68, s27
s_lshl_b32 s27, s20, 7
s_add_u32 s27, s27, 598016
v_mov_b32 v18, s27
v_mov_b32 v56, 0
s_cmp_eq_u32 s21, 0
s_cselect_b32 s12, 1, 0
s_mov_b32 s13, 0
s_mov_b64 exec, s[12:13]
global_store_dword v18, v56, s[48:49] sc1
s_mov_b64 exec, -1
s_mov_b32 s93, 0
s_mov_b32 s17, 0
s_lshl_b32 s18, s20, 7
s_add_u32 s18, s18, 589824
s_mov_b32 s14, 0
s_mov_b32 s15, 0
s_mov_b32 s16, 0
s_add_u32 m0, s71, 0 + 0
s_add_u32 s70, s68, 0
buffer_load_dwordx4 v104, s[76:79], s70 offen lds
s_add_u32 m0, s71, 0 + 1024
s_add_u32 s70, s68, 16384
buffer_load_dwordx4 v104, s[76:79], s70 offen lds
s_add_u32 m0, s71, 0 + 2048
s_add_u32 s70, s68, 32768
buffer_load_dwordx4 v105, s[76:79], s70 offen lds
s_add_u32 m0, s71, 0 + 3072
s_add_u32 s70, s68, 49152
buffer_load_dwordx4 v105, s[76:79], s70 offen lds
s_add_u32 m0, s71, 32768 + 0
s_add_u32 s70, s68, 524288
buffer_load_dwordx4 v104, s[76:79], s70 offen lds
s_add_u32 m0, s71, 32768 + 1024
s_add_u32 s70, s68, 540672
buffer_load_dwordx4 v104, s[76:79], s70 offen lds
s_add_u32 m0, s71, 32768 + 2048
s_add_u32 s70, s68, 557056
buffer_load_dwordx4 v105, s[76:79], s70 offen lds
s_add_u32 m0, s71, 32768 + 3072
s_add_u32 s70, s68, 573440
buffer_load_dwordx4 v105, s[76:79], s70 offen lds
s_add_u32 m0, s71, 16384 + 0
s_add_u32 s70, s68, 1048576
buffer_load_dwordx4 v104, s[76:79], s70 offen lds
s_add_u32 m0, s71, 16384 + 1024
s_add_u32 s70, s68, 1064960
buffer_load_dwordx4 v104, s[76:79], s70 offen lds
s_add_u32 m0, s71, 16384 + 2048
s_add_u32 s70, s68, 1081344
buffer_load_dwordx4 v105, s[76:79], s70 offen lds
s_add_u32 m0, s71, 16384 + 3072
s_add_u32 s70, s68, 1097728
buffer_load_dwordx4 v105, s[76:79], s70 offen lds
s_add_u32 m0, s71, 65536 + 0
s_add_u32 s70, s68, 1572864
buffer_load_dwordx4 v104, s[76:79], s70 offen lds
s_add_u32 m0, s71, 65536 + 1024
s_add_u32 s70, s68, 1589248
buffer_load_dwordx4 v104, s[76:79], s70 offen lds
s_add_u32 m0, s71, 65536 + 2048
s_add_u32 s70, s68, 1605632
buffer_load_dwordx4 v105, s[76:79], s70 offen lds
s_add_u32 m0, s71, 65536 + 3072
s_add_u32 s70, s68, 1622016
buffer_load_dwordx4 v105, s[76:79], s70 offen lds
s_add_u32 m0, s71, 98304 + 0
s_add_u32 s70, s68, 2097152
buffer_load_dwordx4 v104, s[76:79], s70 offen lds
s_add_u32 m0, s71, 98304 + 1024
s_add_u32 s70, s68, 2113536
buffer_load_dwordx4 v104, s[76:79], s70 offen lds
s_add_u32 m0, s71, 98304 + 2048
s_add_u32 s70, s68, 2129920
buffer_load_dwordx4 v105, s[76:79], s70 offen lds
s_add_u32 m0, s71, 98304 + 3072
s_add_u32 s70, s68, 2146304
buffer_load_dwordx4 v105, s[76:79], s70 offen lds
v_and_b32 v40, 15, v0
v_lshrrev_b32 v41, 4, v0
v_and_b32 v42, 1, v0
v_cmp_eq_u32 vcc, 1, v42
v_mov_b32 v43, 0x4444
v_mov_b32 v44, 0xeeee
v_cndmask_b32 v1, v43, v44, vcc
v_and_b32 v45, 2, v0
v_cmp_eq_u32 vcc, 2, v45
s_nop 1
v_cndmask_b32 v17, v43, v44, vcc
v_lshlrev_b32 v10, 4, v0
s_lshl_b32 s27, s21, 11
v_add_u32 v2, s27, v10
s_xor_b32 s27, s21, 1
s_lshl_b32 s27, s27, 11
v_add_u32 v3, s27, v10
s_xor_b32 s27, s21, 2
s_lshl_b32 s27, s27, 11
v_add_u32 v4, s27, v10
s_xor_b32 s27, s21, 3
s_lshl_b32 s27, s27, 11
v_add_u32 v5, s27, v10
s_lshl_b32 s27, s21, 5
v_add_u32 v43, s27, v40
v_lshlrev_b32 v44, 5, v43
v_bfe_u32 v45, v40, 2, 1
v_lshrrev_b32 v46, 3, v40
v_lshl_add_u32 v45, v45, 1, v46
v_xor_b32 v45, v45, v41
v_lshl_add_u32 v44, v45, 3, v44
v_add_u32 v6, 8192, v44
v_bfe_u32 v44, v40, 2, 1
v_lshlrev_b32 v44, 9, v44
v_lshrrev_b32 v45, 3, v40
v_lshl_add_u32 v44, v45, 7, v44
v_lshl_add_u32 v44, v42, 5, v44
s_and_b32 s28, s21, 1
v_lshl_add_u32 v45, v45, 1, s28
v_xor_b32 v45, v45, v41
v_lshl_add_u32 v44, v45, 3, v44
v_bfe_u32 v45, v40, 1, 1
v_lshl_add_u32 v44, v45, 2, v44
s_lshr_b32 s27, s21, 1
s_lshl_b32 s27, s27, 10
s_lshl_b32 s28, s28, 8
s_add_u32 s27, s27, s28
s_add_u32 s27, s27, 12288
v_add_u32 v7, s27, v44
v_and_b32 v44, 1, v41
v_lshrrev_b32 v45, 1, v41
v_lshl_add_u32 v44, v44, 1, v45
v_and_b32 v45, 3, v0
v_xor_b32 v44, v44, v45
v_lshlrev_b32 v44, 3, v44
v_bfe_u32 v45, v0, 2, 4
v_lshl_add_u32 v8, v45, 5, v44
s_lshl_b32 s27, s21, 15
s_add_u32 s27, s27, 32768
v_add_u32 v12, s27, v10
v_lshrrev_b32 v44, 2, v40
v_lshl_add_u32 v44, v44, 1, v42
v_lshlrev_b32 v44, 4, v44
v_lshl_add_u32 v44, v41, 7, v44
s_lshl_b32 s27, s21, 9
s_add_u32 s27, s27, 14336
v_add_u32 v13, s27, v44
v_lshrrev_b32 v44, 3, v40
v_lshl_add_u32 v44, v44, 2, v41
v_and_b32 v45, 1, v44
v_and_b32 v46, 6, v44
v_lshl_add_u32 v45, v46, 1, v45
s_lshl_b32 s27, s21, 5
v_add_u32 v45, s27, v45
v_lshlrev_b32 v45, 11, v45
v_lshlrev_b32 v46, 1, v44
v_xor_b32 v46, s20, v46
v_lshl_add_u32 v45, v46, 6, v45
v_and_b32 v46, 7, v40
v_lshl_add_u32 v14, v46, 3, v45
s_lshl_b32 s27, s20, 2
s_add_u32 s27, s27, s21
s_lshl_b32 s27, s27, 11
v_add_u32 v15, s27, v10
v_and_b32 v44, 1, v0
v_lshlrev_b32 v44, 1, v44
v_bfe_u32 v45, v0, 2, 1
v_add_u32 v44, v44, v45
v_lshlrev_b32 v44, 4, v44
v_and_b32 v45, 1, v41
v_lshlrev_b32 v45, 1, v45
v_lshrrev_b32 v46, 1, v41
v_add_u32 v45, v45, v46
v_lshl_add_u32 v44, v45, 2, v44
s_lshr_b32 s27, s20, 3
s_lshl_b32 s27, s27, 11
s_and_b32 s28, s20, 7
s_lshl_b32 s28, s28, 7
s_add_u32 s27, s27, s28
s_lshr_b32 s28, s21, 1
s_lshl_b32 s28, s28, 10
s_add_u32 s27, s27, s28
s_and_b32 s28, s21, 1
s_lshl_b32 s28, s28, 6
s_add_u32 s27, s27, s28
v_add_u32 v16, s27, v44
s_mov_b32 s46, 0x00330033
s_mov_b32 s47, 0x00330033
s_mov_b32 s24, 0x3e0293ee
s_mov_b32 s50, 0xfffffffe
s_mov_b32 s22, 0x2f800000
s_mov_b32 s51, 0x28000000
s_mov_b32 s6, 0x3f803f80
s_mov_b32 s7, 0x3f803f80
v_lshlrev_b32 v44, 4, v42
v_mov_b32 v45, 0x3f80
v_lshlrev_b32 v11, v44, v45
s_cmp_eq_u32 s21, 0
s_cselect_b32 s12, 1, 0
s_mov_b32 s13, 0
s_lshl_b32 s27, s20, 7
s_add_u32 s27, s27, 598016
v_mov_b32 v18, s27
s_lshl_b32 s27, s21, 11
v_lshl_add_u32 v9, v0, 5, s27
s_add_u32 s30, s48, 0
s_addc_u32 s31, s49, 0
s_add_u32 s32, s48, 32768
s_addc_u32 s33, s49, 0
s_add_u32 s52, s48, 4096
s_addc_u32 s53, s49, 0
s_add_u32 s54, s48, 36864
s_addc_u32 s55, s49, 0
s_add_u32 s34, s48, 262144
s_addc_u32 s35, s49, 0
s_add_u32 s36, s48, 270336
s_addc_u32 s37, s49, 0
s_lshl_b32 s27, s20, 13
s_add_u32 s28, s27, 16777216
s_add_u32 s38, s48, s28
s_addc_u32 s39, s49, 0
s_add_u32 s28, s27, 33554432
s_add_u32 s40, s48, s28
s_addc_u32 s41, s49, 0
s_lshl_b32 s27, s20, 12
s_lshl_b32 s28, s21, 10
s_add_u32 s27, s27, s28
s_add_u32 s28, s27, 50331648
s_add_u32 s42, s48, s28
s_addc_u32 s43, s49, 0
s_lshl_b32 s27, s20, 7
s_lshl_b32 s28, s21, 2
s_add_u32 s27, s27, s28
s_add_u32 s28, s27, 598016
s_add_u32 s56, s48, s28
s_addc_u32 s57, s49, 0
s_lshl_b32 s27, s20, 7
s_add_u32 s28, s27, 589824
s_add_u32 s2, s48, s28
s_addc_u32 s3, s49, 0
v_lshrrev_b32 v52, 4, v0
v_bfe_u32 v53, v0, 2, 2
v_bfe_u32 v54, v0, 1, 1
v_and_b32 v55, 1, v0
v_and_b32 v56, 1, v52
v_lshl_add_u32 v57, v53, 1, v56
v_lshlrev_b32 v57, 1, v57
s_lshl_b32 s27, s21, 2
v_xor_b32 v57, s27, v57
v_add_u32 v57, v57, v54
v_lshlrev_b32 v57, 4, v57
v_lshl_add_u32 v57, v55, 3, v57
v_lshl_add_u32 v57, v53, 8, v57
v_lshl_add_u32 v110, v52, 11, v57
v_xor_b32 v111, 32, v110
v_lshrrev_b32 v57, 1, v52
v_lshl_add_u32 v57, v56, 1, v57
v_lshlrev_b32 v57, 12, v57
v_and_b32 v58, 1, v53
v_lshl_add_u32 v57, v58, 10, v57
v_lshlrev_b32 v58, 2, v58
v_lshl_add_u32 v58, v56, 3, v58
v_lshrrev_b32 v59, 1, v53
v_lshl_add_u32 v59, v59, 1, v54
v_add_u32 v58, v58, v59
v_lshlrev_b32 v58, 4, v58
v_lshl_add_u32 v58, v55, 3, v58
v_add_u32 v57, v57, v58
s_lshl_b32 s27, s21, 8
v_add_u32 v112, s27, v57
s_lshl_b32 s69, s20, 17
s_lshr_b32 s27, s21, 1
s_lshl_b32 s27, s27, 14
s_add_u32 s69, s69, s27
s_and_b32 s27, s21, 1
s_lshl_b32 s27, s27, 12
s_add_u32 s69, s69, s27
v_xor_b32 v113, 64, v112
v_xor_b32 v114, 128, v112
v_xor_b32 v115, 192, v112
v_and_b32 v52, 15, v0
v_bfe_u32 v53, v52, 3, 1
s_lshl_b32 s27, s21, 1
v_add_u32 v53, s27, v53
v_lshlrev_b32 v53, 10, v53
v_bfe_u32 v54, v52, 2, 1
v_lshl_add_u32 v53, v54, 5, v53
v_and_b32 v54, 3, v52
v_lshl_add_u32 v53, v54, 2, v53
s_lshr_b32 s27, s20, 2
s_lshl_b32 s27, s27, 7
s_bfe_u32 s28, s20, 0x10001
s_lshl_b32 s28, s28, 6
s_add_u32 s27, s27, s28
s_and_b32 s28, s20, 1
s_lshl_b32 s28, s28, 4
s_add_u32 s27, s27, s28
v_add_u32 v53, s27, v53
s_lshl_b32 s27, s20, 8
s_lshl_b32 s28, s21, 6
s_add_u32 s27, s27, s28
v_lshlrev_b32 v122, 2, v52
v_add_u32 v122, s27, v122
v_mov_b32 v124, 0
v_mov_b32 v125, 0
v_mov_b32 v126, 0
v_mov_b32 v127, 0
v_mov_b32 v123, -1
global_load_dword v20, v53, s[72:73]
global_store_dwordx4 v15, v[124:127], s[30:31]
global_store_dwordx4 v15, v[124:127], s[30:31] offset:1024
s_mov_b64 exec, 0xffff
global_store_dword v122, v123, s[36:37]
s_mov_b64 exec, -1
s_waitcnt vmcnt(16) lgkmcnt(0)
s_barrier
s_add_u32 m0, s71, 131072 + 0
s_add_u32 s70, s68, 2621440
buffer_load_dwordx4 v104, s[76:79], s70 offen lds
s_add_u32 m0, s71, 131072 + 1024
s_add_u32 s70, s68, 2637824
buffer_load_dwordx4 v104, s[76:79], s70 offen lds
s_add_u32 m0, s71, 131072 + 2048
s_add_u32 s70, s68, 2654208
buffer_load_dwordx4 v105, s[76:79], s70 offen lds
s_add_u32 m0, s71, 131072 + 3072
s_add_u32 s70, s68, 2670592
buffer_load_dwordx4 v105, s[76:79], s70 offen lds
v_add_u32 v116, 0, v110
v_add_u32 v117, 0, v111
s_cmp_eq_u32 s21, 1
s_cbranch_scc1 L_lq0_1
s_cmp_eq_u32 s21, 2
s_cbranch_scc1 L_lq0_2
s_cmp_eq_u32 s21, 3
s_cbranch_scc1 L_lq0_3
ds_read_b64_tr_b16 a[0:1], v116 offset:0
ds_read_b64_tr_b16 a[2:3], v116 offset:1024
ds_read_b64_tr_b16 a[4:5], v116 offset:8192
ds_read_b64_tr_b16 a[6:7], v116 offset:9216
ds_read_b64_tr_b16 a[8:9], v117 offset:0
ds_read_b64_tr_b16 a[10:11], v117 offset:1024
ds_read_b64_tr_b16 a[12:13], v117 offset:8192
ds_read_b64_tr_b16 a[14:15], v117 offset:9216
s_branch L_lq0_e
L_lq0_1:
ds_read_b64_tr_b16 a[32:33], v116 offset:0
ds_read_b64_tr_b16 a[34:35], v116 offset:1024
ds_read_b64_tr_b16 a[36:37], v116 offset:8192
ds_read_b64_tr_b16 a[38:39], v116 offset:9216
ds_read_b64_tr_b16 a[40:41], v117 offset:0
ds_read_b64_tr_b16 a[42:43], v117 offset:1024
ds_read_b64_tr_b16 a[44:45], v117 offset:8192
ds_read_b64_tr_b16 a[46:47], v117 offset:9216
s_branch L_lq0_e
L_lq0_2:
ds_read_b64_tr_b16 a[64:65], v116 offset:0
ds_read_b64_tr_b16 a[66:67], v116 offset:1024
ds_read_b64_tr_b16 a[68:69], v116 offset:8192
ds_read_b64_tr_b16 a[70:71], v116 offset:9216
ds_read_b64_tr_b16 a[72:73], v117 offset:0
ds_read_b64_tr_b16 a[74:75], v117 offset:1024
ds_read_b64_tr_b16 a[76:77], v117 offset:8192
ds_read_b64_tr_b16 a[78:79], v117 offset:9216
s_branch L_lq0_e
L_lq0_3:
ds_read_b64_tr_b16 a[96:97], v116 offset:0
ds_read_b64_tr_b16 a[98:99], v116 offset:1024
ds_read_b64_tr_b16 a[100:101], v116 offset:8192
ds_read_b64_tr_b16 a[102:103], v116 offset:9216
ds_read_b64_tr_b16 a[104:105], v117 offset:0
ds_read_b64_tr_b16 a[106:107], v117 offset:1024
ds_read_b64_tr_b16 a[108:109], v117 offset:8192
ds_read_b64_tr_b16 a[110:111], v117 offset:9216
L_lq0_e:
s_waitcnt vmcnt(16) lgkmcnt(0)
s_barrier
s_add_u32 m0, s71, 0 + 0
s_add_u32 s70, s68, 3145728
buffer_load_dwordx4 v104, s[76:79], s70 offen lds
s_add_u32 m0, s71, 0 + 1024
s_add_u32 s70, s68, 3162112
buffer_load_dwordx4 v104, s[76:79], s70 offen lds
s_add_u32 m0, s71, 0 + 2048
s_add_u32 s70, s68, 3178496
buffer_load_dwordx4 v105, s[76:79], s70 offen lds
s_add_u32 m0, s71, 0 + 3072
s_add_u32 s70, s68, 3194880
buffer_load_dwordx4 v105, s[76:79], s70 offen lds
v_mov_b32 v56, 192
v_mov_b32 v57, 1
s_mov_b64 exec, s[12:13]
global_atomic_add v56, v57, s[8:9] sc1
s_mov_b64 exec, -1
v_add_u32 v116, 32768, v110
v_add_u32 v117, 32768, v111
s_cmp_eq_u32 s21, 1
s_cbranch_scc1 L_lq1_1
s_cmp_eq_u32 s21, 2
s_cbranch_scc1 L_lq1_2
s_cmp_eq_u32 s21, 3
s_cbranch_scc1 L_lq1_3
ds_read_b64_tr_b16 a[16:17], v116 offset:0
ds_read_b64_tr_b16 a[18:19], v116 offset:1024
ds_read_b64_tr_b16 a[20:21], v116 offset:8192
ds_read_b64_tr_b16 a[22:23], v116 offset:9216
ds_read_b64_tr_b16 a[24:25], v117 offset:0
ds_read_b64_tr_b16 a[26:27], v117 offset:1024
ds_read_b64_tr_b16 a[28:29], v117 offset:8192
ds_read_b64_tr_b16 a[30:31], v117 offset:9216
s_branch L_lq1_e
L_lq1_1:
ds_read_b64_tr_b16 a[48:49], v116 offset:0
ds_read_b64_tr_b16 a[50:51], v116 offset:1024
ds_read_b64_tr_b16 a[52:53], v116 offset:8192
ds_read_b64_tr_b16 a[54:55], v116 offset:9216
ds_read_b64_tr_b16 a[56:57], v117 offset:0
ds_read_b64_tr_b16 a[58:59], v117 offset:1024
ds_read_b64_tr_b16 a[60:61], v117 offset:8192
ds_read_b64_tr_b16 a[62:63], v117 offset:9216
s_branch L_lq1_e
L_lq1_2:
ds_read_b64_tr_b16 a[80:81], v116 offset:0
ds_read_b64_tr_b16 a[82:83], v116 offset:1024
ds_read_b64_tr_b16 a[84:85], v116 offset:8192
ds_read_b64_tr_b16 a[86:87], v116 offset:9216
ds_read_b64_tr_b16 a[88:89], v117 offset:0
ds_read_b64_tr_b16 a[90:91], v117 offset:1024
ds_read_b64_tr_b16 a[92:93], v117 offset:8192
ds_read_b64_tr_b16 a[94:95], v117 offset:9216
s_branch L_lq1_e
L_lq1_3:
ds_read_b64_tr_b16 a[112:113], v116 offset:0
ds_read_b64_tr_b16 a[114:115], v116 offset:1024
ds_read_b64_tr_b16 a[116:117], v116 offset:8192
ds_read_b64_tr_b16 a[118:119], v116 offset:9216
ds_read_b64_tr_b16 a[120:121], v117 offset:0
ds_read_b64_tr_b16 a[122:123], v117 offset:1024
ds_read_b64_tr_b16 a[124:125], v117 offset:8192
ds_read_b64_tr_b16 a[126:127], v117 offset:9216
L_lq1_e:
s_waitcnt vmcnt(16) lgkmcnt(0)
s_barrier
s_add_u32 m0, s71, 32768 + 0
s_add_u32 s70, s68, 3670016
buffer_load_dwordx4 v104, s[76:79], s70 offen lds
s_add_u32 m0, s71, 32768 + 1024
s_add_u32 s70, s68, 3686400
buffer_load_dwordx4 v104, s[76:79], s70 offen lds
s_add_u32 m0, s71, 32768 + 2048
s_add_u32 s70, s68, 3702784
buffer_load_dwordx4 v105, s[76:79], s70 offen lds
s_add_u32 m0, s71, 32768 + 3072
s_add_u32 s70, s68, 3719168
buffer_load_dwordx4 v105, s[76:79], s70 offen lds
v_add_u32 v116, 16384, v110
v_add_u32 v117, 16384, v111
s_cmp_eq_u32 s21, 1
s_cbranch_scc1 L_lq2_1
s_cmp_eq_u32 s21, 2
s_cbranch_scc1 L_lq2_2
s_cmp_eq_u32 s21, 3
s_cbranch_scc1 L_lq2_3
ds_read_b64_tr_b16 a[32:33], v116 offset:0
ds_read_b64_tr_b16 a[34:35], v116 offset:1024
ds_read_b64_tr_b16 a[36:37], v116 offset:8192
ds_read_b64_tr_b16 a[38:39], v116 offset:9216
ds_read_b64_tr_b16 a[40:41], v117 offset:0
ds_read_b64_tr_b16 a[42:43], v117 offset:1024
ds_read_b64_tr_b16 a[44:45], v117 offset:8192
ds_read_b64_tr_b16 a[46:47], v117 offset:9216
s_branch L_lq2_e
L_lq2_1:
ds_read_b64_tr_b16 a[0:1], v116 offset:0
ds_read_b64_tr_b16 a[2:3], v116 offset:1024
ds_read_b64_tr_b16 a[4:5], v116 offset:8192
ds_read_b64_tr_b16 a[6:7], v116 offset:9216
ds_read_b64_tr_b16 a[8:9], v117 offset:0
ds_read_b64_tr_b16 a[10:11], v117 offset:1024
ds_read_b64_tr_b16 a[12:13], v117 offset:8192
ds_read_b64_tr_b16 a[14:15], v117 offset:9216
s_branch L_lq2_e
L_lq2_2:
ds_read_b64_tr_b16 a[96:97], v116 offset:0
ds_read_b64_tr_b16 a[98:99], v116 offset:1024
ds_read_b64_tr_b16 a[100:101], v116 offset:8192
ds_read_b64_tr_b16 a[102:103], v116 offset:9216
ds_read_b64_tr_b16 a[104:105], v117 offset:0
ds_read_b64_tr_b16 a[106:107], v117 offset:1024
ds_read_b64_tr_b16 a[108:109], v117 offset:8192
ds_read_b64_tr_b16 a[110:111], v117 offset:9216
s_branch L_lq2_e
L_lq2_3:
ds_read_b64_tr_b16 a[64:65], v116 offset:0
ds_read_b64_tr_b16 a[66:67], v116 offset:1024
ds_read_b64_tr_b16 a[68:69], v116 offset:8192
ds_read_b64_tr_b16 a[70:71], v116 offset:9216
ds_read_b64_tr_b16 a[72:73], v117 offset:0
ds_read_b64_tr_b16 a[74:75], v117 offset:1024
ds_read_b64_tr_b16 a[76:77], v117 offset:8192
ds_read_b64_tr_b16 a[78:79], v117 offset:9216
L_lq2_e:
s_waitcnt vmcnt(16) lgkmcnt(0)
s_barrier
s_add_u32 m0, s71, 16384 + 0
s_add_u32 s70, s68, 0
buffer_load_dwordx4 v104, s[64:67], s70 offen lds
s_add_u32 m0, s71, 16384 + 1024
s_add_u32 s70, s68, 16384
buffer_load_dwordx4 v104, s[64:67], s70 offen lds
s_add_u32 m0, s71, 16384 + 2048
s_add_u32 s70, s68, 32768
buffer_load_dwordx4 v105, s[64:67], s70 offen lds
s_add_u32 m0, s71, 16384 + 3072
s_add_u32 s70, s68, 49152
buffer_load_dwordx4 v105, s[64:67], s70 offen lds
v_add_u32 v116, 65536, v110
v_add_u32 v117, 65536, v111
s_cmp_eq_u32 s21, 1
s_cbranch_scc1 L_lq3_1
s_cmp_eq_u32 s21, 2
s_cbranch_scc1 L_lq3_2
s_cmp_eq_u32 s21, 3
s_cbranch_scc1 L_lq3_3
ds_read_b64_tr_b16 a[48:49], v116 offset:0
ds_read_b64_tr_b16 a[50:51], v116 offset:1024
ds_read_b64_tr_b16 a[52:53], v116 offset:8192
ds_read_b64_tr_b16 a[54:55], v116 offset:9216
ds_read_b64_tr_b16 a[56:57], v117 offset:0
ds_read_b64_tr_b16 a[58:59], v117 offset:1024
ds_read_b64_tr_b16 a[60:61], v117 offset:8192
ds_read_b64_tr_b16 a[62:63], v117 offset:9216
s_branch L_lq3_e
L_lq3_1:
ds_read_b64_tr_b16 a[16:17], v116 offset:0
ds_read_b64_tr_b16 a[18:19], v116 offset:1024
ds_read_b64_tr_b16 a[20:21], v116 offset:8192
ds_read_b64_tr_b16 a[22:23], v116 offset:9216
ds_read_b64_tr_b16 a[24:25], v117 offset:0
ds_read_b64_tr_b16 a[26:27], v117 offset:1024
ds_read_b64_tr_b16 a[28:29], v117 offset:8192
ds_read_b64_tr_b16 a[30:31], v117 offset:9216
s_branch L_lq3_e
L_lq3_2:
ds_read_b64_tr_b16 a[112:113], v116 offset:0
ds_read_b64_tr_b16 a[114:115], v116 offset:1024
ds_read_b64_tr_b16 a[116:117], v116 offset:8192
ds_read_b64_tr_b16 a[118:119], v116 offset:9216
ds_read_b64_tr_b16 a[120:121], v117 offset:0
ds_read_b64_tr_b16 a[122:123], v117 offset:1024
ds_read_b64_tr_b16 a[124:125], v117 offset:8192
ds_read_b64_tr_b16 a[126:127], v117 offset:9216
s_branch L_lq3_e
L_lq3_3:
ds_read_b64_tr_b16 a[80:81], v116 offset:0
ds_read_b64_tr_b16 a[82:83], v116 offset:1024
ds_read_b64_tr_b16 a[84:85], v116 offset:8192
ds_read_b64_tr_b16 a[86:87], v116 offset:9216
ds_read_b64_tr_b16 a[88:89], v117 offset:0
ds_read_b64_tr_b16 a[90:91], v117 offset:1024
ds_read_b64_tr_b16 a[92:93], v117 offset:8192
ds_read_b64_tr_b16 a[94:95], v117 offset:9216
L_lq3_e:
s_waitcnt vmcnt(16) lgkmcnt(0)
s_barrier
s_add_u32 m0, s71, 65536 + 0
s_add_u32 s70, s68, 524288
buffer_load_dwordx4 v104, s[64:67], s70 offen lds
s_add_u32 m0, s71, 65536 + 1024
s_add_u32 s70, s68, 540672
buffer_load_dwordx4 v104, s[64:67], s70 offen lds
s_add_u32 m0, s71, 65536 + 2048
s_add_u32 s70, s68, 557056
buffer_load_dwordx4 v105, s[64:67], s70 offen lds
s_add_u32 m0, s71, 65536 + 3072
s_add_u32 s70, s68, 573440
buffer_load_dwordx4 v105, s[64:67], s70 offen lds
v_min_u32 v20, s50, v20
s_mov_b64 exec, 0xffff
global_store_dword v122, v20, s[34:35]
s_mov_b64 exec, -1
v_add_u32 v116, 98304, v110
v_add_u32 v117, 98304, v111
s_cmp_eq_u32 s21, 1
s_cbranch_scc1 L_lq4_1
s_cmp_eq_u32 s21, 2
s_cbranch_scc1 L_lq4_2
s_cmp_eq_u32 s21, 3
s_cbranch_scc1 L_lq4_3
ds_read_b64_tr_b16 a[64:65], v116 offset:0
ds_read_b64_tr_b16 a[66:67], v116 offset:1024
ds_read_b64_tr_b16 a[68:69], v116 offset:8192
ds_read_b64_tr_b16 a[70:71], v116 offset:9216
ds_read_b64_tr_b16 a[72:73], v117 offset:0
ds_read_b64_tr_b16 a[74:75], v117 offset:1024
ds_read_b64_tr_b16 a[76:77], v117 offset:8192
ds_read_b64_tr_b16 a[78:79], v117 offset:9216
s_branch L_lq4_e
L_lq4_1:
ds_read_b64_tr_b16 a[96:97], v116 offset:0
ds_read_b64_tr_b16 a[98:99], v116 offset:1024
ds_read_b64_tr_b16 a[100:101], v116 offset:8192
ds_read_b64_tr_b16 a[102:103], v116 offset:9216
ds_read_b64_tr_b16 a[104:105], v117 offset:0
ds_read_b64_tr_b16 a[106:107], v117 offset:1024
ds_read_b64_tr_b16 a[108:109], v117 offset:8192
ds_read_b64_tr_b16 a[110:111], v117 offset:9216
s_branch L_lq4_e
L_lq4_2:
ds_read_b64_tr_b16 a[0:1], v116 offset:0
ds_read_b64_tr_b16 a[2:3], v116 offset:1024
ds_read_b64_tr_b16 a[4:5], v116 offset:8192
ds_read_b64_tr_b16 a[6:7], v116 offset:9216
ds_read_b64_tr_b16 a[8:9], v117 offset:0
ds_read_b64_tr_b16 a[10:11], v117 offset:1024
ds_read_b64_tr_b16 a[12:13], v117 offset:8192
ds_read_b64_tr_b16 a[14:15], v117 offset:9216
s_branch L_lq4_e
L_lq4_3:
ds_read_b64_tr_b16 a[32:33], v116 offset:0
ds_read_b64_tr_b16 a[34:35], v116 offset:1024
ds_read_b64_tr_b16 a[36:37], v116 offset:8192
ds_read_b64_tr_b16 a[38:39], v116 offset:9216
ds_read_b64_tr_b16 a[40:41], v117 offset:0
ds_read_b64_tr_b16 a[42:43], v117 offset:1024
ds_read_b64_tr_b16 a[44:45], v117 offset:8192
ds_read_b64_tr_b16 a[46:47], v117 offset:9216
L_lq4_e:
s_waitcnt vmcnt(16) lgkmcnt(0)
s_barrier
s_add_u32 m0, s71, 98304 + 0
s_add_u32 s70, s68, 1048576
buffer_load_dwordx4 v104, s[64:67], s70 offen lds
s_add_u32 m0, s71, 98304 + 1024
s_add_u32 s70, s68, 1064960
buffer_load_dwordx4 v104, s[64:67], s70 offen lds
s_add_u32 m0, s71, 98304 + 2048
s_add_u32 s70, s68, 1081344
buffer_load_dwordx4 v105, s[64:67], s70 offen lds
s_add_u32 m0, s71, 98304 + 3072
s_add_u32 s70, s68, 1097728
buffer_load_dwordx4 v105, s[64:67], s70 offen lds
v_add_u32 v116, 131072, v110
v_add_u32 v117, 131072, v111
s_cmp_eq_u32 s21, 1
s_cbranch_scc1 L_lq5_1
s_cmp_eq_u32 s21, 2
s_cbranch_scc1 L_lq5_2
s_cmp_eq_u32 s21, 3
s_cbranch_scc1 L_lq5_3
ds_read_b64_tr_b16 a[80:81], v116 offset:0
ds_read_b64_tr_b16 a[82:83], v116 offset:1024
ds_read_b64_tr_b16 a[84:85], v116 offset:8192
ds_read_b64_tr_b16 a[86:87], v116 offset:9216
ds_read_b64_tr_b16 a[88:89], v117 offset:0
ds_read_b64_tr_b16 a[90:91], v117 offset:1024
ds_read_b64_tr_b16 a[92:93], v117 offset:8192
ds_read_b64_tr_b16 a[94:95], v117 offset:9216
s_branch L_lq5_e
L_lq5_1:
ds_read_b64_tr_b16 a[112:113], v116 offset:0
ds_read_b64_tr_b16 a[114:115], v116 offset:1024
ds_read_b64_tr_b16 a[116:117], v116 offset:8192
ds_read_b64_tr_b16 a[118:119], v116 offset:9216
ds_read_b64_tr_b16 a[120:121], v117 offset:0
ds_read_b64_tr_b16 a[122:123], v117 offset:1024
ds_read_b64_tr_b16 a[124:125], v117 offset:8192
ds_read_b64_tr_b16 a[126:127], v117 offset:9216
s_branch L_lq5_e
L_lq5_2:
ds_read_b64_tr_b16 a[16:17], v116 offset:0
ds_read_b64_tr_b16 a[18:19], v116 offset:1024
ds_read_b64_tr_b16 a[20:21], v116 offset:8192
ds_read_b64_tr_b16 a[22:23], v116 offset:9216
ds_read_b64_tr_b16 a[24:25], v117 offset:0
ds_read_b64_tr_b16 a[26:27], v117 offset:1024
ds_read_b64_tr_b16 a[28:29], v117 offset:8192
ds_read_b64_tr_b16 a[30:31], v117 offset:9216
s_branch L_lq5_e
L_lq5_3:
ds_read_b64_tr_b16 a[48:49], v116 offset:0
ds_read_b64_tr_b16 a[50:51], v116 offset:1024
ds_read_b64_tr_b16 a[52:53], v116 offset:8192
ds_read_b64_tr_b16 a[54:55], v116 offset:9216
ds_read_b64_tr_b16 a[56:57], v117 offset:0
ds_read_b64_tr_b16 a[58:59], v117 offset:1024
ds_read_b64_tr_b16 a[60:61], v117 offset:8192
ds_read_b64_tr_b16 a[62:63], v117 offset:9216
L_lq5_e:
s_waitcnt vmcnt(16) lgkmcnt(0)
s_barrier
s_add_u32 m0, s71, 131072 + 0
s_add_u32 s70, s68, 1572864
buffer_load_dwordx4 v104, s[64:67], s70 offen lds
s_add_u32 m0, s71, 131072 + 1024
s_add_u32 s70, s68, 1589248
buffer_load_dwordx4 v104, s[64:67], s70 offen lds
s_add_u32 m0, s71, 131072 + 2048
s_add_u32 s70, s68, 1605632
buffer_load_dwordx4 v105, s[64:67], s70 offen lds
s_add_u32 m0, s71, 131072 + 3072
s_add_u32 s70, s68, 1622016
buffer_load_dwordx4 v105, s[64:67], s70 offen lds
v_add_u32 v116, 0, v110
v_add_u32 v117, 0, v111
s_cmp_eq_u32 s21, 1
s_cbranch_scc1 L_lq6_1
s_cmp_eq_u32 s21, 2
s_cbranch_scc1 L_lq6_2
s_cmp_eq_u32 s21, 3
s_cbranch_scc1 L_lq6_3
ds_read_b64_tr_b16 a[96:97], v116 offset:0
ds_read_b64_tr_b16 a[98:99], v116 offset:1024
ds_read_b64_tr_b16 a[100:101], v116 offset:8192
ds_read_b64_tr_b16 a[102:103], v116 offset:9216
ds_read_b64_tr_b16 a[104:105], v117 offset:0
ds_read_b64_tr_b16 a[106:107], v117 offset:1024
ds_read_b64_tr_b16 a[108:109], v117 offset:8192
ds_read_b64_tr_b16 a[110:111], v117 offset:9216
s_branch L_lq6_e
L_lq6_1:
ds_read_b64_tr_b16 a[64:65], v116 offset:0
ds_read_b64_tr_b16 a[66:67], v116 offset:1024
ds_read_b64_tr_b16 a[68:69], v116 offset:8192
ds_read_b64_tr_b16 a[70:71], v116 offset:9216
ds_read_b64_tr_b16 a[72:73], v117 offset:0
ds_read_b64_tr_b16 a[74:75], v117 offset:1024
ds_read_b64_tr_b16 a[76:77], v117 offset:8192
ds_read_b64_tr_b16 a[78:79], v117 offset:9216
s_branch L_lq6_e
L_lq6_2:
ds_read_b64_tr_b16 a[32:33], v116 offset:0
ds_read_b64_tr_b16 a[34:35], v116 offset:1024
ds_read_b64_tr_b16 a[36:37], v116 offset:8192
ds_read_b64_tr_b16 a[38:39], v116 offset:9216
ds_read_b64_tr_b16 a[40:41], v117 offset:0
ds_read_b64_tr_b16 a[42:43], v117 offset:1024
ds_read_b64_tr_b16 a[44:45], v117 offset:8192
ds_read_b64_tr_b16 a[46:47], v117 offset:9216
s_branch L_lq6_e
L_lq6_3:
ds_read_b64_tr_b16 a[0:1], v116 offset:0
ds_read_b64_tr_b16 a[2:3], v116 offset:1024
ds_read_b64_tr_b16 a[4:5], v116 offset:8192
ds_read_b64_tr_b16 a[6:7], v116 offset:9216
ds_read_b64_tr_b16 a[8:9], v117 offset:0
ds_read_b64_tr_b16 a[10:11], v117 offset:1024
ds_read_b64_tr_b16 a[12:13], v117 offset:8192
ds_read_b64_tr_b16 a[14:15], v117 offset:9216
L_lq6_e:
s_waitcnt vmcnt(16) lgkmcnt(0)
s_barrier
s_add_u32 m0, s71, 0 + 0
s_add_u32 s70, s68, 2097152
buffer_load_dwordx4 v104, s[64:67], s70 offen lds
s_add_u32 m0, s71, 0 + 1024
s_add_u32 s70, s68, 2113536
buffer_load_dwordx4 v104, s[64:67], s70 offen lds
s_add_u32 m0, s71, 0 + 2048
s_add_u32 s70, s68, 2129920
buffer_load_dwordx4 v105, s[64:67], s70 offen lds
s_add_u32 m0, s71, 0 + 3072
s_add_u32 s70, s68, 2146304
buffer_load_dwordx4 v105, s[64:67], s70 offen lds
v_add_u32 v116, 32768, v110
v_add_u32 v117, 32768, v111
s_cmp_eq_u32 s21, 1
s_cbranch_scc1 L_lq7_1
s_cmp_eq_u32 s21, 2
s_cbranch_scc1 L_lq7_2
s_cmp_eq_u32 s21, 3
s_cbranch_scc1 L_lq7_3
ds_read_b64_tr_b16 a[112:113], v116 offset:0
ds_read_b64_tr_b16 a[114:115], v116 offset:1024
ds_read_b64_tr_b16 a[116:117], v116 offset:8192
ds_read_b64_tr_b16 a[118:119], v116 offset:9216
ds_read_b64_tr_b16 a[120:121], v117 offset:0
ds_read_b64_tr_b16 a[122:123], v117 offset:1024
ds_read_b64_tr_b16 a[124:125], v117 offset:8192
ds_read_b64_tr_b16 a[126:127], v117 offset:9216
s_branch L_lq7_e
L_lq7_1:
ds_read_b64_tr_b16 a[80:81], v116 offset:0
ds_read_b64_tr_b16 a[82:83], v116 offset:1024
ds_read_b64_tr_b16 a[84:85], v116 offset:8192
ds_read_b64_tr_b16 a[86:87], v116 offset:9216
ds_read_b64_tr_b16 a[88:89], v117 offset:0
ds_read_b64_tr_b16 a[90:91], v117 offset:1024
ds_read_b64_tr_b16 a[92:93], v117 offset:8192
ds_read_b64_tr_b16 a[94:95], v117 offset:9216
s_branch L_lq7_e
L_lq7_2:
ds_read_b64_tr_b16 a[48:49], v116 offset:0
ds_read_b64_tr_b16 a[50:51], v116 offset:1024
ds_read_b64_tr_b16 a[52:53], v116 offset:8192
ds_read_b64_tr_b16 a[54:55], v116 offset:9216
ds_read_b64_tr_b16 a[56:57], v117 offset:0
ds_read_b64_tr_b16 a[58:59], v117 offset:1024
ds_read_b64_tr_b16 a[60:61], v117 offset:8192
ds_read_b64_tr_b16 a[62:63], v117 offset:9216
s_branch L_lq7_e
L_lq7_3:
ds_read_b64_tr_b16 a[16:17], v116 offset:0
ds_read_b64_tr_b16 a[18:19], v116 offset:1024
ds_read_b64_tr_b16 a[20:21], v116 offset:8192
ds_read_b64_tr_b16 a[22:23], v116 offset:9216
ds_read_b64_tr_b16 a[24:25], v117 offset:0
ds_read_b64_tr_b16 a[26:27], v117 offset:1024
ds_read_b64_tr_b16 a[28:29], v117 offset:8192
ds_read_b64_tr_b16 a[30:31], v117 offset:9216
L_lq7_e:
s_waitcnt vmcnt(16) lgkmcnt(0)
s_barrier
s_add_u32 m0, s71, 32768 + 0
s_add_u32 s70, s68, 2621440
buffer_load_dwordx4 v104, s[64:67], s70 offen lds
s_add_u32 m0, s71, 32768 + 1024
s_add_u32 s70, s68, 2637824
buffer_load_dwordx4 v104, s[64:67], s70 offen lds
s_add_u32 m0, s71, 32768 + 2048
s_add_u32 s70, s68, 2654208
buffer_load_dwordx4 v105, s[64:67], s70 offen lds
s_add_u32 m0, s71, 32768 + 3072
s_add_u32 s70, s68, 2670592
buffer_load_dwordx4 v105, s[64:67], s70 offen lds
v_add_u32 v116, 16384, v110
v_add_u32 v117, 16384, v111
s_cmp_eq_u32 s21, 1
s_cbranch_scc1 L_lk0_1
s_cmp_eq_u32 s21, 2
s_cbranch_scc1 L_lk0_2
s_cmp_eq_u32 s21, 3
s_cbranch_scc1 L_lk0_3
ds_read_b64_tr_b16 a[128:129], v116 offset:0
ds_read_b64_tr_b16 a[130:131], v116 offset:1024
ds_read_b64_tr_b16 a[132:133], v116 offset:8192
ds_read_b64_tr_b16 a[134:135], v116 offset:9216
ds_read_b64_tr_b16 a[136:137], v117 offset:0
ds_read_b64_tr_b16 a[138:139], v117 offset:1024
ds_read_b64_tr_b16 a[140:141], v117 offset:8192
ds_read_b64_tr_b16 a[142:143], v117 offset:9216
s_branch L_lk0_e
L_lk0_1:
ds_read_b64_tr_b16 a[160:161], v116 offset:0
ds_read_b64_tr_b16 a[162:163], v116 offset:1024
ds_read_b64_tr_b16 a[164:165], v116 offset:8192
ds_read_b64_tr_b16 a[166:167], v116 offset:9216
ds_read_b64_tr_b16 a[168:169], v117 offset:0
ds_read_b64_tr_b16 a[170:171], v117 offset:1024
ds_read_b64_tr_b16 a[172:173], v117 offset:8192
ds_read_b64_tr_b16 a[174:175], v117 offset:9216
s_branch L_lk0_e
L_lk0_2:
ds_read_b64_tr_b16 a[192:193], v116 offset:0
ds_read_b64_tr_b16 a[194:195], v116 offset:1024
ds_read_b64_tr_b16 a[196:197], v116 offset:8192
ds_read_b64_tr_b16 a[198:199], v116 offset:9216
ds_read_b64_tr_b16 a[200:201], v117 offset:0
ds_read_b64_tr_b16 a[202:203], v117 offset:1024
ds_read_b64_tr_b16 a[204:205], v117 offset:8192
ds_read_b64_tr_b16 a[206:207], v117 offset:9216
s_branch L_lk0_e
L_lk0_3:
ds_read_b64_tr_b16 a[224:225], v116 offset:0
ds_read_b64_tr_b16 a[226:227], v116 offset:1024
ds_read_b64_tr_b16 a[228:229], v116 offset:8192
ds_read_b64_tr_b16 a[230:231], v116 offset:9216
ds_read_b64_tr_b16 a[232:233], v117 offset:0
ds_read_b64_tr_b16 a[234:235], v117 offset:1024
ds_read_b64_tr_b16 a[236:237], v117 offset:8192
ds_read_b64_tr_b16 a[238:239], v117 offset:9216
L_lk0_e:
s_waitcnt vmcnt(16) lgkmcnt(0)
s_barrier
s_add_u32 m0, s71, 16384 + 0
s_add_u32 s70, s68, 3145728
buffer_load_dwordx4 v104, s[64:67], s70 offen lds
s_add_u32 m0, s71, 16384 + 1024
s_add_u32 s70, s68, 3162112
buffer_load_dwordx4 v104, s[64:67], s70 offen lds
s_add_u32 m0, s71, 16384 + 2048
s_add_u32 s70, s68, 3178496
buffer_load_dwordx4 v105, s[64:67], s70 offen lds
s_add_u32 m0, s71, 16384 + 3072
s_add_u32 s70, s68, 3194880
buffer_load_dwordx4 v105, s[64:67], s70 offen lds
s_barrier
v_mov_b32 v122, 136
v_mov_b32 v123, 1
s_mov_b64 exec, s[12:13]
global_atomic_add v122, v123, s[8:9]
s_mov_b64 exec, -1
v_add_u32 v116, 65536, v110
v_add_u32 v117, 65536, v111
s_cmp_eq_u32 s21, 1
s_cbranch_scc1 L_lk1_1
s_cmp_eq_u32 s21, 2
s_cbranch_scc1 L_lk1_2
s_cmp_eq_u32 s21, 3
s_cbranch_scc1 L_lk1_3
ds_read_b64_tr_b16 a[144:145], v116 offset:0
ds_read_b64_tr_b16 a[146:147], v116 offset:1024
ds_read_b64_tr_b16 a[148:149], v116 offset:8192
ds_read_b64_tr_b16 a[150:151], v116 offset:9216
ds_read_b64_tr_b16 a[152:153], v117 offset:0
ds_read_b64_tr_b16 a[154:155], v117 offset:1024
ds_read_b64_tr_b16 a[156:157], v117 offset:8192
ds_read_b64_tr_b16 a[158:159], v117 offset:9216
s_branch L_lk1_e
L_lk1_1:
ds_read_b64_tr_b16 a[176:177], v116 offset:0
ds_read_b64_tr_b16 a[178:179], v116 offset:1024
ds_read_b64_tr_b16 a[180:181], v116 offset:8192
ds_read_b64_tr_b16 a[182:183], v116 offset:9216
ds_read_b64_tr_b16 a[184:185], v117 offset:0
ds_read_b64_tr_b16 a[186:187], v117 offset:1024
ds_read_b64_tr_b16 a[188:189], v117 offset:8192
ds_read_b64_tr_b16 a[190:191], v117 offset:9216
s_branch L_lk1_e
L_lk1_2:
ds_read_b64_tr_b16 a[208:209], v116 offset:0
ds_read_b64_tr_b16 a[210:211], v116 offset:1024
ds_read_b64_tr_b16 a[212:213], v116 offset:8192
ds_read_b64_tr_b16 a[214:215], v116 offset:9216
ds_read_b64_tr_b16 a[216:217], v117 offset:0
ds_read_b64_tr_b16 a[218:219], v117 offset:1024
ds_read_b64_tr_b16 a[220:221], v117 offset:8192
ds_read_b64_tr_b16 a[222:223], v117 offset:9216
s_branch L_lk1_e
L_lk1_3:
ds_read_b64_tr_b16 a[240:241], v116 offset:0
ds_read_b64_tr_b16 a[242:243], v116 offset:1024
ds_read_b64_tr_b16 a[244:245], v116 offset:8192
ds_read_b64_tr_b16 a[246:247], v116 offset:9216
ds_read_b64_tr_b16 a[248:249], v117 offset:0
ds_read_b64_tr_b16 a[250:251], v117 offset:1024
ds_read_b64_tr_b16 a[252:253], v117 offset:8192
ds_read_b64_tr_b16 a[254:255], v117 offset:9216
L_lk1_e:
s_waitcnt vmcnt(16) lgkmcnt(0)
s_barrier
s_add_u32 m0, s71, 65536 + 0
s_add_u32 s70, s68, 3670016
buffer_load_dwordx4 v104, s[64:67], s70 offen lds
s_add_u32 m0, s71, 65536 + 1024
s_add_u32 s70, s68, 3686400
buffer_load_dwordx4 v104, s[64:67], s70 offen lds
s_add_u32 m0, s71, 65536 + 2048
s_add_u32 s70, s68, 3702784
buffer_load_dwordx4 v105, s[64:67], s70 offen lds
s_add_u32 m0, s71, 65536 + 3072
s_add_u32 s70, s68, 3719168
buffer_load_dwordx4 v105, s[64:67], s70 offen lds
v_add_u32 v116, 98304, v110
v_add_u32 v117, 98304, v111
s_cmp_eq_u32 s21, 1
s_cbranch_scc1 L_lk2_1
s_cmp_eq_u32 s21, 2
s_cbranch_scc1 L_lk2_2
s_cmp_eq_u32 s21, 3
s_cbranch_scc1 L_lk2_3
ds_read_b64_tr_b16 a[160:161], v116 offset:0
ds_read_b64_tr_b16 a[162:163], v116 offset:1024
ds_read_b64_tr_b16 a[164:165], v116 offset:8192
ds_read_b64_tr_b16 a[166:167], v116 offset:9216
ds_read_b64_tr_b16 a[168:169], v117 offset:0
ds_read_b64_tr_b16 a[170:171], v117 offset:1024
ds_read_b64_tr_b16 a[172:173], v117 offset:8192
ds_read_b64_tr_b16 a[174:175], v117 offset:9216
s_branch L_lk2_e
L_lk2_1:
ds_read_b64_tr_b16 a[128:129], v116 offset:0
ds_read_b64_tr_b16 a[130:131], v116 offset:1024
ds_read_b64_tr_b16 a[132:133], v116 offset:8192
ds_read_b64_tr_b16 a[134:135], v116 offset:9216
ds_read_b64_tr_b16 a[136:137], v117 offset:0
ds_read_b64_tr_b16 a[138:139], v117 offset:1024
ds_read_b64_tr_b16 a[140:141], v117 offset:8192
ds_read_b64_tr_b16 a[142:143], v117 offset:9216
s_branch L_lk2_e
L_lk2_2:
ds_read_b64_tr_b16 a[224:225], v116 offset:0
ds_read_b64_tr_b16 a[226:227], v116 offset:1024
ds_read_b64_tr_b16 a[228:229], v116 offset:8192
ds_read_b64_tr_b16 a[230:231], v116 offset:9216
ds_read_b64_tr_b16 a[232:233], v117 offset:0
ds_read_b64_tr_b16 a[234:235], v117 offset:1024
ds_read_b64_tr_b16 a[236:237], v117 offset:8192
ds_read_b64_tr_b16 a[238:239], v117 offset:9216
s_branch L_lk2_e
L_lk2_3:
ds_read_b64_tr_b16 a[192:193], v116 offset:0
ds_read_b64_tr_b16 a[194:195], v116 offset:1024
ds_read_b64_tr_b16 a[196:197], v116 offset:8192
ds_read_b64_tr_b16 a[198:199], v116 offset:9216
ds_read_b64_tr_b16 a[200:201], v117 offset:0
ds_read_b64_tr_b16 a[202:203], v117 offset:1024
ds_read_b64_tr_b16 a[204:205], v117 offset:8192
ds_read_b64_tr_b16 a[206:207], v117 offset:9216
L_lk2_e:
s_waitcnt vmcnt(16) lgkmcnt(0)
s_barrier
s_add_u32 m0, s71, 98304 + 0
s_add_u32 s70, s69, 0
buffer_load_dwordx4 v106, s[88:91], s70 offen lds
s_add_u32 m0, s71, 98304 + 1024
s_add_u32 s70, s69, 1024
buffer_load_dwordx4 v107, s[88:91], s70 offen lds
s_add_u32 m0, s71, 98304 + 2048
s_add_u32 s70, s69, 2048
buffer_load_dwordx4 v106, s[88:91], s70 offen lds
s_add_u32 m0, s71, 98304 + 3072
s_add_u32 s70, s69, 3072
buffer_load_dwordx4 v107, s[88:91], s70 offen lds
v_add_u32 v116, 131072, v110
v_add_u32 v117, 131072, v111
s_cmp_eq_u32 s21, 1
s_cbranch_scc1 L_lk3_1
s_cmp_eq_u32 s21, 2
s_cbranch_scc1 L_lk3_2
s_cmp_eq_u32 s21, 3
s_cbranch_scc1 L_lk3_3
ds_read_b64_tr_b16 a[176:177], v116 offset:0
ds_read_b64_tr_b16 a[178:179], v116 offset:1024
ds_read_b64_tr_b16 a[180:181], v116 offset:8192
ds_read_b64_tr_b16 a[182:183], v116 offset:9216
ds_read_b64_tr_b16 a[184:185], v117 offset:0
ds_read_b64_tr_b16 a[186:187], v117 offset:1024
ds_read_b64_tr_b16 a[188:189], v117 offset:8192
ds_read_b64_tr_b16 a[190:191], v117 offset:9216
s_branch L_lk3_e
L_lk3_1:
ds_read_b64_tr_b16 a[144:145], v116 offset:0
ds_read_b64_tr_b16 a[146:147], v116 offset:1024
ds_read_b64_tr_b16 a[148:149], v116 offset:8192
ds_read_b64_tr_b16 a[150:151], v116 offset:9216
ds_read_b64_tr_b16 a[152:153], v117 offset:0
ds_read_b64_tr_b16 a[154:155], v117 offset:1024
ds_read_b64_tr_b16 a[156:157], v117 offset:8192
ds_read_b64_tr_b16 a[158:159], v117 offset:9216
s_branch L_lk3_e
L_lk3_2:
ds_read_b64_tr_b16 a[240:241], v116 offset:0
ds_read_b64_tr_b16 a[242:243], v116 offset:1024
ds_read_b64_tr_b16 a[244:245], v116 offset:8192
ds_read_b64_tr_b16 a[246:247], v116 offset:9216
ds_read_b64_tr_b16 a[248:249], v117 offset:0
ds_read_b64_tr_b16 a[250:251], v117 offset:1024
ds_read_b64_tr_b16 a[252:253], v117 offset:8192
ds_read_b64_tr_b16 a[254:255], v117 offset:9216
s_branch L_lk3_e
L_lk3_3:
ds_read_b64_tr_b16 a[208:209], v116 offset:0
ds_read_b64_tr_b16 a[210:211], v116 offset:1024
ds_read_b64_tr_b16 a[212:213], v116 offset:8192
ds_read_b64_tr_b16 a[214:215], v116 offset:9216
ds_read_b64_tr_b16 a[216:217], v117 offset:0
ds_read_b64_tr_b16 a[218:219], v117 offset:1024
ds_read_b64_tr_b16 a[220:221], v117 offset:8192
ds_read_b64_tr_b16 a[222:223], v117 offset:9216
L_lk3_e:
s_waitcnt vmcnt(16) lgkmcnt(0)
s_barrier
s_add_u32 m0, s71, 131072 + 0
s_add_u32 s70, s69, 8192
buffer_load_dwordx4 v106, s[88:91], s70 offen lds
s_add_u32 m0, s71, 131072 + 1024
s_add_u32 s70, s69, 9216
buffer_load_dwordx4 v107, s[88:91], s70 offen lds
s_add_u32 m0, s71, 131072 + 2048
s_add_u32 s70, s69, 10240
buffer_load_dwordx4 v106, s[88:91], s70 offen lds
s_add_u32 m0, s71, 131072 + 3072
s_add_u32 s70, s69, 11264
buffer_load_dwordx4 v107, s[88:91], s70 offen lds
v_add_u32 v116, 0, v110
v_add_u32 v117, 0, v111
s_cmp_eq_u32 s21, 1
s_cbranch_scc1 L_lk4_1
s_cmp_eq_u32 s21, 2
s_cbranch_scc1 L_lk4_2
s_cmp_eq_u32 s21, 3
s_cbranch_scc1 L_lk4_3
ds_read_b64_tr_b16 a[192:193], v116 offset:0
ds_read_b64_tr_b16 a[194:195], v116 offset:1024
ds_read_b64_tr_b16 a[196:197], v116 offset:8192
ds_read_b64_tr_b16 a[198:199], v116 offset:9216
ds_read_b64_tr_b16 a[200:201], v117 offset:0
ds_read_b64_tr_b16 a[202:203], v117 offset:1024
ds_read_b64_tr_b16 a[204:205], v117 offset:8192
ds_read_b64_tr_b16 a[206:207], v117 offset:9216
s_branch L_lk4_e
L_lk4_1:
ds_read_b64_tr_b16 a[224:225], v116 offset:0
ds_read_b64_tr_b16 a[226:227], v116 offset:1024
ds_read_b64_tr_b16 a[228:229], v116 offset:8192
ds_read_b64_tr_b16 a[230:231], v116 offset:9216
ds_read_b64_tr_b16 a[232:233], v117 offset:0
ds_read_b64_tr_b16 a[234:235], v117 offset:1024
ds_read_b64_tr_b16 a[236:237], v117 offset:8192
ds_read_b64_tr_b16 a[238:239], v117 offset:9216
s_branch L_lk4_e
L_lk4_2:
ds_read_b64_tr_b16 a[128:129], v116 offset:0
ds_read_b64_tr_b16 a[130:131], v116 offset:1024
ds_read_b64_tr_b16 a[132:133], v116 offset:8192
ds_read_b64_tr_b16 a[134:135], v116 offset:9216
ds_read_b64_tr_b16 a[136:137], v117 offset:0
ds_read_b64_tr_b16 a[138:139], v117 offset:1024
ds_read_b64_tr_b16 a[140:141], v117 offset:8192
ds_read_b64_tr_b16 a[142:143], v117 offset:9216
s_branch L_lk4_e
L_lk4_3:
ds_read_b64_tr_b16 a[160:161], v116 offset:0
ds_read_b64_tr_b16 a[162:163], v116 offset:1024
ds_read_b64_tr_b16 a[164:165], v116 offset:8192
ds_read_b64_tr_b16 a[166:167], v116 offset:9216
ds_read_b64_tr_b16 a[168:169], v117 offset:0
ds_read_b64_tr_b16 a[170:171], v117 offset:1024
ds_read_b64_tr_b16 a[172:173], v117 offset:8192
ds_read_b64_tr_b16 a[174:175], v117 offset:9216
L_lk4_e:
s_waitcnt vmcnt(16) lgkmcnt(0)
s_barrier
s_add_u32 m0, s71, 0 + 0
s_add_u32 s70, s69, 32768
buffer_load_dwordx4 v106, s[88:91], s70 offen lds
s_add_u32 m0, s71, 0 + 1024
s_add_u32 s70, s69, 33792
buffer_load_dwordx4 v107, s[88:91], s70 offen lds
s_add_u32 m0, s71, 0 + 2048
s_add_u32 s70, s69, 34816
buffer_load_dwordx4 v106, s[88:91], s70 offen lds
s_add_u32 m0, s71, 0 + 3072
s_add_u32 s70, s69, 35840
buffer_load_dwordx4 v107, s[88:91], s70 offen lds
v_add_u32 v116, 32768, v110
v_add_u32 v117, 32768, v111
s_cmp_eq_u32 s21, 1
s_cbranch_scc1 L_lk5_1
s_cmp_eq_u32 s21, 2
s_cbranch_scc1 L_lk5_2
s_cmp_eq_u32 s21, 3
s_cbranch_scc1 L_lk5_3
ds_read_b64_tr_b16 a[208:209], v116 offset:0
ds_read_b64_tr_b16 a[210:211], v116 offset:1024
ds_read_b64_tr_b16 a[212:213], v116 offset:8192
ds_read_b64_tr_b16 a[214:215], v116 offset:9216
ds_read_b64_tr_b16 a[216:217], v117 offset:0
ds_read_b64_tr_b16 a[218:219], v117 offset:1024
ds_read_b64_tr_b16 a[220:221], v117 offset:8192
ds_read_b64_tr_b16 a[222:223], v117 offset:9216
s_branch L_lk5_e
L_lk5_1:
ds_read_b64_tr_b16 a[240:241], v116 offset:0
ds_read_b64_tr_b16 a[242:243], v116 offset:1024
ds_read_b64_tr_b16 a[244:245], v116 offset:8192
ds_read_b64_tr_b16 a[246:247], v116 offset:9216
ds_read_b64_tr_b16 a[248:249], v117 offset:0
ds_read_b64_tr_b16 a[250:251], v117 offset:1024
ds_read_b64_tr_b16 a[252:253], v117 offset:8192
ds_read_b64_tr_b16 a[254:255], v117 offset:9216
s_branch L_lk5_e
L_lk5_2:
ds_read_b64_tr_b16 a[144:145], v116 offset:0
ds_read_b64_tr_b16 a[146:147], v116 offset:1024
ds_read_b64_tr_b16 a[148:149], v116 offset:8192
ds_read_b64_tr_b16 a[150:151], v116 offset:9216
ds_read_b64_tr_b16 a[152:153], v117 offset:0
ds_read_b64_tr_b16 a[154:155], v117 offset:1024
ds_read_b64_tr_b16 a[156:157], v117 offset:8192
ds_read_b64_tr_b16 a[158:159], v117 offset:9216
s_branch L_lk5_e
L_lk5_3:
ds_read_b64_tr_b16 a[176:177], v116 offset:0
ds_read_b64_tr_b16 a[178:179], v116 offset:1024
ds_read_b64_tr_b16 a[180:181], v116 offset:8192
ds_read_b64_tr_b16 a[182:183], v116 offset:9216
ds_read_b64_tr_b16 a[184:185], v117 offset:0
ds_read_b64_tr_b16 a[186:187], v117 offset:1024
ds_read_b64_tr_b16 a[188:189], v117 offset:8192
ds_read_b64_tr_b16 a[190:191], v117 offset:9216
L_lk5_e:
s_waitcnt vmcnt(16) lgkmcnt(0)
s_barrier
s_add_u32 m0, s71, 32768 + 0
s_add_u32 s70, s69, 40960
buffer_load_dwordx4 v106, s[88:91], s70 offen lds
s_add_u32 m0, s71, 32768 + 1024
s_add_u32 s70, s69, 41984
buffer_load_dwordx4 v107, s[88:91], s70 offen lds
s_add_u32 m0, s71, 32768 + 2048
s_add_u32 s70, s69, 43008
buffer_load_dwordx4 v106, s[88:91], s70 offen lds
s_add_u32 m0, s71, 32768 + 3072
s_add_u32 s70, s69, 44032
buffer_load_dwordx4 v107, s[88:91], s70 offen lds
v_add_u32 v116, 16384, v110
v_add_u32 v117, 16384, v111
s_cmp_eq_u32 s21, 1
s_cbranch_scc1 L_lk6_1
s_cmp_eq_u32 s21, 2
s_cbranch_scc1 L_lk6_2
s_cmp_eq_u32 s21, 3
s_cbranch_scc1 L_lk6_3
ds_read_b64_tr_b16 a[224:225], v116 offset:0
ds_read_b64_tr_b16 a[226:227], v116 offset:1024
ds_read_b64_tr_b16 a[228:229], v116 offset:8192
ds_read_b64_tr_b16 a[230:231], v116 offset:9216
ds_read_b64_tr_b16 a[232:233], v117 offset:0
ds_read_b64_tr_b16 a[234:235], v117 offset:1024
ds_read_b64_tr_b16 a[236:237], v117 offset:8192
ds_read_b64_tr_b16 a[238:239], v117 offset:9216
s_branch L_lk6_e
L_lk6_1:
ds_read_b64_tr_b16 a[192:193], v116 offset:0
ds_read_b64_tr_b16 a[194:195], v116 offset:1024
ds_read_b64_tr_b16 a[196:197], v116 offset:8192
ds_read_b64_tr_b16 a[198:199], v116 offset:9216
ds_read_b64_tr_b16 a[200:201], v117 offset:0
ds_read_b64_tr_b16 a[202:203], v117 offset:1024
ds_read_b64_tr_b16 a[204:205], v117 offset:8192
ds_read_b64_tr_b16 a[206:207], v117 offset:9216
s_branch L_lk6_e
L_lk6_2:
ds_read_b64_tr_b16 a[160:161], v116 offset:0
ds_read_b64_tr_b16 a[162:163], v116 offset:1024
ds_read_b64_tr_b16 a[164:165], v116 offset:8192
ds_read_b64_tr_b16 a[166:167], v116 offset:9216
ds_read_b64_tr_b16 a[168:169], v117 offset:0
ds_read_b64_tr_b16 a[170:171], v117 offset:1024
ds_read_b64_tr_b16 a[172:173], v117 offset:8192
ds_read_b64_tr_b16 a[174:175], v117 offset:9216
s_branch L_lk6_e
L_lk6_3:
ds_read_b64_tr_b16 a[128:129], v116 offset:0
ds_read_b64_tr_b16 a[130:131], v116 offset:1024
ds_read_b64_tr_b16 a[132:133], v116 offset:8192
ds_read_b64_tr_b16 a[134:135], v116 offset:9216
ds_read_b64_tr_b16 a[136:137], v117 offset:0
ds_read_b64_tr_b16 a[138:139], v117 offset:1024
ds_read_b64_tr_b16 a[140:141], v117 offset:8192
ds_read_b64_tr_b16 a[142:143], v117 offset:9216
L_lk6_e:
s_waitcnt vmcnt(16) lgkmcnt(0)
s_barrier
s_add_u32 m0, s71, 16384 + 0
s_add_u32 s70, s69, 65536
buffer_load_dwordx4 v106, s[88:91], s70 offen lds
s_add_u32 m0, s71, 16384 + 1024
s_add_u32 s70, s69, 66560
buffer_load_dwordx4 v107, s[88:91], s70 offen lds
s_add_u32 m0, s71, 16384 + 2048
s_add_u32 s70, s69, 67584
buffer_load_dwordx4 v106, s[88:91], s70 offen lds
s_add_u32 m0, s71, 16384 + 3072
s_add_u32 s70, s69, 68608
buffer_load_dwordx4 v107, s[88:91], s70 offen lds
v_add_u32 v116, 65536, v110
v_add_u32 v117, 65536, v111
s_cmp_eq_u32 s21, 1
s_cbranch_scc1 L_lk7_1
s_cmp_eq_u32 s21, 2
s_cbranch_scc1 L_lk7_2
s_cmp_eq_u32 s21, 3
s_cbranch_scc1 L_lk7_3
ds_read_b64_tr_b16 a[240:241], v116 offset:0
ds_read_b64_tr_b16 a[242:243], v116 offset:1024
ds_read_b64_tr_b16 a[244:245], v116 offset:8192
ds_read_b64_tr_b16 a[246:247], v116 offset:9216
ds_read_b64_tr_b16 a[248:249], v117 offset:0
ds_read_b64_tr_b16 a[250:251], v117 offset:1024
ds_read_b64_tr_b16 a[252:253], v117 offset:8192
ds_read_b64_tr_b16 a[254:255], v117 offset:9216
s_branch L_lk7_e
L_lk7_1:
ds_read_b64_tr_b16 a[208:209], v116 offset:0
ds_read_b64_tr_b16 a[210:211], v116 offset:1024
ds_read_b64_tr_b16 a[212:213], v116 offset:8192
ds_read_b64_tr_b16 a[214:215], v116 offset:9216
ds_read_b64_tr_b16 a[216:217], v117 offset:0
ds_read_b64_tr_b16 a[218:219], v117 offset:1024
ds_read_b64_tr_b16 a[220:221], v117 offset:8192
ds_read_b64_tr_b16 a[222:223], v117 offset:9216
s_branch L_lk7_e
L_lk7_2:
ds_read_b64_tr_b16 a[176:177], v116 offset:0
ds_read_b64_tr_b16 a[178:179], v116 offset:1024
ds_read_b64_tr_b16 a[180:181], v116 offset:8192
ds_read_b64_tr_b16 a[182:183], v116 offset:9216
ds_read_b64_tr_b16 a[184:185], v117 offset:0
ds_read_b64_tr_b16 a[186:187], v117 offset:1024
ds_read_b64_tr_b16 a[188:189], v117 offset:8192
ds_read_b64_tr_b16 a[190:191], v117 offset:9216
s_branch L_lk7_e
L_lk7_3:
ds_read_b64_tr_b16 a[144:145], v116 offset:0
ds_read_b64_tr_b16 a[146:147], v116 offset:1024
ds_read_b64_tr_b16 a[148:149], v116 offset:8192
ds_read_b64_tr_b16 a[150:151], v116 offset:9216
ds_read_b64_tr_b16 a[152:153], v117 offset:0
ds_read_b64_tr_b16 a[154:155], v117 offset:1024
ds_read_b64_tr_b16 a[156:157], v117 offset:8192
ds_read_b64_tr_b16 a[158:159], v117 offset:9216
L_lk7_e:
s_waitcnt vmcnt(16) lgkmcnt(0)
s_barrier
s_add_u32 m0, s71, 65536 + 0
s_add_u32 s70, s69, 73728
buffer_load_dwordx4 v106, s[88:91], s70 offen lds
s_add_u32 m0, s71, 65536 + 1024
s_add_u32 s70, s69, 74752
buffer_load_dwordx4 v107, s[88:91], s70 offen lds
s_add_u32 m0, s71, 65536 + 2048
s_add_u32 s70, s69, 75776
buffer_load_dwordx4 v106, s[88:91], s70 offen lds
s_add_u32 m0, s71, 65536 + 3072
s_add_u32 s70, s69, 76800
buffer_load_dwordx4 v107, s[88:91], s70 offen lds
v_add_u32 v116, 98304, v112
v_add_u32 v117, 98304, v113
v_add_u32 v118, 98304, v114
v_add_u32 v119, 98304, v115
s_cmp_eq_u32 s21, 1
s_cbranch_scc1 L_lo00_1
s_cmp_eq_u32 s21, 2
s_cbranch_scc1 L_lo00_2
s_cmp_eq_u32 s21, 3
s_cbranch_scc1 L_lo00_3
ds_read_b64_tr_b16 v[224:225], v116 offset:0
ds_read_b64_tr_b16 v[226:227], v116 offset:2048
ds_read_b64_tr_b16 v[232:233], v117 offset:0
ds_read_b64_tr_b16 v[234:235], v117 offset:2048
ds_read_b64_tr_b16 v[240:241], v118 offset:0
ds_read_b64_tr_b16 v[242:243], v118 offset:2048
ds_read_b64_tr_b16 v[248:249], v119 offset:0
ds_read_b64_tr_b16 v[250:251], v119 offset:2048
s_branch L_lo00_e
L_lo00_1:
ds_read_b64_tr_b16 v[40:41], v116 offset:0
ds_read_b64_tr_b16 v[42:43], v116 offset:2048
ds_read_b64_tr_b16 v[48:49], v117 offset:0
ds_read_b64_tr_b16 v[50:51], v117 offset:2048
ds_read_b64_tr_b16 v[56:57], v118 offset:0
ds_read_b64_tr_b16 v[58:59], v118 offset:2048
ds_read_b64_tr_b16 v[64:65], v119 offset:0
ds_read_b64_tr_b16 v[66:67], v119 offset:2048
s_branch L_lo00_e
L_lo00_2:
ds_read_b64_tr_b16 v[40:41], v116 offset:0
ds_read_b64_tr_b16 v[42:43], v116 offset:2048
ds_read_b64_tr_b16 v[48:49], v117 offset:0
ds_read_b64_tr_b16 v[50:51], v117 offset:2048
ds_read_b64_tr_b16 v[56:57], v118 offset:0
ds_read_b64_tr_b16 v[58:59], v118 offset:2048
ds_read_b64_tr_b16 v[64:65], v119 offset:0
ds_read_b64_tr_b16 v[66:67], v119 offset:2048
s_branch L_lo00_e
L_lo00_3:
ds_read_b64_tr_b16 v[72:73], v116 offset:0
ds_read_b64_tr_b16 v[74:75], v116 offset:2048
ds_read_b64_tr_b16 v[80:81], v117 offset:0
ds_read_b64_tr_b16 v[82:83], v117 offset:2048
ds_read_b64_tr_b16 v[88:89], v118 offset:0
ds_read_b64_tr_b16 v[90:91], v118 offset:2048
ds_read_b64_tr_b16 v[96:97], v119 offset:0
ds_read_b64_tr_b16 v[98:99], v119 offset:2048
L_lo00_e:
s_waitcnt vmcnt(16) lgkmcnt(0)
s_barrier
s_add_u32 m0, s71, 98304 + 0
s_add_u32 s70, s69, 98304
buffer_load_dwordx4 v106, s[88:91], s70 offen lds
s_add_u32 m0, s71, 98304 + 1024
s_add_u32 s70, s69, 99328
buffer_load_dwordx4 v107, s[88:91], s70 offen lds
s_add_u32 m0, s71, 98304 + 2048
s_add_u32 s70, s69, 100352
buffer_load_dwordx4 v106, s[88:91], s70 offen lds
s_add_u32 m0, s71, 98304 + 3072
s_add_u32 s70, s69, 101376
buffer_load_dwordx4 v107, s[88:91], s70 offen lds
v_mov_b32 v127, 0
global_load_dword v125, v127, s[8:9] offset:192 sc1
v_add_u32 v116, 131072, v112
v_add_u32 v117, 131072, v113
v_add_u32 v118, 131072, v114
v_add_u32 v119, 131072, v115
s_cmp_eq_u32 s21, 1
s_cbranch_scc1 L_lo01_1
s_cmp_eq_u32 s21, 2
s_cbranch_scc1 L_lo01_2
s_cmp_eq_u32 s21, 3
s_cbranch_scc1 L_lo01_3
ds_read_b64_tr_b16 v[228:229], v116 offset:0
ds_read_b64_tr_b16 v[230:231], v116 offset:2048
ds_read_b64_tr_b16 v[236:237], v117 offset:0
ds_read_b64_tr_b16 v[238:239], v117 offset:2048
ds_read_b64_tr_b16 v[244:245], v118 offset:0
ds_read_b64_tr_b16 v[246:247], v118 offset:2048
ds_read_b64_tr_b16 v[252:253], v119 offset:0
ds_read_b64_tr_b16 v[254:255], v119 offset:2048
s_branch L_lo01_e
L_lo01_1:
ds_read_b64_tr_b16 v[44:45], v116 offset:0
ds_read_b64_tr_b16 v[46:47], v116 offset:2048
ds_read_b64_tr_b16 v[52:53], v117 offset:0
ds_read_b64_tr_b16 v[54:55], v117 offset:2048
ds_read_b64_tr_b16 v[60:61], v118 offset:0
ds_read_b64_tr_b16 v[62:63], v118 offset:2048
ds_read_b64_tr_b16 v[68:69], v119 offset:0
ds_read_b64_tr_b16 v[70:71], v119 offset:2048
s_branch L_lo01_e
L_lo01_2:
ds_read_b64_tr_b16 v[44:45], v116 offset:0
ds_read_b64_tr_b16 v[46:47], v116 offset:2048
ds_read_b64_tr_b16 v[52:53], v117 offset:0
ds_read_b64_tr_b16 v[54:55], v117 offset:2048
ds_read_b64_tr_b16 v[60:61], v118 offset:0
ds_read_b64_tr_b16 v[62:63], v118 offset:2048
ds_read_b64_tr_b16 v[68:69], v119 offset:0
ds_read_b64_tr_b16 v[70:71], v119 offset:2048
s_branch L_lo01_e
L_lo01_3:
ds_read_b64_tr_b16 v[76:77], v116 offset:0
ds_read_b64_tr_b16 v[78:79], v116 offset:2048
ds_read_b64_tr_b16 v[84:85], v117 offset:0
ds_read_b64_tr_b16 v[86:87], v117 offset:2048
ds_read_b64_tr_b16 v[92:93], v118 offset:0
ds_read_b64_tr_b16 v[94:95], v118 offset:2048
ds_read_b64_tr_b16 v[100:101], v119 offset:0
ds_read_b64_tr_b16 v[102:103], v119 offset:2048
L_lo01_e:
s_waitcnt vmcnt(16) lgkmcnt(0)
s_barrier
s_add_u32 m0, s71, 131072 + 0
s_add_u32 s70, s69, 106496
buffer_load_dwordx4 v106, s[88:91], s70 offen lds
s_add_u32 m0, s71, 131072 + 1024
s_add_u32 s70, s69, 107520
buffer_load_dwordx4 v107, s[88:91], s70 offen lds
s_add_u32 m0, s71, 131072 + 2048
s_add_u32 s70, s69, 108544
buffer_load_dwordx4 v106, s[88:91], s70 offen lds
s_add_u32 m0, s71, 131072 + 3072
s_add_u32 s70, s69, 109568
buffer_load_dwordx4 v107, s[88:91], s70 offen lds
s_cmp_eq_u32 s21, 1
s_cbranch_scc1 L_po0_1
s_cmp_eq_u32 s21, 2
s_cbranch_scc1 L_po0_2
s_cmp_eq_u32 s21, 3
s_cbranch_scc1 L_po0_3
s_branch L_po0_e
L_po0_1:
ds_write_b128 v12, v[40:43] offset:16384
ds_write_b128 v12, v[44:47] offset:17408
ds_write_b128 v12, v[48:51] offset:18432
ds_write_b128 v12, v[52:55] offset:19456
ds_write_b128 v12, v[56:59] offset:20480
ds_write_b128 v12, v[60:63] offset:21504
ds_write_b128 v12, v[64:67] offset:22528
ds_write_b128 v12, v[68:71] offset:23552
s_waitcnt lgkmcnt(0)
s_branch L_po0_e
L_po0_2:
ds_write_b128 v12, v[40:43] offset:24576
ds_write_b128 v12, v[44:47] offset:25600
ds_write_b128 v12, v[48:51] offset:26624
ds_write_b128 v12, v[52:55] offset:27648
ds_write_b128 v12, v[56:59] offset:28672
ds_write_b128 v12, v[60:63] offset:29696
ds_write_b128 v12, v[64:67] offset:30720
ds_write_b128 v12, v[68:71] offset:31744
s_waitcnt lgkmcnt(0)
s_branch L_po0_e
L_po0_3:
L_po0_e:
v_add_u32 v116, 0, v112
v_add_u32 v117, 0, v113
v_add_u32 v118, 0, v114
v_add_u32 v119, 0, v115
s_cmp_eq_u32 s21, 1
s_cbranch_scc1 L_lo10_1
s_cmp_eq_u32 s21, 2
s_cbranch_scc1 L_lo10_2
s_cmp_eq_u32 s21, 3
s_cbranch_scc1 L_lo10_3
ds_read_b64_tr_b16 v[40:41], v116 offset:0
ds_read_b64_tr_b16 v[42:43], v116 offset:2048
ds_read_b64_tr_b16 v[48:49], v117 offset:0
ds_read_b64_tr_b16 v[50:51], v117 offset:2048
ds_read_b64_tr_b16 v[56:57], v118 offset:0
ds_read_b64_tr_b16 v[58:59], v118 offset:2048
ds_read_b64_tr_b16 v[64:65], v119 offset:0
ds_read_b64_tr_b16 v[66:67], v119 offset:2048
s_branch L_lo10_e
L_lo10_1:
ds_read_b64_tr_b16 v[224:225], v116 offset:0
ds_read_b64_tr_b16 v[226:227], v116 offset:2048
ds_read_b64_tr_b16 v[232:233], v117 offset:0
ds_read_b64_tr_b16 v[234:235], v117 offset:2048
ds_read_b64_tr_b16 v[240:241], v118 offset:0
ds_read_b64_tr_b16 v[242:243], v118 offset:2048
ds_read_b64_tr_b16 v[248:249], v119 offset:0
ds_read_b64_tr_b16 v[250:251], v119 offset:2048
s_branch L_lo10_e
L_lo10_2:
ds_read_b64_tr_b16 v[72:73], v116 offset:0
ds_read_b64_tr_b16 v[74:75], v116 offset:2048
ds_read_b64_tr_b16 v[80:81], v117 offset:0
ds_read_b64_tr_b16 v[82:83], v117 offset:2048
ds_read_b64_tr_b16 v[88:89], v118 offset:0
ds_read_b64_tr_b16 v[90:91], v118 offset:2048
ds_read_b64_tr_b16 v[96:97], v119 offset:0
ds_read_b64_tr_b16 v[98:99], v119 offset:2048
s_branch L_lo10_e
L_lo10_3:
ds_read_b64_tr_b16 v[40:41], v116 offset:0
ds_read_b64_tr_b16 v[42:43], v116 offset:2048
ds_read_b64_tr_b16 v[48:49], v117 offset:0
ds_read_b64_tr_b16 v[50:51], v117 offset:2048
ds_read_b64_tr_b16 v[56:57], v118 offset:0
ds_read_b64_tr_b16 v[58:59], v118 offset:2048
ds_read_b64_tr_b16 v[64:65], v119 offset:0
ds_read_b64_tr_b16 v[66:67], v119 offset:2048
L_lo10_e:
s_waitcnt vmcnt(16) lgkmcnt(0)
s_barrier
s_add_u32 m0, s71, 0 + 0
s_add_u32 s70, s68, 0
buffer_load_dwordx4 v104, s[84:87], s70 offen lds
s_add_u32 m0, s71, 0 + 1024
s_add_u32 s70, s68, 16384
buffer_load_dwordx4 v104, s[84:87], s70 offen lds
s_add_u32 m0, s71, 0 + 2048
s_add_u32 s70, s68, 32768
buffer_load_dwordx4 v105, s[84:87], s70 offen lds
s_add_u32 m0, s71, 0 + 3072
s_add_u32 s70, s68, 49152
buffer_load_dwordx4 v105, s[84:87], s70 offen lds
v_add_u32 v116, 32768, v112
v_add_u32 v117, 32768, v113
v_add_u32 v118, 32768, v114
v_add_u32 v119, 32768, v115
s_cmp_eq_u32 s21, 1
s_cbranch_scc1 L_lo11_1
s_cmp_eq_u32 s21, 2
s_cbranch_scc1 L_lo11_2
s_cmp_eq_u32 s21, 3
s_cbranch_scc1 L_lo11_3
ds_read_b64_tr_b16 v[44:45], v116 offset:0
ds_read_b64_tr_b16 v[46:47], v116 offset:2048
ds_read_b64_tr_b16 v[52:53], v117 offset:0
ds_read_b64_tr_b16 v[54:55], v117 offset:2048
ds_read_b64_tr_b16 v[60:61], v118 offset:0
ds_read_b64_tr_b16 v[62:63], v118 offset:2048
ds_read_b64_tr_b16 v[68:69], v119 offset:0
ds_read_b64_tr_b16 v[70:71], v119 offset:2048
s_branch L_lo11_e
L_lo11_1:
ds_read_b64_tr_b16 v[228:229], v116 offset:0
ds_read_b64_tr_b16 v[230:231], v116 offset:2048
ds_read_b64_tr_b16 v[236:237], v117 offset:0
ds_read_b64_tr_b16 v[238:239], v117 offset:2048
ds_read_b64_tr_b16 v[244:245], v118 offset:0
ds_read_b64_tr_b16 v[246:247], v118 offset:2048
ds_read_b64_tr_b16 v[252:253], v119 offset:0
ds_read_b64_tr_b16 v[254:255], v119 offset:2048
s_branch L_lo11_e
L_lo11_2:
ds_read_b64_tr_b16 v[76:77], v116 offset:0
ds_read_b64_tr_b16 v[78:79], v116 offset:2048
ds_read_b64_tr_b16 v[84:85], v117 offset:0
ds_read_b64_tr_b16 v[86:87], v117 offset:2048
ds_read_b64_tr_b16 v[92:93], v118 offset:0
ds_read_b64_tr_b16 v[94:95], v118 offset:2048
ds_read_b64_tr_b16 v[100:101], v119 offset:0
ds_read_b64_tr_b16 v[102:103], v119 offset:2048
s_branch L_lo11_e
L_lo11_3:
ds_read_b64_tr_b16 v[44:45], v116 offset:0
ds_read_b64_tr_b16 v[46:47], v116 offset:2048
ds_read_b64_tr_b16 v[52:53], v117 offset:0
ds_read_b64_tr_b16 v[54:55], v117 offset:2048
ds_read_b64_tr_b16 v[60:61], v118 offset:0
ds_read_b64_tr_b16 v[62:63], v118 offset:2048
ds_read_b64_tr_b16 v[68:69], v119 offset:0
ds_read_b64_tr_b16 v[70:71], v119 offset:2048
L_lo11_e:
s_waitcnt vmcnt(16) lgkmcnt(0)
s_barrier
s_add_u32 m0, s71, 32768 + 0
s_add_u32 s70, s68, 524288
buffer_load_dwordx4 v104, s[84:87], s70 offen lds
s_add_u32 m0, s71, 32768 + 1024
s_add_u32 s70, s68, 540672
buffer_load_dwordx4 v104, s[84:87], s70 offen lds
s_add_u32 m0, s71, 32768 + 2048
s_add_u32 s70, s68, 557056
buffer_load_dwordx4 v105, s[84:87], s70 offen lds
s_add_u32 m0, s71, 32768 + 3072
s_add_u32 s70, s68, 573440
buffer_load_dwordx4 v105, s[84:87], s70 offen lds
s_cmp_eq_u32 s21, 1
s_cbranch_scc1 L_po1_1
s_cmp_eq_u32 s21, 2
s_cbranch_scc1 L_po1_2
s_cmp_eq_u32 s21, 3
s_cbranch_scc1 L_po1_3
ds_write_b128 v12, v[40:43] offset:16384
ds_write_b128 v12, v[44:47] offset:17408
ds_write_b128 v12, v[48:51] offset:18432
ds_write_b128 v12, v[52:55] offset:19456
ds_write_b128 v12, v[56:59] offset:20480
ds_write_b128 v12, v[60:63] offset:21504
ds_write_b128 v12, v[64:67] offset:22528
ds_write_b128 v12, v[68:71] offset:23552
s_waitcnt lgkmcnt(0)
s_branch L_po1_e
L_po1_1:
s_branch L_po1_e
L_po1_2:
s_branch L_po1_e
L_po1_3:
ds_write_b128 v12, v[40:43] offset:24576
ds_write_b128 v12, v[44:47] offset:25600
ds_write_b128 v12, v[48:51] offset:26624
ds_write_b128 v12, v[52:55] offset:27648
ds_write_b128 v12, v[56:59] offset:28672
ds_write_b128 v12, v[60:63] offset:29696
ds_write_b128 v12, v[64:67] offset:30720
ds_write_b128 v12, v[68:71] offset:31744
s_waitcnt lgkmcnt(0)
L_po1_e:
v_add_u32 v116, 16384, v112
v_add_u32 v117, 16384, v113
v_add_u32 v118, 16384, v114
v_add_u32 v119, 16384, v115
s_cmp_eq_u32 s21, 1
s_cbranch_scc1 L_lo20_1
s_cmp_eq_u32 s21, 2
s_cbranch_scc1 L_lo20_2
s_cmp_eq_u32 s21, 3
s_cbranch_scc1 L_lo20_3
ds_read_b64_tr_b16 v[40:41], v116 offset:0
ds_read_b64_tr_b16 v[42:43], v116 offset:2048
ds_read_b64_tr_b16 v[48:49], v117 offset:0
ds_read_b64_tr_b16 v[50:51], v117 offset:2048
ds_read_b64_tr_b16 v[56:57], v118 offset:0
ds_read_b64_tr_b16 v[58:59], v118 offset:2048
ds_read_b64_tr_b16 v[64:65], v119 offset:0
ds_read_b64_tr_b16 v[66:67], v119 offset:2048
s_branch L_lo20_e
L_lo20_1:
ds_read_b64_tr_b16 v[72:73], v116 offset:0
ds_read_b64_tr_b16 v[74:75], v116 offset:2048
ds_read_b64_tr_b16 v[80:81], v117 offset:0
ds_read_b64_tr_b16 v[82:83], v117 offset:2048
ds_read_b64_tr_b16 v[88:89], v118 offset:0
ds_read_b64_tr_b16 v[90:91], v118 offset:2048
ds_read_b64_tr_b16 v[96:97], v119 offset:0
ds_read_b64_tr_b16 v[98:99], v119 offset:2048
s_branch L_lo20_e
L_lo20_2:
ds_read_b64_tr_b16 v[224:225], v116 offset:0
ds_read_b64_tr_b16 v[226:227], v116 offset:2048
ds_read_b64_tr_b16 v[232:233], v117 offset:0
ds_read_b64_tr_b16 v[234:235], v117 offset:2048
ds_read_b64_tr_b16 v[240:241], v118 offset:0
ds_read_b64_tr_b16 v[242:243], v118 offset:2048
ds_read_b64_tr_b16 v[248:249], v119 offset:0
ds_read_b64_tr_b16 v[250:251], v119 offset:2048
s_branch L_lo20_e
L_lo20_3:
ds_read_b64_tr_b16 v[40:41], v116 offset:0
ds_read_b64_tr_b16 v[42:43], v116 offset:2048
ds_read_b64_tr_b16 v[48:49], v117 offset:0
ds_read_b64_tr_b16 v[50:51], v117 offset:2048
ds_read_b64_tr_b16 v[56:57], v118 offset:0
ds_read_b64_tr_b16 v[58:59], v118 offset:2048
ds_read_b64_tr_b16 v[64:65], v119 offset:0
ds_read_b64_tr_b16 v[66:67], v119 offset:2048
L_lo20_e:
s_waitcnt vmcnt(16) lgkmcnt(0)
s_barrier
s_add_u32 m0, s71, 16384 + 0
s_add_u32 s70, s68, 1048576
buffer_load_dwordx4 v104, s[84:87], s70 offen lds
s_add_u32 m0, s71, 16384 + 1024
s_add_u32 s70, s68, 1064960
buffer_load_dwordx4 v104, s[84:87], s70 offen lds
s_add_u32 m0, s71, 16384 + 2048
s_add_u32 s70, s68, 1081344
buffer_load_dwordx4 v105, s[84:87], s70 offen lds
s_add_u32 m0, s71, 16384 + 3072
s_add_u32 s70, s68, 1097728
buffer_load_dwordx4 v105, s[84:87], s70 offen lds
v_add_u32 v116, 65536, v112
v_add_u32 v117, 65536, v113
v_add_u32 v118, 65536, v114
v_add_u32 v119, 65536, v115
s_cmp_eq_u32 s21, 1
s_cbranch_scc1 L_lo21_1
s_cmp_eq_u32 s21, 2
s_cbranch_scc1 L_lo21_2
s_cmp_eq_u32 s21, 3
s_cbranch_scc1 L_lo21_3
ds_read_b64_tr_b16 v[44:45], v116 offset:0
ds_read_b64_tr_b16 v[46:47], v116 offset:2048
ds_read_b64_tr_b16 v[52:53], v117 offset:0
ds_read_b64_tr_b16 v[54:55], v117 offset:2048
ds_read_b64_tr_b16 v[60:61], v118 offset:0
ds_read_b64_tr_b16 v[62:63], v118 offset:2048
ds_read_b64_tr_b16 v[68:69], v119 offset:0
ds_read_b64_tr_b16 v[70:71], v119 offset:2048
s_branch L_lo21_e
L_lo21_1:
ds_read_b64_tr_b16 v[76:77], v116 offset:0
ds_read_b64_tr_b16 v[78:79], v116 offset:2048
ds_read_b64_tr_b16 v[84:85], v117 offset:0
ds_read_b64_tr_b16 v[86:87], v117 offset:2048
ds_read_b64_tr_b16 v[92:93], v118 offset:0
ds_read_b64_tr_b16 v[94:95], v118 offset:2048
ds_read_b64_tr_b16 v[100:101], v119 offset:0
ds_read_b64_tr_b16 v[102:103], v119 offset:2048
s_branch L_lo21_e
L_lo21_2:
ds_read_b64_tr_b16 v[228:229], v116 offset:0
ds_read_b64_tr_b16 v[230:231], v116 offset:2048
ds_read_b64_tr_b16 v[236:237], v117 offset:0
ds_read_b64_tr_b16 v[238:239], v117 offset:2048
ds_read_b64_tr_b16 v[244:245], v118 offset:0
ds_read_b64_tr_b16 v[246:247], v118 offset:2048
ds_read_b64_tr_b16 v[252:253], v119 offset:0
ds_read_b64_tr_b16 v[254:255], v119 offset:2048
s_branch L_lo21_e
L_lo21_3:
ds_read_b64_tr_b16 v[44:45], v116 offset:0
ds_read_b64_tr_b16 v[46:47], v116 offset:2048
ds_read_b64_tr_b16 v[52:53], v117 offset:0
ds_read_b64_tr_b16 v[54:55], v117 offset:2048
ds_read_b64_tr_b16 v[60:61], v118 offset:0
ds_read_b64_tr_b16 v[62:63], v118 offset:2048
ds_read_b64_tr_b16 v[68:69], v119 offset:0
ds_read_b64_tr_b16 v[70:71], v119 offset:2048
L_lo21_e:
s_waitcnt vmcnt(16) lgkmcnt(0)
s_barrier
s_add_u32 m0, s71, 65536 + 0
s_add_u32 s70, s68, 1572864
buffer_load_dwordx4 v104, s[84:87], s70 offen lds
s_add_u32 m0, s71, 65536 + 1024
s_add_u32 s70, s68, 1589248
buffer_load_dwordx4 v104, s[84:87], s70 offen lds
s_add_u32 m0, s71, 65536 + 2048
s_add_u32 s70, s68, 1605632
buffer_load_dwordx4 v105, s[84:87], s70 offen lds
s_add_u32 m0, s71, 65536 + 3072
s_add_u32 s70, s68, 1622016
buffer_load_dwordx4 v105, s[84:87], s70 offen lds
s_cmp_eq_u32 s21, 1
s_cbranch_scc1 L_po2_1
s_cmp_eq_u32 s21, 2
s_cbranch_scc1 L_po2_2
s_cmp_eq_u32 s21, 3
s_cbranch_scc1 L_po2_3
ds_write_b128 v12, v[40:43] offset:24576
ds_write_b128 v12, v[44:47] offset:25600
ds_write_b128 v12, v[48:51] offset:26624
ds_write_b128 v12, v[52:55] offset:27648
ds_write_b128 v12, v[56:59] offset:28672
ds_write_b128 v12, v[60:63] offset:29696
ds_write_b128 v12, v[64:67] offset:30720
ds_write_b128 v12, v[68:71] offset:31744
s_waitcnt lgkmcnt(0)
s_branch L_po2_e
L_po2_1:
s_branch L_po2_e
L_po2_2:
s_branch L_po2_e
L_po2_3:
ds_write_b128 v12, v[40:43] offset:16384
ds_write_b128 v12, v[44:47] offset:17408
ds_write_b128 v12, v[48:51] offset:18432
ds_write_b128 v12, v[52:55] offset:19456
ds_write_b128 v12, v[56:59] offset:20480
ds_write_b128 v12, v[60:63] offset:21504
ds_write_b128 v12, v[64:67] offset:22528
ds_write_b128 v12, v[68:71] offset:23552
s_waitcnt lgkmcnt(0)
L_po2_e:
v_readfirstlane_b32 s27, v125
s_cmp_eq_u32 s27, 256
s_cselect_b32 s93, 1, 0
global_load_dword v124, v127, s[8:9] offset:136 sc1
global_load_dword v126, v127, s[2:3] sc1
v_add_u32 v116, 98304, v112
v_add_u32 v117, 98304, v113
v_add_u32 v118, 98304, v114
v_add_u32 v119, 98304, v115
s_cmp_eq_u32 s21, 1
s_cbranch_scc1 L_lo30_1
s_cmp_eq_u32 s21, 2
s_cbranch_scc1 L_lo30_2
s_cmp_eq_u32 s21, 3
s_cbranch_scc1 L_lo30_3
ds_read_b64_tr_b16 v[72:73], v116 offset:0
ds_read_b64_tr_b16 v[74:75], v116 offset:2048
ds_read_b64_tr_b16 v[80:81], v117 offset:0
ds_read_b64_tr_b16 v[82:83], v117 offset:2048
ds_read_b64_tr_b16 v[88:89], v118 offset:0
ds_read_b64_tr_b16 v[90:91], v118 offset:2048
ds_read_b64_tr_b16 v[96:97], v119 offset:0
ds_read_b64_tr_b16 v[98:99], v119 offset:2048
s_branch L_lo30_e
L_lo30_1:
ds_read_b64_tr_b16 v[40:41], v116 offset:0
ds_read_b64_tr_b16 v[42:43], v116 offset:2048
ds_read_b64_tr_b16 v[48:49], v117 offset:0
ds_read_b64_tr_b16 v[50:51], v117 offset:2048
ds_read_b64_tr_b16 v[56:57], v118 offset:0
ds_read_b64_tr_b16 v[58:59], v118 offset:2048
ds_read_b64_tr_b16 v[64:65], v119 offset:0
ds_read_b64_tr_b16 v[66:67], v119 offset:2048
s_branch L_lo30_e
L_lo30_2:
ds_read_b64_tr_b16 v[40:41], v116 offset:0
ds_read_b64_tr_b16 v[42:43], v116 offset:2048
ds_read_b64_tr_b16 v[48:49], v117 offset:0
ds_read_b64_tr_b16 v[50:51], v117 offset:2048
ds_read_b64_tr_b16 v[56:57], v118 offset:0
ds_read_b64_tr_b16 v[58:59], v118 offset:2048
ds_read_b64_tr_b16 v[64:65], v119 offset:0
ds_read_b64_tr_b16 v[66:67], v119 offset:2048
s_branch L_lo30_e
L_lo30_3:
ds_read_b64_tr_b16 v[224:225], v116 offset:0
ds_read_b64_tr_b16 v[226:227], v116 offset:2048
ds_read_b64_tr_b16 v[232:233], v117 offset:0
ds_read_b64_tr_b16 v[234:235], v117 offset:2048
ds_read_b64_tr_b16 v[240:241], v118 offset:0
ds_read_b64_tr_b16 v[242:243], v118 offset:2048
ds_read_b64_tr_b16 v[248:249], v119 offset:0
ds_read_b64_tr_b16 v[250:251], v119 offset:2048
L_lo30_e:
s_waitcnt vmcnt(16) lgkmcnt(0)
s_barrier
s_add_u32 m0, s71, 98304 + 0
s_add_u32 s70, s68, 2097152
buffer_load_dwordx4 v104, s[84:87], s70 offen lds
s_add_u32 m0, s71, 98304 + 1024
s_add_u32 s70, s68, 2113536
buffer_load_dwordx4 v104, s[84:87], s70 offen lds
s_add_u32 m0, s71, 98304 + 2048
s_add_u32 s70, s68, 2129920
buffer_load_dwordx4 v105, s[84:87], s70 offen lds
s_add_u32 m0, s71, 98304 + 3072
s_add_u32 s70, s68, 2146304
buffer_load_dwordx4 v105, s[84:87], s70 offen lds
v_add_u32 v116, 131072, v112
v_add_u32 v117, 131072, v113
v_add_u32 v118, 131072, v114
v_add_u32 v119, 131072, v115
s_cmp_eq_u32 s21, 1
s_cbranch_scc1 L_lo31_1
s_cmp_eq_u32 s21, 2
s_cbranch_scc1 L_lo31_2
s_cmp_eq_u32 s21, 3
s_cbranch_scc1 L_lo31_3
ds_read_b64_tr_b16 v[76:77], v116 offset:0
ds_read_b64_tr_b16 v[78:79], v116 offset:2048
ds_read_b64_tr_b16 v[84:85], v117 offset:0
ds_read_b64_tr_b16 v[86:87], v117 offset:2048
ds_read_b64_tr_b16 v[92:93], v118 offset:0
ds_read_b64_tr_b16 v[94:95], v118 offset:2048
ds_read_b64_tr_b16 v[100:101], v119 offset:0
ds_read_b64_tr_b16 v[102:103], v119 offset:2048
s_branch L_lo31_e
L_lo31_1:
ds_read_b64_tr_b16 v[44:45], v116 offset:0
ds_read_b64_tr_b16 v[46:47], v116 offset:2048
ds_read_b64_tr_b16 v[52:53], v117 offset:0
ds_read_b64_tr_b16 v[54:55], v117 offset:2048
ds_read_b64_tr_b16 v[60:61], v118 offset:0
ds_read_b64_tr_b16 v[62:63], v118 offset:2048
ds_read_b64_tr_b16 v[68:69], v119 offset:0
ds_read_b64_tr_b16 v[70:71], v119 offset:2048
s_branch L_lo31_e
L_lo31_2:
ds_read_b64_tr_b16 v[44:45], v116 offset:0
ds_read_b64_tr_b16 v[46:47], v116 offset:2048
ds_read_b64_tr_b16 v[52:53], v117 offset:0
ds_read_b64_tr_b16 v[54:55], v117 offset:2048
ds_read_b64_tr_b16 v[60:61], v118 offset:0
ds_read_b64_tr_b16 v[62:63], v118 offset:2048
ds_read_b64_tr_b16 v[68:69], v119 offset:0
ds_read_b64_tr_b16 v[70:71], v119 offset:2048
s_branch L_lo31_e
L_lo31_3:
ds_read_b64_tr_b16 v[228:229], v116 offset:0
ds_read_b64_tr_b16 v[230:231], v116 offset:2048
ds_read_b64_tr_b16 v[236:237], v117 offset:0
ds_read_b64_tr_b16 v[238:239], v117 offset:2048
ds_read_b64_tr_b16 v[244:245], v118 offset:0
ds_read_b64_tr_b16 v[246:247], v118 offset:2048
ds_read_b64_tr_b16 v[252:253], v119 offset:0
ds_read_b64_tr_b16 v[254:255], v119 offset:2048
L_lo31_e:
s_waitcnt vmcnt(16) lgkmcnt(0)
s_barrier
s_add_u32 m0, s71, 131072 + 0
s_add_u32 s70, s68, 2621440
buffer_load_dwordx4 v104, s[84:87], s70 offen lds
s_add_u32 m0, s71, 131072 + 1024
s_add_u32 s70, s68, 2637824
buffer_load_dwordx4 v104, s[84:87], s70 offen lds
s_add_u32 m0, s71, 131072 + 2048
s_add_u32 s70, s68, 2654208
buffer_load_dwordx4 v105, s[84:87], s70 offen lds
s_add_u32 m0, s71, 131072 + 3072
s_add_u32 s70, s68, 2670592
buffer_load_dwordx4 v105, s[84:87], s70 offen lds
s_cmp_eq_u32 s21, 1
s_cbranch_scc1 L_po3_1
s_cmp_eq_u32 s21, 2
s_cbranch_scc1 L_po3_2
s_cmp_eq_u32 s21, 3
s_cbranch_scc1 L_po3_3
s_branch L_po3_e
L_po3_1:
ds_write_b128 v12, v[40:43] offset:24576
ds_write_b128 v12, v[44:47] offset:25600
ds_write_b128 v12, v[48:51] offset:26624
ds_write_b128 v12, v[52:55] offset:27648
ds_write_b128 v12, v[56:59] offset:28672
ds_write_b128 v12, v[60:63] offset:29696
ds_write_b128 v12, v[64:67] offset:30720
ds_write_b128 v12, v[68:71] offset:31744
s_waitcnt lgkmcnt(0)
s_branch L_po3_e
L_po3_2:
ds_write_b128 v12, v[40:43] offset:16384
ds_write_b128 v12, v[44:47] offset:17408
ds_write_b128 v12, v[48:51] offset:18432
ds_write_b128 v12, v[52:55] offset:19456
ds_write_b128 v12, v[56:59] offset:20480
ds_write_b128 v12, v[60:63] offset:21504
ds_write_b128 v12, v[64:67] offset:22528
ds_write_b128 v12, v[68:71] offset:23552
s_waitcnt lgkmcnt(0)
s_branch L_po3_e
L_po3_3:
L_po3_e:
v_add_u32 v116, 0, v110
v_add_u32 v117, 0, v111
s_cmp_eq_u32 s21, 1
s_cbranch_scc1 L_lv0_1
s_cmp_eq_u32 s21, 2
s_cbranch_scc1 L_lv0_2
s_cmp_eq_u32 s21, 3
s_cbranch_scc1 L_lv0_3
ds_read_b64_tr_b16 v[40:41], v116 offset:0
ds_read_b64_tr_b16 v[42:43], v116 offset:1024
ds_read_b64_tr_b16 v[44:45], v116 offset:8192
ds_read_b64_tr_b16 v[46:47], v116 offset:9216
ds_read_b64_tr_b16 v[48:49], v117 offset:0
ds_read_b64_tr_b16 v[50:51], v117 offset:1024
ds_read_b64_tr_b16 v[52:53], v117 offset:8192
ds_read_b64_tr_b16 v[54:55], v117 offset:9216
s_branch L_lv0_e
L_lv0_1:
ds_read_b64_tr_b16 v[128:129], v116 offset:0
ds_read_b64_tr_b16 v[130:131], v116 offset:1024
ds_read_b64_tr_b16 v[132:133], v116 offset:8192
ds_read_b64_tr_b16 v[134:135], v116 offset:9216
ds_read_b64_tr_b16 v[136:137], v117 offset:0
ds_read_b64_tr_b16 v[138:139], v117 offset:1024
ds_read_b64_tr_b16 v[140:141], v117 offset:8192
ds_read_b64_tr_b16 v[142:143], v117 offset:9216
s_branch L_lv0_e
L_lv0_2:
ds_read_b64_tr_b16 v[160:161], v116 offset:0
ds_read_b64_tr_b16 v[162:163], v116 offset:1024
ds_read_b64_tr_b16 v[164:165], v116 offset:8192
ds_read_b64_tr_b16 v[166:167], v116 offset:9216
ds_read_b64_tr_b16 v[168:169], v117 offset:0
ds_read_b64_tr_b16 v[170:171], v117 offset:1024
ds_read_b64_tr_b16 v[172:173], v117 offset:8192
ds_read_b64_tr_b16 v[174:175], v117 offset:9216
s_branch L_lv0_e
L_lv0_3:
ds_read_b64_tr_b16 v[192:193], v116 offset:0
ds_read_b64_tr_b16 v[194:195], v116 offset:1024
ds_read_b64_tr_b16 v[196:197], v116 offset:8192
ds_read_b64_tr_b16 v[198:199], v116 offset:9216
ds_read_b64_tr_b16 v[200:201], v117 offset:0
ds_read_b64_tr_b16 v[202:203], v117 offset:1024
ds_read_b64_tr_b16 v[204:205], v117 offset:8192
ds_read_b64_tr_b16 v[206:207], v117 offset:9216
L_lv0_e:
s_waitcnt vmcnt(16) lgkmcnt(0)
s_barrier
s_add_u32 m0, s71, 0 + 0
s_add_u32 s70, s68, 3145728
buffer_load_dwordx4 v104, s[84:87], s70 offen lds
s_add_u32 m0, s71, 0 + 1024
s_add_u32 s70, s68, 3162112
buffer_load_dwordx4 v104, s[84:87], s70 offen lds
s_add_u32 m0, s71, 0 + 2048
s_add_u32 s70, s68, 3178496
buffer_load_dwordx4 v105, s[84:87], s70 offen lds
s_add_u32 m0, s71, 0 + 3072
s_add_u32 s70, s68, 3194880
buffer_load_dwordx4 v105, s[84:87], s70 offen lds
s_getpc_b64 s[94:95]
L_pc2:
v_lshlrev_b32 v28, 6, v0
s_lshl_b32 s27, s21, 12
s_add_u32 s27, s27, L_step0 - L_pc2 - 64
v_add_u32 v28, s27, v28
v_mov_b32 v29, 0
v_lshl_add_u64 v[28:29], v[28:29], 0, s[94:95]
global_load_dword v30, v[28:29], off
v_add_u32 v116, 32768, v110
v_add_u32 v117, 32768, v111
s_cmp_eq_u32 s21, 1
s_cbranch_scc1 L_lv1_1
s_cmp_eq_u32 s21, 2
s_cbranch_scc1 L_lv1_2
s_cmp_eq_u32 s21, 3
s_cbranch_scc1 L_lv1_3
ds_read_b64_tr_b16 v[56:57], v116 offset:0
ds_read_b64_tr_b16 v[58:59], v116 offset:1024
ds_read_b64_tr_b16 v[60:61], v116 offset:8192
ds_read_b64_tr_b16 v[62:63], v116 offset:9216
ds_read_b64_tr_b16 v[64:65], v117 offset:0
ds_read_b64_tr_b16 v[66:67], v117 offset:1024
ds_read_b64_tr_b16 v[68:69], v117 offset:8192
ds_read_b64_tr_b16 v[70:71], v117 offset:9216
s_branch L_lv1_e
L_lv1_1:
ds_read_b64_tr_b16 v[144:145], v116 offset:0
ds_read_b64_tr_b16 v[146:147], v116 offset:1024
ds_read_b64_tr_b16 v[148:149], v116 offset:8192
ds_read_b64_tr_b16 v[150:151], v116 offset:9216
ds_read_b64_tr_b16 v[152:153], v117 offset:0
ds_read_b64_tr_b16 v[154:155], v117 offset:1024
ds_read_b64_tr_b16 v[156:157], v117 offset:8192
ds_read_b64_tr_b16 v[158:159], v117 offset:9216
s_branch L_lv1_e
L_lv1_2:
ds_read_b64_tr_b16 v[176:177], v116 offset:0
ds_read_b64_tr_b16 v[178:179], v116 offset:1024
ds_read_b64_tr_b16 v[180:181], v116 offset:8192
ds_read_b64_tr_b16 v[182:183], v116 offset:9216
ds_read_b64_tr_b16 v[184:185], v117 offset:0
ds_read_b64_tr_b16 v[186:187], v117 offset:1024
ds_read_b64_tr_b16 v[188:189], v117 offset:8192
ds_read_b64_tr_b16 v[190:191], v117 offset:9216
s_branch L_lv1_e
L_lv1_3:
ds_read_b64_tr_b16 v[208:209], v116 offset:0
ds_read_b64_tr_b16 v[210:211], v116 offset:1024
ds_read_b64_tr_b16 v[212:213], v116 offset:8192
ds_read_b64_tr_b16 v[214:215], v116 offset:9216
ds_read_b64_tr_b16 v[216:217], v117 offset:0
ds_read_b64_tr_b16 v[218:219], v117 offset:1024
ds_read_b64_tr_b16 v[220:221], v117 offset:8192
ds_read_b64_tr_b16 v[222:223], v117 offset:9216
L_lv1_e:
s_waitcnt vmcnt(16) lgkmcnt(0)
s_barrier
s_add_u32 m0, s71, 32768 + 0
s_add_u32 s70, s68, 3670016
buffer_load_dwordx4 v104, s[84:87], s70 offen lds
s_add_u32 m0, s71, 32768 + 1024
s_add_u32 s70, s68, 3686400
buffer_load_dwordx4 v104, s[84:87], s70 offen lds
s_add_u32 m0, s71, 32768 + 2048
s_add_u32 s70, s68, 3702784
buffer_load_dwordx4 v105, s[84:87], s70 offen lds
s_add_u32 m0, s71, 32768 + 3072
s_add_u32 s70, s68, 3719168
buffer_load_dwordx4 v105, s[84:87], s70 offen lds
v_add_u32 v116, 16384, v110
v_add_u32 v117, 16384, v111
s_cmp_eq_u32 s21, 1
s_cbranch_scc1 L_lv2_1
s_cmp_eq_u32 s21, 2
s_cbranch_scc1 L_lv2_2
s_cmp_eq_u32 s21, 3
s_cbranch_scc1 L_lv2_3
ds_read_b64_tr_b16 v[128:129], v116 offset:0
ds_read_b64_tr_b16 v[130:131], v116 offset:1024
ds_read_b64_tr_b16 v[132:133], v116 offset:8192
ds_read_b64_tr_b16 v[134:135], v116 offset:9216
ds_read_b64_tr_b16 v[136:137], v117 offset:0
ds_read_b64_tr_b16 v[138:139], v117 offset:1024
ds_read_b64_tr_b16 v[140:141], v117 offset:8192
ds_read_b64_tr_b16 v[142:143], v117 offset:9216
s_branch L_lv2_e
L_lv2_1:
ds_read_b64_tr_b16 v[40:41], v116 offset:0
ds_read_b64_tr_b16 v[42:43], v116 offset:1024
ds_read_b64_tr_b16 v[44:45], v116 offset:8192
ds_read_b64_tr_b16 v[46:47], v116 offset:9216
ds_read_b64_tr_b16 v[48:49], v117 offset:0
ds_read_b64_tr_b16 v[50:51], v117 offset:1024
ds_read_b64_tr_b16 v[52:53], v117 offset:8192
ds_read_b64_tr_b16 v[54:55], v117 offset:9216
s_branch L_lv2_e
L_lv2_2:
ds_read_b64_tr_b16 v[192:193], v116 offset:0
ds_read_b64_tr_b16 v[194:195], v116 offset:1024
ds_read_b64_tr_b16 v[196:197], v116 offset:8192
ds_read_b64_tr_b16 v[198:199], v116 offset:9216
ds_read_b64_tr_b16 v[200:201], v117 offset:0
ds_read_b64_tr_b16 v[202:203], v117 offset:1024
ds_read_b64_tr_b16 v[204:205], v117 offset:8192
ds_read_b64_tr_b16 v[206:207], v117 offset:9216
s_branch L_lv2_e
L_lv2_3:
ds_read_b64_tr_b16 v[160:161], v116 offset:0
ds_read_b64_tr_b16 v[162:163], v116 offset:1024
ds_read_b64_tr_b16 v[164:165], v116 offset:8192
ds_read_b64_tr_b16 v[166:167], v116 offset:9216
ds_read_b64_tr_b16 v[168:169], v117 offset:0
ds_read_b64_tr_b16 v[170:171], v117 offset:1024
ds_read_b64_tr_b16 v[172:173], v117 offset:8192
ds_read_b64_tr_b16 v[174:175], v117 offset:9216
L_lv2_e:
s_waitcnt vmcnt(16) lgkmcnt(0)
s_barrier
v_readfirstlane_b32 s27, v124
v_readfirstlane_b32 s28, v126
s_cmp_ge_u32 s27, 32
s_cselect_b32 s93, s93, 0
s_cmp_lg_u32 s28, 0
s_cselect_b32 s93, s93, 0
s_cmp_eq_u32 s93, 1
s_cbranch_scc0 L_early_no
s_mov_b32 s14, s28
s_lshl_b32 s29, s21, 11
s_add_u32 s29, s29, 16384
s_mov_b32 m0, s29
s_nop 0
global_load_lds_dwordx4 v2, s[38:39] sc1
global_load_lds_dwordx4 v2, s[38:39] offset:1024 sc1
global_load_dwordx4 v[20:23], v2, s[40:41] sc1
global_load_dwordx4 v[24:27], v2, s[40:41] offset:1024 sc1
L_early_no:
v_add_u32 v116, 65536, v110
v_add_u32 v117, 65536, v111
s_cmp_eq_u32 s21, 1
s_cbranch_scc1 L_lv3_1
s_cmp_eq_u32 s21, 2
s_cbranch_scc1 L_lv3_2
s_cmp_eq_u32 s21, 3
s_cbranch_scc1 L_lv3_3
ds_read_b64_tr_b16 v[144:145], v116 offset:0
ds_read_b64_tr_b16 v[146:147], v116 offset:1024
ds_read_b64_tr_b16 v[148:149], v116 offset:8192
ds_read_b64_tr_b16 v[150:151], v116 offset:9216
ds_read_b64_tr_b16 v[152:153], v117 offset:0
ds_read_b64_tr_b16 v[154:155], v117 offset:1024
ds_read_b64_tr_b16 v[156:157], v117 offset:8192
ds_read_b64_tr_b16 v[158:159], v117 offset:9216
s_branch L_lv3_e
L_lv3_1:
ds_read_b64_tr_b16 v[56:57], v116 offset:0
ds_read_b64_tr_b16 v[58:59], v116 offset:1024
ds_read_b64_tr_b16 v[60:61], v116 offset:8192
ds_read_b64_tr_b16 v[62:63], v116 offset:9216
ds_read_b64_tr_b16 v[64:65], v117 offset:0
ds_read_b64_tr_b16 v[66:67], v117 offset:1024
ds_read_b64_tr_b16 v[68:69], v117 offset:8192
ds_read_b64_tr_b16 v[70:71], v117 offset:9216
s_branch L_lv3_e
L_lv3_2:
ds_read_b64_tr_b16 v[208:209], v116 offset:0
ds_read_b64_tr_b16 v[210:211], v116 offset:1024
ds_read_b64_tr_b16 v[212:213], v116 offset:8192
ds_read_b64_tr_b16 v[214:215], v116 offset:9216
ds_read_b64_tr_b16 v[216:217], v117 offset:0
ds_read_b64_tr_b16 v[218:219], v117 offset:1024
ds_read_b64_tr_b16 v[220:221], v117 offset:8192
ds_read_b64_tr_b16 v[222:223], v117 offset:9216
s_branch L_lv3_e
L_lv3_3:
ds_read_b64_tr_b16 v[176:177], v116 offset:0
ds_read_b64_tr_b16 v[178:179], v116 offset:1024
ds_read_b64_tr_b16 v[180:181], v116 offset:8192
ds_read_b64_tr_b16 v[182:183], v116 offset:9216
ds_read_b64_tr_b16 v[184:185], v117 offset:0
ds_read_b64_tr_b16 v[186:187], v117 offset:1024
ds_read_b64_tr_b16 v[188:189], v117 offset:8192
ds_read_b64_tr_b16 v[190:191], v117 offset:9216
L_lv3_e:
s_waitcnt vmcnt(12) lgkmcnt(0)
s_barrier
v_add_u32 v116, 98304, v110
v_add_u32 v117, 98304, v111
s_cmp_eq_u32 s21, 1
s_cbranch_scc1 L_lv4_1
s_cmp_eq_u32 s21, 2
s_cbranch_scc1 L_lv4_2
s_cmp_eq_u32 s21, 3
s_cbranch_scc1 L_lv4_3
ds_read_b64_tr_b16 v[160:161], v116 offset:0
ds_read_b64_tr_b16 v[162:163], v116 offset:1024
ds_read_b64_tr_b16 v[164:165], v116 offset:8192
ds_read_b64_tr_b16 v[166:167], v116 offset:9216
ds_read_b64_tr_b16 v[168:169], v117 offset:0
ds_read_b64_tr_b16 v[170:171], v117 offset:1024
ds_read_b64_tr_b16 v[172:173], v117 offset:8192
ds_read_b64_tr_b16 v[174:175], v117 offset:9216
s_branch L_lv4_e
L_lv4_1:
ds_read_b64_tr_b16 v[192:193], v116 offset:0
ds_read_b64_tr_b16 v[194:195], v116 offset:1024
ds_read_b64_tr_b16 v[196:197], v116 offset:8192
ds_read_b64_tr_b16 v[198:199], v116 offset:9216
ds_read_b64_tr_b16 v[200:201], v117 offset:0
ds_read_b64_tr_b16 v[202:203], v117 offset:1024
ds_read_b64_tr_b16 v[204:205], v117 offset:8192
ds_read_b64_tr_b16 v[206:207], v117 offset:9216
s_branch L_lv4_e
L_lv4_2:
ds_read_b64_tr_b16 v[40:41], v116 offset:0
ds_read_b64_tr_b16 v[42:43], v116 offset:1024
ds_read_b64_tr_b16 v[44:45], v116 offset:8192
ds_read_b64_tr_b16 v[46:47], v116 offset:9216
ds_read_b64_tr_b16 v[48:49], v117 offset:0
ds_read_b64_tr_b16 v[50:51], v117 offset:1024
ds_read_b64_tr_b16 v[52:53], v117 offset:8192
ds_read_b64_tr_b16 v[54:55], v117 offset:9216
s_branch L_lv4_e
L_lv4_3:
ds_read_b64_tr_b16 v[128:129], v116 offset:0
ds_read_b64_tr_b16 v[130:131], v116 offset:1024
ds_read_b64_tr_b16 v[132:133], v116 offset:8192
ds_read_b64_tr_b16 v[134:135], v116 offset:9216
ds_read_b64_tr_b16 v[136:137], v117 offset:0
ds_read_b64_tr_b16 v[138:139], v117 offset:1024
ds_read_b64_tr_b16 v[140:141], v117 offset:8192
ds_read_b64_tr_b16 v[142:143], v117 offset:9216
L_lv4_e:
s_waitcnt vmcnt(8) lgkmcnt(0)
s_barrier
v_add_u32 v116, 131072, v110
v_add_u32 v117, 131072, v111
s_cmp_eq_u32 s21, 1
s_cbranch_scc1 L_lv5_1
s_cmp_eq_u32 s21, 2
s_cbranch_scc1 L_lv5_2
s_cmp_eq_u32 s21, 3
s_cbranch_scc1 L_lv5_3
ds_read_b64_tr_b16 v[176:177], v116 offset:0
ds_read_b64_tr_b16 v[178:179], v116 offset:1024
ds_read_b64_tr_b16 v[180:181], v116 offset:8192
ds_read_b64_tr_b16 v[182:183], v116 offset:9216
ds_read_b64_tr_b16 v[184:185], v117 offset:0
ds_read_b64_tr_b16 v[186:187], v117 offset:1024
ds_read_b64_tr_b16 v[188:189], v117 offset:8192
ds_read_b64_tr_b16 v[190:191], v117 offset:9216
s_branch L_lv5_e
L_lv5_1:
ds_read_b64_tr_b16 v[208:209], v116 offset:0
ds_read_b64_tr_b16 v[210:211], v116 offset:1024
ds_read_b64_tr_b16 v[212:213], v116 offset:8192
ds_read_b64_tr_b16 v[214:215], v116 offset:9216
ds_read_b64_tr_b16 v[216:217], v117 offset:0
ds_read_b64_tr_b16 v[218:219], v117 offset:1024
ds_read_b64_tr_b16 v[220:221], v117 offset:8192
ds_read_b64_tr_b16 v[222:223], v117 offset:9216
s_branch L_lv5_e
L_lv5_2:
ds_read_b64_tr_b16 v[56:57], v116 offset:0
ds_read_b64_tr_b16 v[58:59], v116 offset:1024
ds_read_b64_tr_b16 v[60:61], v116 offset:8192
ds_read_b64_tr_b16 v[62:63], v116 offset:9216
ds_read_b64_tr_b16 v[64:65], v117 offset:0
ds_read_b64_tr_b16 v[66:67], v117 offset:1024
ds_read_b64_tr_b16 v[68:69], v117 offset:8192
ds_read_b64_tr_b16 v[70:71], v117 offset:9216
s_branch L_lv5_e
L_lv5_3:
ds_read_b64_tr_b16 v[144:145], v116 offset:0
ds_read_b64_tr_b16 v[146:147], v116 offset:1024
ds_read_b64_tr_b16 v[148:149], v116 offset:8192
ds_read_b64_tr_b16 v[150:151], v116 offset:9216
ds_read_b64_tr_b16 v[152:153], v117 offset:0
ds_read_b64_tr_b16 v[154:155], v117 offset:1024
ds_read_b64_tr_b16 v[156:157], v117 offset:8192
ds_read_b64_tr_b16 v[158:159], v117 offset:9216
L_lv5_e:
s_waitcnt vmcnt(4) lgkmcnt(0)
s_barrier
v_add_u32 v116, 0, v110
v_add_u32 v117, 0, v111
s_cmp_eq_u32 s21, 1
s_cbranch_scc1 L_lv6_1
s_cmp_eq_u32 s21, 2
s_cbranch_scc1 L_lv6_2
s_cmp_eq_u32 s21, 3
s_cbranch_scc1 L_lv6_3
ds_read_b64_tr_b16 v[192:193], v116 offset:0
ds_read_b64_tr_b16 v[194:195], v116 offset:1024
ds_read_b64_tr_b16 v[196:197], v116 offset:8192
ds_read_b64_tr_b16 v[198:199], v116 offset:9216
ds_read_b64_tr_b16 v[200:201], v117 offset:0
ds_read_b64_tr_b16 v[202:203], v117 offset:1024
ds_read_b64_tr_b16 v[204:205], v117 offset:8192
ds_read_b64_tr_b16 v[206:207], v117 offset:9216
s_branch L_lv6_e
L_lv6_1:
ds_read_b64_tr_b16 v[160:161], v116 offset:0
ds_read_b64_tr_b16 v[162:163], v116 offset:1024
ds_read_b64_tr_b16 v[164:165], v116 offset:8192
ds_read_b64_tr_b16 v[166:167], v116 offset:9216
ds_read_b64_tr_b16 v[168:169], v117 offset:0
ds_read_b64_tr_b16 v[170:171], v117 offset:1024
ds_read_b64_tr_b16 v[172:173], v117 offset:8192
ds_read_b64_tr_b16 v[174:175], v117 offset:9216
s_branch L_lv6_e
L_lv6_2:
ds_read_b64_tr_b16 v[128:129], v116 offset:0
ds_read_b64_tr_b16 v[130:131], v116 offset:1024
ds_read_b64_tr_b16 v[132:133], v116 offset:8192
ds_read_b64_tr_b16 v[134:135], v116 offset:9216
ds_read_b64_tr_b16 v[136:137], v117 offset:0
ds_read_b64_tr_b16 v[138:139], v117 offset:1024
ds_read_b64_tr_b16 v[140:141], v117 offset:8192
ds_read_b64_tr_b16 v[142:143], v117 offset:9216
s_branch L_lv6_e
L_lv6_3:
ds_read_b64_tr_b16 v[40:41], v116 offset:0
ds_read_b64_tr_b16 v[42:43], v116 offset:1024
ds_read_b64_tr_b16 v[44:45], v116 offset:8192
ds_read_b64_tr_b16 v[46:47], v116 offset:9216
ds_read_b64_tr_b16 v[48:49], v117 offset:0
ds_read_b64_tr_b16 v[50:51], v117 offset:1024
ds_read_b64_tr_b16 v[52:53], v117 offset:8192
ds_read_b64_tr_b16 v[54:55], v117 offset:9216
L_lv6_e:
s_waitcnt vmcnt(0) lgkmcnt(0)
s_barrier
v_add_u32 v116, 32768, v110
v_add_u32 v117, 32768, v111
s_cmp_eq_u32 s21, 1
s_cbranch_scc1 L_lv7_1
s_cmp_eq_u32 s21, 2
s_cbranch_scc1 L_lv7_2
s_cmp_eq_u32 s21, 3
s_cbranch_scc1 L_lv7_3
ds_read_b64_tr_b16 v[208:209], v116 offset:0
ds_read_b64_tr_b16 v[210:211], v116 offset:1024
ds_read_b64_tr_b16 v[212:213], v116 offset:8192
ds_read_b64_tr_b16 v[214:215], v116 offset:9216
ds_read_b64_tr_b16 v[216:217], v117 offset:0
ds_read_b64_tr_b16 v[218:219], v117 offset:1024
ds_read_b64_tr_b16 v[220:221], v117 offset:8192
ds_read_b64_tr_b16 v[222:223], v117 offset:9216
s_branch L_lv7_e
L_lv7_1:
ds_read_b64_tr_b16 v[176:177], v116 offset:0
ds_read_b64_tr_b16 v[178:179], v116 offset:1024
ds_read_b64_tr_b16 v[180:181], v116 offset:8192
ds_read_b64_tr_b16 v[182:183], v116 offset:9216
ds_read_b64_tr_b16 v[184:185], v117 offset:0
ds_read_b64_tr_b16 v[186:187], v117 offset:1024
ds_read_b64_tr_b16 v[188:189], v117 offset:8192
ds_read_b64_tr_b16 v[190:191], v117 offset:9216
s_branch L_lv7_e
L_lv7_2:
ds_read_b64_tr_b16 v[144:145], v116 offset:0
ds_read_b64_tr_b16 v[146:147], v116 offset:1024
ds_read_b64_tr_b16 v[148:149], v116 offset:8192
ds_read_b64_tr_b16 v[150:151], v116 offset:9216
ds_read_b64_tr_b16 v[152:153], v117 offset:0
ds_read_b64_tr_b16 v[154:155], v117 offset:1024
ds_read_b64_tr_b16 v[156:157], v117 offset:8192
ds_read_b64_tr_b16 v[158:159], v117 offset:9216
s_branch L_lv7_e
L_lv7_3:
ds_read_b64_tr_b16 v[56:57], v116 offset:0
ds_read_b64_tr_b16 v[58:59], v116 offset:1024
ds_read_b64_tr_b16 v[60:61], v116 offset:8192
ds_read_b64_tr_b16 v[62:63], v116 offset:9216
ds_read_b64_tr_b16 v[64:65], v117 offset:0
ds_read_b64_tr_b16 v[66:67], v117 offset:1024
ds_read_b64_tr_b16 v[68:69], v117 offset:8192
ds_read_b64_tr_b16 v[70:71], v117 offset:9216
L_lv7_e:
s_waitcnt lgkmcnt(0)
s_barrier
ds_write_b128 v12, v[40:43] offset:0
ds_write_b128 v12, v[44:47] offset:1024
ds_write_b128 v12, v[48:51] offset:2048
ds_write_b128 v12, v[52:55] offset:3072
s_waitcnt lgkmcnt(4)
ds_write_b128 v12, v[56:59] offset:4096
ds_write_b128 v12, v[60:63] offset:5120
ds_write_b128 v12, v[64:67] offset:6144
ds_write_b128 v12, v[68:71] offset:7168
s_waitcnt lgkmcnt(4)
ds_write_b128 v12, v[72:75] offset:8192
ds_write_b128 v12, v[76:79] offset:9216
s_waitcnt lgkmcnt(4)
ds_write_b128 v12, v[80:83] offset:10240
ds_write_b128 v12, v[84:87] offset:11264
s_waitcnt lgkmcnt(4)
ds_write_b128 v12, v[88:91] offset:12288
ds_write_b128 v12, v[92:95] offset:13312
s_waitcnt lgkmcnt(4)
ds_write_b128 v12, v[96:99] offset:14336
ds_write_b128 v12, v[100:103] offset:15360
s_waitcnt lgkmcnt(4)
s_cmp_eq_u32 s93, 1
s_cbranch_scc1 L_late_done
s_mov_b32 s25, 0
v_mov_b32 v40, 192
s_branch L_wc_c_e
L_wc_c:
s_sleep 8
L_wc_c_e:
global_load_dword v41, v40, s[8:9] sc1
s_add_u32 s25, s25, 1
s_waitcnt vmcnt(0)
v_readfirstlane_b32 s27, v41
s_cmp_eq_u32 s27, 256
s_cbranch_scc1 L_wc_c_d
s_cmp_ge_u32 s27, 65536
s_cbranch_scc1 L_fallback
s_cmp_le_u32 s25, 32768
s_cbranch_scc1 L_wc_c
v_mov_b32 v43, s27
s_or_b32 s27, s27, 65536
v_mov_b32 v42, s27
s_mov_b64 exec, 1
global_atomic_cmpswap v40, v[42:43], s[8:9] sc1
s_mov_b64 exec, -1
s_waitcnt vmcnt(0)
s_branch L_wc_c_e
L_wc_c_d:
s_mov_b32 s25, 0
L_cbar:
v_mov_b32 v40, 136
global_load_dword v41, v40, s[8:9] sc1
s_add_u32 s25, s25, 1
s_cmp_gt_u32 s25, 1048576
s_cbranch_scc1 L_fail
s_waitcnt vmcnt(0)
v_cmp_gt_u32 vcc, 32, v41
s_cbranch_vccnz L_cbar
s_mov_b32 s14, 0
L_late_done:
s_cmp_gt_u32 s14, s17
s_cbranch_scc0 L_kvs_first
L_kvb_first:
s_mov_b32 s27, s14
s_mov_b32 s14, s15
s_mov_b32 s15, s27
s_add_u32 s18, s18, 4
s_and_b32 s27, s18, 127
s_cmp_eq_u32 s27, 8
s_cselect_b32 s27, 8, 0
s_sub_u32 s18, s18, s27
s_cmp_lg_u32 s27, 0
s_addc_u32 s17, s17, 0
s_cmp_eq_u32 s93, 1
s_cbranch_scc1 L_first_done
s_lshl_b32 s29, s21, 11
s_add_u32 s29, s29, 16384
s_mov_b32 m0, s29
s_nop 0
global_load_lds_dwordx4 v2, s[38:39] sc1
global_load_lds_dwordx4 v2, s[38:39] offset:1024 sc1
global_load_dwordx4 v[20:23], v2, s[40:41] sc1
global_load_dwordx4 v[24:27], v2, s[40:41] offset:1024 sc1
L_first_done:
s_lshl_b32 s29, s21, 11
s_add_u32 s29, s29, 16384
s_mov_b32 m0, s29
s_add_u32 s38, s38, 262144
s_addc_u32 s39, s39, 0
s_add_u32 s40, s40, 262144
s_addc_u32 s41, s41, 0
v_and_b32 v40, 2, v0
v_bfe_u32 v41, v0, 2, 1
v_add_u32 v0, v40, v41
s_waitcnt vmcnt(0) lgkmcnt(0)
s_barrier
ds_read_b128 v[96:99], v12 offset:0
ds_read_b128 v[100:103], v12 offset:1024
ds_read_b128 v[104:107], v12 offset:2048
ds_read_b128 v[108:111], v12 offset:3072
ds_read_b128 v[112:115], v12 offset:4096
ds_read_b128 v[116:119], v12 offset:5120
ds_read_b128 v[120:123], v12 offset:6144
ds_read_b128 v[124:127], v12 offset:7168
v_mov_b64 v[72:73], 0
v_mov_b64 v[74:75], 0
v_mov_b64 v[76:77], 0
v_mov_b64 v[78:79], 0
v_mov_b64 v[80:81], 0
v_mov_b64 v[82:83], 0
v_mov_b64 v[84:85], 0
v_mov_b64 v[86:87], 0
v_mov_b64 v[88:89], 0
v_mov_b64 v[90:91], 0
v_mov_b64 v[92:93], 0
v_mov_b64 v[94:95], 0
s_waitcnt lgkmcnt(0)
s_mov_b32 s23, 0
s_mov_b32 s11, 0
v_mov_b32 v36, 0
v_mov_b32 v37, 0
v_mov_b32 v38, 0
v_mov_b32 v39, 0
.p2align 6
s_nop 0
s_nop 0
s_nop 0
s_nop 0
s_nop 0
s_nop 0
L_step0:
s_cmp_lt_u32 s21, 2
s_cbranch_scc0 L_wd_g0
s_nop 6
s_nop 5
s_nop 5
s_nop 5
L_wd_g0:
s_nop 2
s_nop 2
s_nop 2
s_nop 2
s_nop 2
s_nop 1
s_nop 1
s_nop 1
s_nop 1
s_nop 1
global_load_dwordx4 v[40:43], v2, s[34:35] sc1
s_cmp_gt_u32 s14, s17
s_cbranch_scc0 L_kvs_s0
L_kvb_s0:
s_mov_b32 s27, s14
s_mov_b32 s14, s15
s_mov_b32 s15, s27
s_add_u32 s18, s18, 4
s_and_b32 s27, s18, 127
s_cmp_eq_u32 s27, 8
s_cselect_b32 s27, 8, 0
s_sub_u32 s18, s18, s27
s_cmp_lg_u32 s27, 0
s_addc_u32 s17, s17, 0
s_mov_b32 s25, 0
s_waitcnt lgkmcnt(0)
s_nop 4
global_load_dwordx4 v[40:43], v2, s[34:35] sc1
s_nop 7
s_nop 6
global_load_dwordx4 v[44:47], v2, s[34:35] offset:1024 sc1
s_nop 7
s_nop 6
global_load_dwordx4 v[44:47], v2, s[34:35] offset:1024 sc1
L_gwait0:
s_waitcnt vmcnt(3)
v_max3_u32 v52, v40, v41, v42
v_max_u32_e64 v52, v52, v43
v_cmp_eq_u32 vcc, -1, v52
s_cbranch_vccnz L_gre0
L_gok0:
v_smfmac_f32_16x16x64_bf16 v[72:75], v[40:43], a[0:7], v1
ds_write_b128 v2, v[40:43]
v_smfmac_f32_16x16x64_bf16 v[76:79], v[40:43], a[8:15], v1
v_smfmac_f32_16x16x64_bf16 v[80:83], v[40:43], a[128:135], v1
v_smfmac_f32_16x16x64_bf16 v[84:87], v[40:43], a[136:143], v1
v_smfmac_f32_16x16x64_bf16 v[88:91], v[40:43], v[96:103], v1
v_smfmac_f32_16x16x64_bf16 v[92:95], v[40:43], v[104:111], v1
s_waitcnt vmcnt(1)
v_max3_u32 v52, v44, v45, v46
v_max_u32_e64 v52, v52, v47
v_cmp_eq_u32 vcc, -1, v52
s_cbranch_vccnz L_hre0
L_hok0:
ds_write_b128 v2, v[44:47] offset:1024
v_smfmac_f32_16x16x64_bf16 v[72:75], v[44:47], a[16:23], v1
global_store_dwordx4 v10, v[36:39], s[42:43] sc1
v_smfmac_f32_16x16x64_bf16 v[76:79], v[44:47], a[24:31], v1
v_smfmac_f32_16x16x64_bf16 v[80:83], v[44:47], a[144:151], v1
s_waitcnt lgkmcnt(0)
s_barrier
ds_read_b128 v[48:51], v3 offset:0
v_smfmac_f32_16x16x64_bf16 v[84:87], v[44:47], a[152:159], v1
ds_read_b128 v[52:55], v3 offset:1024
v_smfmac_f32_16x16x64_bf16 v[88:91], v[44:47], v[112:119], v1
ds_read_b128 v[56:59], v4 offset:0
v_smfmac_f32_16x16x64_bf16 v[92:95], v[44:47], v[120:127], v1
ds_read_b128 v[60:63], v4 offset:1024
ds_read_b128 v[64:67], v5 offset:0
ds_read_b128 v[68:71], v5 offset:1024
s_waitcnt lgkmcnt(5)
v_smfmac_f32_16x16x64_bf16 v[72:75], v[48:51], a[32:39], v1
v_mov_b32 v19, s11
v_smfmac_f32_16x16x64_bf16 v[76:79], v[48:51], a[40:47], v1
s_waitcnt lgkmcnt(4)
global_load_dword v18, v9, s[38:39] sc1
v_smfmac_f32_16x16x64_bf16 v[72:75], v[52:55], a[48:55], v1
v_smfmac_f32_16x16x64_bf16 v[76:79], v[52:55], a[56:63], v1
s_waitcnt lgkmcnt(3)
v_smfmac_f32_16x16x64_bf16 v[72:75], v[56:59], a[64:71], v1
ds_read_b128 v[96:99], v10 offset:16384
v_smfmac_f32_16x16x64_bf16 v[76:79], v[56:59], a[72:79], v1
ds_read_b128 v[104:107], v10 offset:17408
s_waitcnt lgkmcnt(4)
v_smfmac_f32_16x16x64_bf16 v[72:75], v[60:63], a[80:87], v1
ds_read_b128 v[112:115], v10 offset:18432
global_load_dwordx4 v[28:31], v2, s[40:41] sc1
v_smfmac_f32_16x16x64_bf16 v[76:79], v[60:63], a[88:95], v1
ds_read_b128 v[120:123], v10 offset:19456
s_waitcnt lgkmcnt(5)
v_smfmac_f32_16x16x64_bf16 v[72:75], v[64:67], a[96:103], v1
ds_read_b128 v[100:103], v10 offset:20480
v_smfmac_f32_16x16x64_bf16 v[76:79], v[64:67], a[104:111], v1
ds_read_b128 v[108:111], v10 offset:21504
s_waitcnt lgkmcnt(6)
v_smfmac_f32_16x16x64_bf16 v[72:75], v[68:71], a[112:119], v1
ds_read_b128 v[116:119], v10 offset:22528
global_load_dwordx4 v[32:35], v2, s[40:41] offset:1024 sc1
v_smfmac_f32_16x16x64_bf16 v[76:79], v[68:71], a[120:127], v1
ds_read_b128 v[124:127], v10 offset:23552
v_smfmac_f32_16x16x64_bf16 v[80:83], v[48:51], a[160:167], v1
v_add_f32 v72, v72, v73
v_add_f32 v74, v74, v75
v_smfmac_f32_16x16x64_bf16 v[84:87], v[48:51], a[168:175], v1
v_add_f32 v76, v76, v77
v_add_f32 v78, v78, v79
v_cvt_pk_bf16_f32 v73, v72, v74
v_smfmac_f32_16x16x64_bf16 v[80:83], v[52:55], a[176:183], v1
v_cvt_pk_bf16_f32 v72, v72, v74
v_cvt_pk_bf16_f32 v77, v76, v78
v_smfmac_f32_16x16x64_bf16 v[84:87], v[52:55], a[184:191], v1
ds_write_b64 v6, v[72:73] offset:0
v_cvt_pk_bf16_f32 v76, v76, v78
v_smfmac_f32_16x16x64_bf16 v[80:83], v[56:59], a[192:199], v1
ds_write_b64 v6, v[76:77] offset:512
v_smfmac_f32_16x16x64_bf16 v[84:87], v[56:59], a[200:207], v1
s_mov_b64 exec, 1
v_smfmac_f32_16x16x64_bf16 v[80:83], v[60:63], a[208:215], v1
global_store_dword v10, v19, s[56:57] sc1
global_load_dword v18, v10, s[2:3] offset:0 sc1
v_smfmac_f32_16x16x64_bf16 v[84:87], v[60:63], a[216:223], v1
s_mov_b64 exec, -1
s_waitcnt vmcnt(6) lgkmcnt(0)
v_smfmac_f32_16x16x64_bf16 v[80:83], v[64:67], a[224:231], v1
s_barrier
ds_read_b64_tr_b16 v[40:41], v8 offset:8192
v_smfmac_f32_16x16x64_bf16 v[84:87], v[64:67], a[232:239], v1
ds_read_b64_tr_b16 v[42:43], v8 offset:8704
v_smfmac_f32_16x16x64_bf16 v[80:83], v[68:71], a[240:247], v1
ds_read_b64_tr_b16 v[44:45], v8 offset:9216
v_smfmac_f32_16x16x64_bf16 v[84:87], v[68:71], a[248:255], v1
ds_read_b64_tr_b16 v[46:47], v8 offset:9728
v_smfmac_f32_16x16x64_bf16 v[88:91], v[56:59], v[160:167], v1
ds_read_b64_tr_b16 v[72:73], v8 offset:10240
v_add_f32 v80, v80, v81
v_add_f32 v82, v82, v83
v_smfmac_f32_16x16x64_bf16 v[92:95], v[56:59], v[168:175], v1
ds_read_b64_tr_b16 v[74:75], v8 offset:10752
v_add_f32 v84, v84, v85
v_add_f32 v86, v86, v87
v_smfmac_f32_16x16x64_bf16 v[88:91], v[60:63], v[176:183], v1
ds_read_b64_tr_b16 v[76:77], v8 offset:11264
v_cvt_pk_bf16_f32 v36, v80, v82
v_cvt_pk_bf16_f32 v37, v84, v86
v_smfmac_f32_16x16x64_bf16 v[92:95], v[60:63], v[184:191], v1
ds_read_b64_tr_b16 v[78:79], v8 offset:11776
ds_write2_b32 v7, v36, v37 offset0:0 offset1:16
s_waitcnt lgkmcnt(7)
v_mfma_f32_16x16x32_bf16 v[56:59], v[96:99], v[40:43], 0
s_waitcnt lgkmcnt(5)
v_mfma_f32_16x16x32_bf16 v[56:59], v[104:107], v[44:47], v[56:59]
s_waitcnt lgkmcnt(3)
v_mfma_f32_16x16x32_bf16 v[56:59], v[112:115], v[72:75], v[56:59]
v_mov_b32_e64 v105, 0
v_mov_b32 v106, 0
s_waitcnt lgkmcnt(1)
v_mfma_f32_16x16x32_bf16 v[56:59], v[120:123], v[76:79], v[56:59]
v_mov_b64 v[112:113], s[6:7]
v_mov_b64 v[114:115], s[6:7]
v_mfma_f32_16x16x32_bf16 v[60:63], v[100:103], v[40:43], 0
s_waitcnt lgkmcnt(0)
s_barrier
ds_read_b64_tr_b16 v[80:81], v8 offset:12288
v_mfma_f32_16x16x32_bf16 v[60:63], v[108:111], v[44:47], v[60:63]
ds_read_b64_tr_b16 v[82:83], v8 offset:12800
v_exp_f32 v96, v56
v_mfma_f32_16x16x32_bf16 v[60:63], v[116:119], v[72:75], v[60:63]
ds_read_b64_tr_b16 v[84:85], v8 offset:13312
v_exp_f32 v97, v57
v_mov_b64 v[108:109], 0
v_mfma_f32_16x16x32_bf16 v[60:63], v[124:127], v[76:79], v[60:63]
ds_read_b64_tr_b16 v[86:87], v8 offset:13824
v_exp_f32 v98, v58
v_mov_b64 v[110:111], 0
v_smfmac_f32_16x16x64_bf16 v[88:91], v[64:67], v[192:199], v1
v_exp_f32 v99, v59
v_smfmac_f32_16x16x64_bf16 v[92:95], v[64:67], v[200:207], v1
v_exp_f32 v100, v60
s_waitcnt lgkmcnt(2)
v_smfmac_f32_16x16x64_bf16 v[108:111], v[80:83], v[40:47], v17
v_exp_f32 v101, v61
s_waitcnt lgkmcnt(0)
v_smfmac_f32_16x16x64_bf16 v[108:111], v[84:87], v[72:79], v17
ds_read_b128 v[40:43], v12 offset:16384
v_exp_f32 v102, v62
v_smfmac_f32_16x16x64_bf16 v[88:91], v[48:51], v[128:135], v1
ds_read_b128 v[44:47], v12 offset:17408
v_exp_f32 v103, v63
v_cvt_pk_bf16_f32 v96, v96, v97
v_smfmac_f32_16x16x64_bf16 v[92:95], v[48:51], v[136:143], v1
ds_read_b128 v[72:75], v12 offset:24576
v_add_f32 v108, v108, v110
v_add_f32 v109, v109, v111
v_smfmac_f32_16x16x64_bf16 v[88:91], v[52:55], v[144:151], v1
ds_read_b128 v[76:79], v12 offset:25600
v_mul_f32 v108, s24, v108
v_mul_f32 v109, s24, v109
v_smfmac_f32_16x16x64_bf16 v[88:91], v[68:71], v[208:215], v1
ds_read_b128 v[80:83], v12 offset:8192
v_exp_f32 v110, v108
v_cvt_pk_bf16_f32 v97, v98, v99
v_smfmac_f32_16x16x64_bf16 v[92:95], v[52:55], v[152:159], v1
ds_read_b128 v[84:87], v12 offset:9216
v_exp_f32 v111, v109
v_cvt_pk_bf16_f32 v98, v100, v101
v_smfmac_f32_16x16x64_bf16 v[92:95], v[68:71], v[216:223], v1
v_cvt_pk_bf16_f32 v99, v102, v103
v_add_f32 v88, v88, v89
v_add_f32 v90, v90, v91
v_mfma_f32_16x16x32_bf16 v[124:127], v[112:115], v[96:99], 0
v_cvt_pk_bf16_f32 v104, v110, v111
v_cvt_pk_bf16_f32 v107, v110, v111
v_mfma_f32_16x16x32_bf16 v[116:119], v[20:23], v[96:99], 0
v_cvt_pk_bf16_f32 v38, v88, v90
v_add_f32_e64 v92, v92, v93
v_mfma_f32_16x16x32_bf16 v[120:123], v[24:27], v[96:99], 0
v_add_f32_e64 v94, v94, v95
v_mov_b64_e64 v[48:49], 0
v_mfma_f32_16x16x16_bf16 v[124:127], v[112:113], v[104:105], v[124:127]
v_cvt_pk_bf16_f32 v39, v92, v94
v_mov_b64_e64 v[50:51], 0
v_mov_b64_e64 v[52:53], 0
v_mfma_f32_16x16x16_bf16 v[116:119], v[38:39], v[104:105], v[116:119]
v_mov_b64 v[54:55], 0
v_mov_b64 v[64:65], 0
v_mov_b64 v[66:67], 0
v_mfma_f32_16x16x16_bf16 v[120:123], v[38:39], v[106:107], v[120:123]
v_rcp_f32 v125, v124
v_subrev_u32 v19, s22, v124
v_cmp_lt_u32 vcc, s51, v19
L_smb_s0:
v_pk_mul_f32 v[116:117], v[116:117], v[124:125] op_sel:[0,1] op_sel_hi:[1,1]
v_pk_mul_f32 v[118:119], v[118:119], v[124:125] op_sel:[0,1] op_sel_hi:[1,1]
v_cvt_pk_bf16_f32 v88, v116, v117
v_cvt_pk_bf16_f32 v89, v118, v119
v_mov_b64_e64 v[68:69], 0
v_mov_b64 v[70:71], 0
v_pk_mul_f32 v[120:121], v[120:121], v[124:125] op_sel:[0,1] op_sel_hi:[1,1]
v_pk_mul_f32 v[122:123], v[122:123], v[124:125] op_sel:[0,1] op_sel_hi:[1,1]
v_cvt_pk_bf16_f32 v90, v120, v121
v_cvt_pk_bf16_f32 v91, v122, v123
s_cbranch_vccnz L_sms_s0
s_nop 0
v_smfmac_f32_16x16x64_bf16 v[48:51], v[88:91], v[224:231], v17
ds_write_b128 v13, v[88:91]
v_smfmac_f32_16x16x64_bf16 v[52:55], v[88:91], v[232:239], v17
ds_read_b128 v[56:59], v12 offset:18432
ds_read_b128 v[60:63], v12 offset:19456
v_xor_b32 v92, 512, v13
v_smfmac_f32_16x16x64_bf16 v[64:67], v[88:91], v[240:247], v17
ds_read_b128 v[96:99], v12 offset:26624
ds_read_b128 v[100:103], v12 offset:27648
v_xor_b32 v120, 1024, v13
v_smfmac_f32_16x16x64_bf16 v[68:71], v[88:91], v[248:255], v17
ds_read_b128 v[104:107], v12 offset:10240
ds_read_b128 v[108:111], v12 offset:11264
v_xor_b32 v124, 1536, v13
s_waitcnt lgkmcnt(6)
s_barrier
ds_read_b128 v[92:95], v92
ds_read_b128 v[120:123], v120
ds_read_b128 v[124:127], v124
ds_read_b128 v[20:23], v12 offset:20480
ds_read_b128 v[24:27], v12 offset:21504
ds_read_b128 v[112:115], v12 offset:28672
ds_read_b128 v[116:119], v12 offset:29696
s_waitcnt lgkmcnt(6)
v_smfmac_f32_16x16x64_bf16 v[48:51], v[92:95], v[40:47], v17
ds_read_b128 v[40:43], v12 offset:12288
s_waitcnt lgkmcnt(6)
v_smfmac_f32_16x16x64_bf16 v[48:51], v[120:123], v[72:79], v17
ds_read_b128 v[44:47], v12 offset:13312
s_waitcnt lgkmcnt(6)
v_smfmac_f32_16x16x64_bf16 v[48:51], v[124:127], v[80:87], v17
ds_read_b128 v[72:75], v12 offset:22528
s_waitcnt lgkmcnt(14)
v_smfmac_f32_16x16x64_bf16 v[52:55], v[92:95], v[56:63], v17
ds_read_b128 v[76:79], v12 offset:23552
s_waitcnt lgkmcnt(13)
v_smfmac_f32_16x16x64_bf16 v[52:55], v[120:123], v[96:103], v17
ds_read_b128 v[80:83], v12 offset:30720
v_cvt_pk_bf16_f32 v48, v48, v49
s_waitcnt lgkmcnt(12)
v_smfmac_f32_16x16x64_bf16 v[52:55], v[124:127], v[104:111], v17
ds_read_b128 v[84:87], v12 offset:31744
v_cvt_pk_bf16_f32 v49, v50, v51
v_bfi_b32 v48, 1, 1, v48
s_waitcnt lgkmcnt(8)
v_smfmac_f32_16x16x64_bf16 v[64:67], v[92:95], v[20:27], v17
global_store_dwordx2 v14, v[48:49], s[30:31]
ds_read_b128 v[56:59], v12 offset:14336
s_waitcnt lgkmcnt(7)
v_smfmac_f32_16x16x64_bf16 v[64:67], v[120:123], v[112:119], v17
v_cvt_pk_bf16_f32 v52, v52, v53
v_cvt_pk_bf16_f32 v53, v54, v55
v_bfi_b32 v52, 1, 1, v52
global_store_dwordx2 v14, v[52:53], s[32:33]
ds_read_b128 v[60:63], v12 offset:15360
s_waitcnt lgkmcnt(6)
v_smfmac_f32_16x16x64_bf16 v[64:67], v[124:127], v[40:47], v17
s_waitcnt lgkmcnt(4)
v_smfmac_f32_16x16x64_bf16 v[68:71], v[92:95], v[72:79], v17
s_waitcnt lgkmcnt(2)
v_smfmac_f32_16x16x64_bf16 v[68:71], v[120:123], v[80:87], v17
v_cvt_pk_bf16_f32 v64, v64, v65
v_cvt_pk_bf16_f32 v65, v66, v67
v_bfi_b32 v64, 1, 1, v64
s_waitcnt lgkmcnt(0)
v_smfmac_f32_16x16x64_bf16 v[68:71], v[124:127], v[56:63], v17
global_store_dwordx2 v14, v[64:65], s[52:53]
s_nop 6
v_cvt_pk_bf16_f32 v68, v68, v69
v_cvt_pk_bf16_f32 v69, v70, v71
v_bfi_b32 v68, 1, 1, v68
global_store_dwordx2 v14, v[68:69], s[54:55]
ds_read_b128 v[96:99], v12 offset:0
ds_read_b128 v[100:103], v12 offset:1024
ds_read_b128 v[104:107], v12 offset:2048
ds_read_b128 v[108:111], v12 offset:3072
ds_read_b128 v[112:115], v12 offset:4096
ds_read_b128 v[116:119], v12 offset:5120
ds_read_b128 v[120:123], v12 offset:6144
ds_read_b128 v[124:127], v12 offset:7168
s_add_u32 s40, s40, 262144
s_addc_u32 s41, s41, 0
s_add_u32 s42, s42, 131072
s_addc_u32 s43, s43, 0
s_mov_b32 s11, s23
s_cmp_lt_u32 s21, 2
s_cbranch_scc1 L_wd_r0
s_nop 7
s_nop 7
s_nop 6
s_nop 6
L_wd_r0:
s_nop 7
s_nop 6
global_load_dwordx4 v[48:51], v15, s[30:31] sc1
global_load_dwordx4 v[52:55], v15, s[30:31] offset:1024 sc1
s_mov_b32 s25, 0
v_cmp_eq_u32 vcc, 0, v0
s_nop 1
v_cndmask_b32 v60, 0, v11, vcc
v_cmp_eq_u32 vcc, 1, v0
s_nop 1
v_cndmask_b32 v61, 0, v11, vcc
v_cmp_eq_u32 vcc, 2, v0
s_nop 1
v_cndmask_b32 v62, 0, v11, vcc
v_cmp_eq_u32 vcc, 3, v0
s_nop 1
v_cndmask_b32 v63, 0, v11, vcc
v_mov_b64_e64 v[72:73], 0
v_mov_b64_e64 v[74:75], 0
v_mov_b64_e64 v[76:77], 0
v_mov_b64_e64 v[78:79], 0
v_mov_b64_e64 v[80:81], 0
v_mov_b64_e64 v[82:83], 0
v_mov_b64_e64 v[84:85], 0
v_mov_b64 v[86:87], 0
v_mov_b64 v[88:89], 0
v_mov_b64 v[90:91], 0
v_mov_b64 v[92:93], 0
v_mov_b64 v[94:95], 0
global_load_dwordx4 v[40:43], v15, s[30:31] sc1
global_load_dwordx4 v[44:47], v15, s[30:31] offset:1024 sc1
s_waitcnt vmcnt(2)
L_rchk0:
v_mfma_f32_16x16x32_bf16 v[68:71], v[48:51], v[60:63], 0
v_and_b32 v66, v48, v50
v_and_b32 v67, v52, v54
v_mfma_f32_16x16x32_bf16 v[68:71], v[52:55], v[60:63], v[68:71]
v_bitop3_b32 v66, v66, v67, 1 bitop3:0x80
v_cmp_ne_u32 vcc, 1, v66
s_cbranch_vccnz L_rre0
L_rok0:
v_mov_b32 v66, -1
s_nop 2
v_permlane32_swap_b32 v68, v69
v_permlane32_swap_b32 v70, v71
v_add_f32 v68, v68, v69
v_add_f32 v70, v70, v71
s_nop 1
v_permlane16_swap_b32 v68, v70
v_add_f32 v68, v68, v70
s_nop 1
v_mov_b32_dpp v69, v68 quad_perm:[2,3,0,1] row_mask:0xf bank_mask:0xf
v_cvt_pk_bf16_f32 v68, v68, v69
v_min_u32 v68, s50, v68
s_mov_b64 exec, s[46:47]
global_store_dword v16, v68, s[36:37]
global_store_dword v16, v66, s[34:35]
s_mov_b64 exec, -1
global_load_lds_dwordx4 v2, s[38:39] sc1
global_load_lds_dwordx4 v2, s[38:39] offset:1024 sc1
s_add_u32 s38, s38, 262144
s_addc_u32 s39, s39, 0
v_readfirstlane_b32 s14, v18
s_add_u32 s23, s23, 1
s_cmp_ge_u32 s23, 63
s_cbranch_scc1 L_steps_done
L_step1:
s_cmp_lt_u32 s21, 2
s_cbranch_scc0 L_wd_g1
s_nop 6
s_nop 5
s_nop 5
s_nop 5
L_wd_g1:
s_nop 2
s_nop 2
s_nop 2
s_nop 2
s_nop 2
s_nop 1
s_nop 1
s_nop 1
s_nop 1
s_nop 1
global_load_dwordx4 v[40:43], v2, s[36:37] sc1
s_cmp_gt_u32 s14, s17
s_cbranch_scc0 L_kvs_s1
L_kvb_s1:
s_mov_b32 s27, s14
s_mov_b32 s14, s15
s_mov_b32 s15, s27
s_add_u32 s18, s18, 4
s_and_b32 s27, s18, 127
s_cmp_eq_u32 s27, 8
s_cselect_b32 s27, 8, 0
s_sub_u32 s18, s18, s27
s_cmp_lg_u32 s27, 0
s_addc_u32 s17, s17, 0
s_mov_b32 s25, 0
s_waitcnt lgkmcnt(0)
s_nop 4
global_load_dwordx4 v[40:43], v2, s[36:37] sc1
s_nop 7
s_nop 6
global_load_dwordx4 v[44:47], v2, s[36:37] offset:1024 sc1
s_nop 7
s_nop 6
global_load_dwordx4 v[44:47], v2, s[36:37] offset:1024 sc1
L_gwait1:
s_waitcnt vmcnt(3)
v_max3_u32 v52, v40, v41, v42
v_max_u32_e64 v52, v52, v43
v_cmp_eq_u32 vcc, -1, v52
s_cbranch_vccnz L_gre1
L_gok1:
v_smfmac_f32_16x16x64_bf16 v[72:75], v[40:43], a[0:7], v1
ds_write_b128 v2, v[40:43]
v_smfmac_f32_16x16x64_bf16 v[76:79], v[40:43], a[8:15], v1
v_smfmac_f32_16x16x64_bf16 v[80:83], v[40:43], a[128:135], v1
v_smfmac_f32_16x16x64_bf16 v[84:87], v[40:43], a[136:143], v1
v_smfmac_f32_16x16x64_bf16 v[88:91], v[40:43], v[96:103], v1
v_smfmac_f32_16x16x64_bf16 v[92:95], v[40:43], v[104:111], v1
s_waitcnt vmcnt(1)
v_max3_u32 v52, v44, v45, v46
v_max_u32_e64 v52, v52, v47
v_cmp_eq_u32 vcc, -1, v52
s_cbranch_vccnz L_hre1
L_hok1:
ds_write_b128 v2, v[44:47] offset:1024
v_smfmac_f32_16x16x64_bf16 v[72:75], v[44:47], a[16:23], v1
global_store_dwordx4 v10, v[36:39], s[42:43] sc1
v_smfmac_f32_16x16x64_bf16 v[76:79], v[44:47], a[24:31], v1
v_smfmac_f32_16x16x64_bf16 v[80:83], v[44:47], a[144:151], v1
s_waitcnt lgkmcnt(0)
s_barrier
ds_read_b128 v[48:51], v3 offset:0
v_smfmac_f32_16x16x64_bf16 v[84:87], v[44:47], a[152:159], v1
ds_read_b128 v[52:55], v3 offset:1024
v_smfmac_f32_16x16x64_bf16 v[88:91], v[44:47], v[112:119], v1
ds_read_b128 v[56:59], v4 offset:0
v_smfmac_f32_16x16x64_bf16 v[92:95], v[44:47], v[120:127], v1
ds_read_b128 v[60:63], v4 offset:1024
ds_read_b128 v[64:67], v5 offset:0
ds_read_b128 v[68:71], v5 offset:1024
s_waitcnt lgkmcnt(5)
v_smfmac_f32_16x16x64_bf16 v[72:75], v[48:51], a[32:39], v1
v_mov_b32 v19, s11
v_smfmac_f32_16x16x64_bf16 v[76:79], v[48:51], a[40:47], v1
s_waitcnt lgkmcnt(4)
global_load_dword v18, v9, s[38:39] sc1
v_smfmac_f32_16x16x64_bf16 v[72:75], v[52:55], a[48:55], v1
v_smfmac_f32_16x16x64_bf16 v[76:79], v[52:55], a[56:63], v1
s_waitcnt lgkmcnt(3)
v_smfmac_f32_16x16x64_bf16 v[72:75], v[56:59], a[64:71], v1
ds_read_b128 v[96:99], v10 offset:16384
v_smfmac_f32_16x16x64_bf16 v[76:79], v[56:59], a[72:79], v1
ds_read_b128 v[104:107], v10 offset:17408
s_waitcnt lgkmcnt(4)
v_smfmac_f32_16x16x64_bf16 v[72:75], v[60:63], a[80:87], v1
ds_read_b128 v[112:115], v10 offset:18432
global_load_dwordx4 v[20:23], v2, s[40:41] sc1
v_smfmac_f32_16x16x64_bf16 v[76:79], v[60:63], a[88:95], v1
ds_read_b128 v[120:123], v10 offset:19456
s_waitcnt lgkmcnt(5)
v_smfmac_f32_16x16x64_bf16 v[72:75], v[64:67], a[96:103], v1
ds_read_b128 v[100:103], v10 offset:20480
v_smfmac_f32_16x16x64_bf16 v[76:79], v[64:67], a[104:111], v1
ds_read_b128 v[108:111], v10 offset:21504
s_waitcnt lgkmcnt(6)
v_smfmac_f32_16x16x64_bf16 v[72:75], v[68:71], a[112:119], v1
ds_read_b128 v[116:119], v10 offset:22528
global_load_dwordx4 v[24:27], v2, s[40:41] offset:1024 sc1
v_smfmac_f32_16x16x64_bf16 v[76:79], v[68:71], a[120:127], v1
ds_read_b128 v[124:127], v10 offset:23552
v_smfmac_f32_16x16x64_bf16 v[80:83], v[48:51], a[160:167], v1
v_add_f32 v72, v72, v73
v_add_f32 v74, v74, v75
v_smfmac_f32_16x16x64_bf16 v[84:87], v[48:51], a[168:175], v1
v_add_f32 v76, v76, v77
v_add_f32 v78, v78, v79
v_cvt_pk_bf16_f32 v73, v72, v74
v_smfmac_f32_16x16x64_bf16 v[80:83], v[52:55], a[176:183], v1
v_cvt_pk_bf16_f32 v72, v72, v74
v_cvt_pk_bf16_f32 v77, v76, v78
v_smfmac_f32_16x16x64_bf16 v[84:87], v[52:55], a[184:191], v1
ds_write_b64 v6, v[72:73] offset:0
v_cvt_pk_bf16_f32 v76, v76, v78
v_smfmac_f32_16x16x64_bf16 v[80:83], v[56:59], a[192:199], v1
ds_write_b64 v6, v[76:77] offset:512
v_smfmac_f32_16x16x64_bf16 v[84:87], v[56:59], a[200:207], v1
s_mov_b64 exec, 1
v_smfmac_f32_16x16x64_bf16 v[80:83], v[60:63], a[208:215], v1
global_store_dword v10, v19, s[56:57] sc1
global_load_dword v18, v10, s[2:3] offset:4 sc1
v_smfmac_f32_16x16x64_bf16 v[84:87], v[60:63], a[216:223], v1
s_mov_b64 exec, -1
s_waitcnt vmcnt(6) lgkmcnt(0)
v_smfmac_f32_16x16x64_bf16 v[80:83], v[64:67], a[224:231], v1
s_barrier
ds_read_b64_tr_b16 v[40:41], v8 offset:8192
v_smfmac_f32_16x16x64_bf16 v[84:87], v[64:67], a[232:239], v1
ds_read_b64_tr_b16 v[42:43], v8 offset:8704
v_smfmac_f32_16x16x64_bf16 v[80:83], v[68:71], a[240:247], v1
ds_read_b64_tr_b16 v[44:45], v8 offset:9216
v_smfmac_f32_16x16x64_bf16 v[84:87], v[68:71], a[248:255], v1
ds_read_b64_tr_b16 v[46:47], v8 offset:9728
v_smfmac_f32_16x16x64_bf16 v[88:91], v[56:59], v[160:167], v1
ds_read_b64_tr_b16 v[72:73], v8 offset:10240
v_add_f32 v80, v80, v81
v_add_f32 v82, v82, v83
v_smfmac_f32_16x16x64_bf16 v[92:95], v[56:59], v[168:175], v1
ds_read_b64_tr_b16 v[74:75], v8 offset:10752
v_add_f32 v84, v84, v85
v_add_f32 v86, v86, v87
v_smfmac_f32_16x16x64_bf16 v[88:91], v[60:63], v[176:183], v1
ds_read_b64_tr_b16 v[76:77], v8 offset:11264
v_cvt_pk_bf16_f32 v36, v80, v82
v_cvt_pk_bf16_f32 v37, v84, v86
v_smfmac_f32_16x16x64_bf16 v[92:95], v[60:63], v[184:191], v1
ds_read_b64_tr_b16 v[78:79], v8 offset:11776
ds_write2_b32 v7, v36, v37 offset0:0 offset1:16
s_waitcnt lgkmcnt(7)
v_mfma_f32_16x16x32_bf16 v[56:59], v[96:99], v[40:43], 0
s_waitcnt lgkmcnt(5)
v_mfma_f32_16x16x32_bf16 v[56:59], v[104:107], v[44:47], v[56:59]
s_waitcnt lgkmcnt(3)
v_mfma_f32_16x16x32_bf16 v[56:59], v[112:115], v[72:75], v[56:59]
v_mov_b32_e64 v105, 0
v_mov_b32 v106, 0
s_waitcnt lgkmcnt(1)
v_mfma_f32_16x16x32_bf16 v[56:59], v[120:123], v[76:79], v[56:59]
v_mov_b64 v[112:113], s[6:7]
v_mov_b64 v[114:115], s[6:7]
v_mfma_f32_16x16x32_bf16 v[60:63], v[100:103], v[40:43], 0
s_waitcnt lgkmcnt(0)
s_barrier
ds_read_b64_tr_b16 v[80:81], v8 offset:12288
v_mfma_f32_16x16x32_bf16 v[60:63], v[108:111], v[44:47], v[60:63]
ds_read_b64_tr_b16 v[82:83], v8 offset:12800
v_exp_f32 v96, v56
v_mfma_f32_16x16x32_bf16 v[60:63], v[116:119], v[72:75], v[60:63]
ds_read_b64_tr_b16 v[84:85], v8 offset:13312
v_exp_f32 v97, v57
v_mov_b64 v[108:109], 0
v_mfma_f32_16x16x32_bf16 v[60:63], v[124:127], v[76:79], v[60:63]
ds_read_b64_tr_b16 v[86:87], v8 offset:13824
v_exp_f32 v98, v58
v_mov_b64 v[110:111], 0
v_smfmac_f32_16x16x64_bf16 v[88:91], v[64:67], v[192:199], v1
v_exp_f32 v99, v59
v_smfmac_f32_16x16x64_bf16 v[92:95], v[64:67], v[200:207], v1
v_exp_f32 v100, v60
s_waitcnt lgkmcnt(2)
v_smfmac_f32_16x16x64_bf16 v[108:111], v[80:83], v[40:47], v17
v_exp_f32 v101, v61
s_waitcnt lgkmcnt(0)
v_smfmac_f32_16x16x64_bf16 v[108:111], v[84:87], v[72:79], v17
ds_read_b128 v[40:43], v12 offset:16384
v_exp_f32 v102, v62
v_smfmac_f32_16x16x64_bf16 v[88:91], v[48:51], v[128:135], v1
ds_read_b128 v[44:47], v12 offset:17408
v_exp_f32 v103, v63
v_cvt_pk_bf16_f32 v96, v96, v97
v_smfmac_f32_16x16x64_bf16 v[92:95], v[48:51], v[136:143], v1
ds_read_b128 v[72:75], v12 offset:24576
v_add_f32 v108, v108, v110
v_add_f32 v109, v109, v111
v_smfmac_f32_16x16x64_bf16 v[88:91], v[52:55], v[144:151], v1
ds_read_b128 v[76:79], v12 offset:25600
v_mul_f32 v108, s24, v108
v_mul_f32 v109, s24, v109
v_smfmac_f32_16x16x64_bf16 v[88:91], v[68:71], v[208:215], v1
ds_read_b128 v[80:83], v12 offset:8192
v_exp_f32 v110, v108
v_cvt_pk_bf16_f32 v97, v98, v99
v_smfmac_f32_16x16x64_bf16 v[92:95], v[52:55], v[152:159], v1
ds_read_b128 v[84:87], v12 offset:9216
v_exp_f32 v111, v109
v_cvt_pk_bf16_f32 v98, v100, v101
v_smfmac_f32_16x16x64_bf16 v[92:95], v[68:71], v[216:223], v1
v_cvt_pk_bf16_f32 v99, v102, v103
v_add_f32 v88, v88, v89
v_add_f32 v90, v90, v91
v_mfma_f32_16x16x32_bf16 v[124:127], v[112:115], v[96:99], 0
v_cvt_pk_bf16_f32 v104, v110, v111
v_cvt_pk_bf16_f32 v107, v110, v111
v_mfma_f32_16x16x32_bf16 v[116:119], v[28:31], v[96:99], 0
v_cvt_pk_bf16_f32 v38, v88, v90
v_add_f32_e64 v92, v92, v93
v_mfma_f32_16x16x32_bf16 v[120:123], v[32:35], v[96:99], 0
v_add_f32_e64 v94, v94, v95
v_mov_b64_e64 v[48:49], 0
v_mfma_f32_16x16x16_bf16 v[124:127], v[112:113], v[104:105], v[124:127]
v_cvt_pk_bf16_f32 v39, v92, v94
v_mov_b64_e64 v[50:51], 0
v_mov_b64_e64 v[52:53], 0
v_mfma_f32_16x16x16_bf16 v[116:119], v[38:39], v[104:105], v[116:119]
v_mov_b64 v[54:55], 0
v_mov_b64 v[64:65], 0
v_mov_b64 v[66:67], 0
v_mfma_f32_16x16x16_bf16 v[120:123], v[38:39], v[106:107], v[120:123]
v_rcp_f32 v125, v124
v_subrev_u32 v19, s22, v124
v_cmp_lt_u32 vcc, s51, v19
L_smb_s1:
v_pk_mul_f32 v[116:117], v[116:117], v[124:125] op_sel:[0,1] op_sel_hi:[1,1]
v_pk_mul_f32 v[118:119], v[118:119], v[124:125] op_sel:[0,1] op_sel_hi:[1,1]
v_cvt_pk_bf16_f32 v88, v116, v117
v_cvt_pk_bf16_f32 v89, v118, v119
v_mov_b64_e64 v[68:69], 0
v_mov_b64 v[70:71], 0
v_pk_mul_f32 v[120:121], v[120:121], v[124:125] op_sel:[0,1] op_sel_hi:[1,1]
v_pk_mul_f32 v[122:123], v[122:123], v[124:125] op_sel:[0,1] op_sel_hi:[1,1]
v_cvt_pk_bf16_f32 v90, v120, v121
v_cvt_pk_bf16_f32 v91, v122, v123
s_cbranch_vccnz L_sms_s1
s_nop 0
v_smfmac_f32_16x16x64_bf16 v[48:51], v[88:91], v[224:231], v17
ds_write_b128 v13, v[88:91]
v_smfmac_f32_16x16x64_bf16 v[52:55], v[88:91], v[232:239], v17
ds_read_b128 v[56:59], v12 offset:18432
ds_read_b128 v[60:63], v12 offset:19456
v_xor_b32 v92, 512, v13
v_smfmac_f32_16x16x64_bf16 v[64:67], v[88:91], v[240:247], v17
ds_read_b128 v[96:99], v12 offset:26624
ds_read_b128 v[100:103], v12 offset:27648
v_xor_b32 v120, 1024, v13
v_smfmac_f32_16x16x64_bf16 v[68:71], v[88:91], v[248:255], v17
ds_read_b128 v[104:107], v12 offset:10240
ds_read_b128 v[108:111], v12 offset:11264
v_xor_b32 v124, 1536, v13
s_waitcnt lgkmcnt(6)
s_barrier
ds_read_b128 v[92:95], v92
ds_read_b128 v[120:123], v120
ds_read_b128 v[124:127], v124
ds_read_b128 v[28:31], v12 offset:20480
ds_read_b128 v[32:35], v12 offset:21504
ds_read_b128 v[112:115], v12 offset:28672
ds_read_b128 v[116:119], v12 offset:29696
s_waitcnt lgkmcnt(6)
v_smfmac_f32_16x16x64_bf16 v[48:51], v[92:95], v[40:47], v17
ds_read_b128 v[40:43], v12 offset:12288
s_waitcnt lgkmcnt(6)
v_smfmac_f32_16x16x64_bf16 v[48:51], v[120:123], v[72:79], v17
ds_read_b128 v[44:47], v12 offset:13312
s_waitcnt lgkmcnt(6)
v_smfmac_f32_16x16x64_bf16 v[48:51], v[124:127], v[80:87], v17
ds_read_b128 v[72:75], v12 offset:22528
s_waitcnt lgkmcnt(14)
v_smfmac_f32_16x16x64_bf16 v[52:55], v[92:95], v[56:63], v17
ds_read_b128 v[76:79], v12 offset:23552
s_waitcnt lgkmcnt(13)
v_smfmac_f32_16x16x64_bf16 v[52:55], v[120:123], v[96:103], v17
ds_read_b128 v[80:83], v12 offset:30720
v_cvt_pk_bf16_f32 v48, v48, v49
s_waitcnt lgkmcnt(12)
v_smfmac_f32_16x16x64_bf16 v[52:55], v[124:127], v[104:111], v17
ds_read_b128 v[84:87], v12 offset:31744
v_cvt_pk_bf16_f32 v49, v50, v51
v_bfi_b32 v48, 1, 0, v48
s_waitcnt lgkmcnt(8)
v_smfmac_f32_16x16x64_bf16 v[64:67], v[92:95], v[28:35], v17
global_store_dwordx2 v14, v[48:49], s[30:31]
ds_read_b128 v[56:59], v12 offset:14336
s_waitcnt lgkmcnt(7)
v_smfmac_f32_16x16x64_bf16 v[64:67], v[120:123], v[112:119], v17
v_cvt_pk_bf16_f32 v52, v52, v53
v_cvt_pk_bf16_f32 v53, v54, v55
v_bfi_b32 v52, 1, 0, v52
global_store_dwordx2 v14, v[52:53], s[32:33]
ds_read_b128 v[60:63], v12 offset:15360
s_waitcnt lgkmcnt(6)
v_smfmac_f32_16x16x64_bf16 v[64:67], v[124:127], v[40:47], v17
s_waitcnt lgkmcnt(4)
v_smfmac_f32_16x16x64_bf16 v[68:71], v[92:95], v[72:79], v17
s_waitcnt lgkmcnt(2)
v_smfmac_f32_16x16x64_bf16 v[68:71], v[120:123], v[80:87], v17
v_cvt_pk_bf16_f32 v64, v64, v65
v_cvt_pk_bf16_f32 v65, v66, v67
v_bfi_b32 v64, 1, 0, v64
s_waitcnt lgkmcnt(0)
v_smfmac_f32_16x16x64_bf16 v[68:71], v[124:127], v[56:63], v17
global_store_dwordx2 v14, v[64:65], s[52:53]
s_nop 6
v_cvt_pk_bf16_f32 v68, v68, v69
v_cvt_pk_bf16_f32 v69, v70, v71
v_bfi_b32 v68, 1, 0, v68
global_store_dwordx2 v14, v[68:69], s[54:55]
ds_read_b128 v[96:99], v12 offset:0
ds_read_b128 v[100:103], v12 offset:1024
ds_read_b128 v[104:107], v12 offset:2048
ds_read_b128 v[108:111], v12 offset:3072
ds_read_b128 v[112:115], v12 offset:4096
ds_read_b128 v[116:119], v12 offset:5120
ds_read_b128 v[120:123], v12 offset:6144
ds_read_b128 v[124:127], v12 offset:7168
s_add_u32 s40, s40, 262144
s_addc_u32 s41, s41, 0
s_add_u32 s42, s42, 131072
s_addc_u32 s43, s43, 0
s_mov_b32 s11, s23
s_cmp_lt_u32 s21, 2
s_cbranch_scc1 L_wd_r1
s_nop 7
s_nop 7
s_nop 6
s_nop 6
L_wd_r1:
s_nop 7
s_nop 6
global_load_dwordx4 v[48:51], v15, s[30:31] sc1
global_load_dwordx4 v[52:55], v15, s[30:31] offset:1024 sc1
s_mov_b32 s25, 0
v_cmp_eq_u32 vcc, 0, v0
s_nop 1
v_cndmask_b32 v60, 0, v11, vcc
v_cmp_eq_u32 vcc, 1, v0
s_nop 1
v_cndmask_b32 v61, 0, v11, vcc
v_cmp_eq_u32 vcc, 2, v0
s_nop 1
v_cndmask_b32 v62, 0, v11, vcc
v_cmp_eq_u32 vcc, 3, v0
s_nop 1
v_cndmask_b32 v63, 0, v11, vcc
v_mov_b64_e64 v[72:73], 0
v_mov_b64_e64 v[74:75], 0
v_mov_b64_e64 v[76:77], 0
v_mov_b64_e64 v[78:79], 0
v_mov_b64_e64 v[80:81], 0
v_mov_b64_e64 v[82:83], 0
v_mov_b64_e64 v[84:85], 0
v_mov_b64 v[86:87], 0
v_mov_b64 v[88:89], 0
v_mov_b64 v[90:91], 0
v_mov_b64 v[92:93], 0
v_mov_b64 v[94:95], 0
global_load_dwordx4 v[40:43], v15, s[30:31] sc1
global_load_dwordx4 v[44:47], v15, s[30:31] offset:1024 sc1
s_waitcnt vmcnt(2)
L_rchk1:
v_mfma_f32_16x16x32_bf16 v[68:71], v[48:51], v[60:63], 0
v_or_b32 v66, v48, v50
v_or3_b32 v67, v52, v54, v66
v_mfma_f32_16x16x32_bf16 v[68:71], v[52:55], v[60:63], v[68:71]
v_and_b32 v66, 1, v67
v_cmp_ne_u32 vcc, 0, v66
s_cbranch_vccnz L_rre1
L_rok1:
v_mov_b32 v66, -1
s_nop 2
v_permlane32_swap_b32 v68, v69
v_permlane32_swap_b32 v70, v71
v_add_f32 v68, v68, v69
v_add_f32 v70, v70, v71
s_nop 1
v_permlane16_swap_b32 v68, v70
v_add_f32 v68, v68, v70
s_nop 1
v_mov_b32_dpp v69, v68 quad_perm:[2,3,0,1] row_mask:0xf bank_mask:0xf
v_cvt_pk_bf16_f32 v68, v68, v69
v_min_u32 v68, s50, v68
s_mov_b64 exec, s[46:47]
global_store_dword v16, v68, s[34:35]
global_store_dword v16, v66, s[36:37]
s_mov_b64 exec, -1
global_load_lds_dwordx4 v2, s[38:39] sc1
global_load_lds_dwordx4 v2, s[38:39] offset:1024 sc1
s_add_u32 s38, s38, 262144
s_addc_u32 s39, s39, 0
v_readfirstlane_b32 s14, v18
s_add_u32 s23, s23, 1
s_branch L_step0
L_steps_done:
s_mov_b32 s25, 0
s_waitcnt lgkmcnt(0)
s_cmp_lt_u32 s21, 2
s_cbranch_scc0 L_wd_z
s_nop 7
s_nop 7
s_nop 7
L_wd_z:
s_nop 7
s_nop 7
s_nop 7
s_nop 7
s_nop 7
s_nop 7
L_gpoll_z:
global_load_dwordx4 v[40:43], v2, s[36:37] offset:0 sc1
global_load_dwordx4 v[44:47], v2, s[36:37] offset:1024 sc1
s_add_u32 s25, s25, 1
s_cmp_gt_u32 s25, 1048576
s_cbranch_scc1 L_fail
s_waitcnt vmcnt(0)
v_max3_u32 v52, v40, v41, v42
v_max3_u32 v53, v43, v44, v45
v_max3_u32 v52, v52, v46, v47
v_max_u32 v52, v52, v53
v_cmp_eq_u32 vcc, -1, v52
s_cbranch_vccnz L_gpoll_z
ds_write_b128 v2, v[40:43]
ds_write_b128 v2, v[44:47] offset:1024
v_smfmac_f32_16x16x64_bf16 v[80:83], v[40:43], a[128:135], v1
global_store_dwordx4 v10, v[36:39], s[42:43] sc1
s_add_u32 s42, s42, 131072
s_addc_u32 s43, s43, 0
v_smfmac_f32_16x16x64_bf16 v[84:87], v[40:43], a[136:143], v1
s_waitcnt lgkmcnt(0)
s_barrier
ds_read_b128 v[48:51], v3 offset:0
ds_read_b128 v[52:55], v3 offset:1024
ds_read_b128 v[56:59], v4 offset:0
ds_read_b128 v[60:63], v4 offset:1024
ds_read_b128 v[64:67], v5 offset:0
ds_read_b128 v[68:71], v5 offset:1024
v_mov_b32 v19, s11
s_mov_b64 exec, 1
global_store_dword v10, v19, s[56:57] sc1
s_mov_b64 exec, -1
v_smfmac_f32_16x16x64_bf16 v[80:83], v[44:47], a[144:151], v1
v_smfmac_f32_16x16x64_bf16 v[84:87], v[44:47], a[152:159], v1
v_smfmac_f32_16x16x64_bf16 v[88:91], v[40:43], v[96:103], v1
v_smfmac_f32_16x16x64_bf16 v[92:95], v[40:43], v[104:111], v1
v_smfmac_f32_16x16x64_bf16 v[88:91], v[44:47], v[112:119], v1
v_smfmac_f32_16x16x64_bf16 v[92:95], v[44:47], v[120:127], v1
s_waitcnt lgkmcnt(5)
v_smfmac_f32_16x16x64_bf16 v[80:83], v[48:51], a[160:167], v1
v_smfmac_f32_16x16x64_bf16 v[84:87], v[48:51], a[168:175], v1
s_waitcnt lgkmcnt(4)
v_smfmac_f32_16x16x64_bf16 v[80:83], v[52:55], a[176:183], v1
v_smfmac_f32_16x16x64_bf16 v[84:87], v[52:55], a[184:191], v1
s_waitcnt lgkmcnt(3)
v_smfmac_f32_16x16x64_bf16 v[80:83], v[56:59], a[192:199], v1
v_smfmac_f32_16x16x64_bf16 v[84:87], v[56:59], a[200:207], v1
s_waitcnt lgkmcnt(2)
v_smfmac_f32_16x16x64_bf16 v[80:83], v[60:63], a[208:215], v1
v_smfmac_f32_16x16x64_bf16 v[84:87], v[60:63], a[216:223], v1
s_waitcnt lgkmcnt(1)
v_smfmac_f32_16x16x64_bf16 v[80:83], v[64:67], a[224:231], v1
v_smfmac_f32_16x16x64_bf16 v[84:87], v[64:67], a[232:239], v1
s_waitcnt lgkmcnt(0)
v_smfmac_f32_16x16x64_bf16 v[80:83], v[68:71], a[240:247], v1
v_smfmac_f32_16x16x64_bf16 v[84:87], v[68:71], a[248:255], v1
v_smfmac_f32_16x16x64_bf16 v[88:91], v[48:51], v[128:135], v1
v_smfmac_f32_16x16x64_bf16 v[92:95], v[48:51], v[136:143], v1
v_smfmac_f32_16x16x64_bf16 v[88:91], v[52:55], v[144:151], v1
v_smfmac_f32_16x16x64_bf16 v[92:95], v[52:55], v[152:159], v1
v_smfmac_f32_16x16x64_bf16 v[88:91], v[56:59], v[160:167], v1
v_smfmac_f32_16x16x64_bf16 v[92:95], v[56:59], v[168:175], v1
v_smfmac_f32_16x16x64_bf16 v[88:91], v[60:63], v[176:183], v1
v_smfmac_f32_16x16x64_bf16 v[92:95], v[60:63], v[184:191], v1
v_smfmac_f32_16x16x64_bf16 v[88:91], v[64:67], v[192:199], v1
v_smfmac_f32_16x16x64_bf16 v[92:95], v[64:67], v[200:207], v1
v_smfmac_f32_16x16x64_bf16 v[88:91], v[68:71], v[208:215], v1
v_smfmac_f32_16x16x64_bf16 v[92:95], v[68:71], v[216:223], v1
v_add_f32 v80, v80, v81
v_add_f32 v82, v82, v83
v_cvt_pk_bf16_f32 v36, v80, v82
v_add_f32 v84, v84, v85
v_add_f32 v86, v86, v87
v_cvt_pk_bf16_f32 v37, v84, v86
v_add_f32 v88, v88, v89
v_add_f32 v90, v90, v91
v_cvt_pk_bf16_f32 v38, v88, v90
v_add_f32 v92, v92, v93
v_add_f32 v94, v94, v95
v_cvt_pk_bf16_f32 v39, v92, v94
global_store_dwordx4 v10, v[36:39], s[42:43] sc1
s_add_u32 s23, s23, 1
v_mov_b32 v19, s23
s_waitcnt vmcnt(0)
s_barrier
s_mov_b64 exec, 1
global_store_dword v10, v19, s[56:57] sc1
s_mov_b64 exec, -1
s_branch L_cfin
L_fail:
s_mov_b32 s26, 1
L_cfin:
s_waitcnt vmcnt(0)
s_endpgm
L_kvs_first:
s_nop 7
s_mov_b32 s25, 0
L_kvp_first:
v_mov_b32 v19, s18
global_load_dword v19, v19, s[48:49] sc1
s_add_u32 s25, s25, 1
s_cmp_gt_u32 s25, 1048576
s_cbranch_scc1 L_fail
s_waitcnt vmcnt(0)
v_readfirstlane_b32 s14, v19
s_cmp_gt_u32 s14, s17
s_cbranch_scc1 L_kvb_first
s_sleep 4
s_branch L_kvp_first
L_kvs_s0:
s_nop 7
s_mov_b32 s25, 0
L_kvp_s0:
v_mov_b32 v19, s18
global_load_dword v19, v19, s[48:49] sc1
s_add_u32 s25, s25, 1
s_cmp_gt_u32 s25, 1048576
s_cbranch_scc1 L_fail
s_waitcnt vmcnt(0)
v_readfirstlane_b32 s14, v19
s_cmp_gt_u32 s14, s17
s_cbranch_scc1 L_kvb_s0
s_sleep 4
s_branch L_kvp_s0
L_gre0:
s_mov_b64 exec, vcc
global_load_dwordx4 v[40:43], v2, s[34:35] sc1
s_mov_b64 exec, -1
global_load_dwordx4 v[44:47], v2, s[34:35] offset:1024 sc1
s_waitcnt vmcnt(4)
v_max3_u32 v52, v40, v41, v42
v_max_u32 v52, v52, v43
v_cmp_eq_u32 vcc, -1, v52
s_cbranch_vccz L_gok0
L_gre20:
s_mov_b64 exec, vcc
global_load_dwordx4 v[40:43], v2, s[34:35] sc1
s_mov_b64 exec, -1
global_load_dwordx4 v[44:47], v2, s[34:35] offset:1024 sc1
s_add_u32 s25, s25, 1
s_cmp_gt_u32 s25, 1048576
s_cbranch_scc1 L_fail
s_waitcnt vmcnt(3)
v_max3_u32 v52, v40, v41, v42
v_max_u32 v52, v52, v43
v_cmp_eq_u32 vcc, -1, v52
s_cbranch_vccnz L_gre20
s_branch L_gok0
L_hre0:
s_mov_b64 exec, vcc
global_load_dwordx4 v[44:47], v2, s[34:35] offset:1024 sc1
s_mov_b64 exec, -1
s_add_u32 s25, s25, 1
s_cmp_gt_u32 s25, 1048576
s_cbranch_scc1 L_fail
s_waitcnt vmcnt(1)
v_max3_u32 v52, v44, v45, v46
v_max_u32 v52, v52, v47
v_cmp_eq_u32 vcc, -1, v52
s_cbranch_vccnz L_hre0
s_branch L_hok0
L_sms_s0:
s_nop 7
v_max3_f32 v92, v56, v57, v58
v_max3_f32 v93, v59, v60, v61
v_max3_f32 v19, v62, v63, v108
v_max3_f32 v92, v92, v93, v109
v_max_f32 v92, v92, v19
v_mov_b32 v93, v92
s_nop 1
v_permlane32_swap_b32 v92, v93
v_max_f32 v92, v92, v93
v_mov_b32 v93, v92
s_nop 1
v_permlane16_swap_b32 v92, v93
v_max_f32 v92, v92, v93
v_sub_f32 v96, v56, v92
v_sub_f32 v97, v57, v92
v_sub_f32 v98, v58, v92
v_sub_f32 v99, v59, v92
v_sub_f32 v100, v60, v92
v_sub_f32 v101, v61, v92
v_sub_f32 v102, v62, v92
v_sub_f32 v103, v63, v92
v_sub_f32 v110, v108, v92
v_sub_f32 v111, v109, v92
v_exp_f32 v96, v96
v_exp_f32 v97, v97
v_exp_f32 v98, v98
v_exp_f32 v99, v99
v_exp_f32 v100, v100
v_exp_f32 v101, v101
v_exp_f32 v102, v102
v_exp_f32 v103, v103
v_exp_f32 v110, v110
v_exp_f32 v111, v111
v_cvt_pk_bf16_f32 v96, v96, v97
v_cvt_pk_bf16_f32 v97, v98, v99
v_cvt_pk_bf16_f32 v98, v100, v101
v_cvt_pk_bf16_f32 v99, v102, v103
v_cvt_pk_bf16_f32 v104, v110, v111
v_cvt_pk_bf16_f32 v107, v110, v111
v_mfma_f32_16x16x32_bf16 v[124:127], v[112:115], v[96:99], 0
v_mfma_f32_16x16x32_bf16 v[116:119], v[20:23], v[96:99], 0
v_mfma_f32_16x16x32_bf16 v[120:123], v[24:27], v[96:99], 0
v_mfma_f32_16x16x16_bf16 v[124:127], v[112:113], v[104:105], v[124:127]
v_mfma_f32_16x16x16_bf16 v[116:119], v[38:39], v[104:105], v[116:119]
v_mfma_f32_16x16x16_bf16 v[120:123], v[38:39], v[106:107], v[120:123]
v_rcp_f32 v125, v124
s_mov_b64 vcc, 0
s_branch L_smb_s0
L_rre0:
s_mov_b64 s[4:5], vcc
s_mov_b64 exec, s[4:5]
global_load_dwordx4 v[48:51], v15, s[30:31] sc1
global_load_dwordx4 v[52:55], v15, s[30:31] offset:1024 sc1
s_mov_b64 exec, -1
s_waitcnt vmcnt(2)
s_nop 1
v_mfma_f32_16x16x32_bf16 v[68:71], v[40:43], v[60:63], 0
v_and_b32 v66, v40, v42
v_and_b32 v67, v44, v46
v_mfma_f32_16x16x32_bf16 v[68:71], v[44:47], v[60:63], v[68:71]
v_bitop3_b32 v66, v66, v67, 1 bitop3:0x80
v_cmp_ne_u32 vcc, 1, v66
s_cbranch_vccz L_rok0
L_rre20:
s_mov_b64 exec, s[4:5]
global_load_dwordx4 v[48:51], v15, s[30:31] sc1
global_load_dwordx4 v[52:55], v15, s[30:31] offset:1024 sc1
s_mov_b64 exec, -1
s_add_u32 s25, s25, 1
s_cmp_gt_u32 s25, 1048576
s_cbranch_scc1 L_fail
s_waitcnt vmcnt(2)
v_and_b32 v66, v48, v50
v_and_b32 v67, v52, v54
v_bitop3_b32 v66, v66, v67, 1 bitop3:0x80
v_cmp_ne_u32 vcc, 1, v66
s_nop 4
s_mov_b64 s[4:5], vcc
s_cbranch_vccnz L_rre20
s_branch L_rchk0
L_kvs_s1:
s_nop 7
s_mov_b32 s25, 0
L_kvp_s1:
v_mov_b32 v19, s18
global_load_dword v19, v19, s[48:49] sc1
s_add_u32 s25, s25, 1
s_cmp_gt_u32 s25, 1048576
s_cbranch_scc1 L_fail
s_waitcnt vmcnt(0)
v_readfirstlane_b32 s14, v19
s_cmp_gt_u32 s14, s17
s_cbranch_scc1 L_kvb_s1
s_sleep 4
s_branch L_kvp_s1
L_gre1:
s_mov_b64 exec, vcc
global_load_dwordx4 v[40:43], v2, s[36:37] sc1
s_mov_b64 exec, -1
global_load_dwordx4 v[44:47], v2, s[36:37] offset:1024 sc1
s_waitcnt vmcnt(4)
v_max3_u32 v52, v40, v41, v42
v_max_u32 v52, v52, v43
v_cmp_eq_u32 vcc, -1, v52
s_cbranch_vccz L_gok1
L_gre21:
s_mov_b64 exec, vcc
global_load_dwordx4 v[40:43], v2, s[36:37] sc1
s_mov_b64 exec, -1
global_load_dwordx4 v[44:47], v2, s[36:37] offset:1024 sc1
s_add_u32 s25, s25, 1
s_cmp_gt_u32 s25, 1048576
s_cbranch_scc1 L_fail
s_waitcnt vmcnt(3)
v_max3_u32 v52, v40, v41, v42
v_max_u32 v52, v52, v43
v_cmp_eq_u32 vcc, -1, v52
s_cbranch_vccnz L_gre21
s_branch L_gok1
L_hre1:
s_mov_b64 exec, vcc
global_load_dwordx4 v[44:47], v2, s[36:37] offset:1024 sc1
s_mov_b64 exec, -1
s_add_u32 s25, s25, 1
s_cmp_gt_u32 s25, 1048576
s_cbranch_scc1 L_fail
s_waitcnt vmcnt(1)
v_max3_u32 v52, v44, v45, v46
v_max_u32 v52, v52, v47
v_cmp_eq_u32 vcc, -1, v52
s_cbranch_vccnz L_hre1
s_branch L_hok1
L_sms_s1:
s_nop 7
v_max3_f32 v92, v56, v57, v58
v_max3_f32 v93, v59, v60, v61
v_max3_f32 v19, v62, v63, v108
v_max3_f32 v92, v92, v93, v109
v_max_f32 v92, v92, v19
v_mov_b32 v93, v92
s_nop 1
v_permlane32_swap_b32 v92, v93
v_max_f32 v92, v92, v93
v_mov_b32 v93, v92
s_nop 1
v_permlane16_swap_b32 v92, v93
v_max_f32 v92, v92, v93
v_sub_f32 v96, v56, v92
v_sub_f32 v97, v57, v92
v_sub_f32 v98, v58, v92
v_sub_f32 v99, v59, v92
v_sub_f32 v100, v60, v92
v_sub_f32 v101, v61, v92
v_sub_f32 v102, v62, v92
v_sub_f32 v103, v63, v92
v_sub_f32 v110, v108, v92
v_sub_f32 v111, v109, v92
v_exp_f32 v96, v96
v_exp_f32 v97, v97
v_exp_f32 v98, v98
v_exp_f32 v99, v99
v_exp_f32 v100, v100
v_exp_f32 v101, v101
v_exp_f32 v102, v102
v_exp_f32 v103, v103
v_exp_f32 v110, v110
v_exp_f32 v111, v111
v_cvt_pk_bf16_f32 v96, v96, v97
v_cvt_pk_bf16_f32 v97, v98, v99
v_cvt_pk_bf16_f32 v98, v100, v101
v_cvt_pk_bf16_f32 v99, v102, v103
v_cvt_pk_bf16_f32 v104, v110, v111
v_cvt_pk_bf16_f32 v107, v110, v111
v_mfma_f32_16x16x32_bf16 v[124:127], v[112:115], v[96:99], 0
v_mfma_f32_16x16x32_bf16 v[116:119], v[28:31], v[96:99], 0
v_mfma_f32_16x16x32_bf16 v[120:123], v[32:35], v[96:99], 0
v_mfma_f32_16x16x16_bf16 v[124:127], v[112:113], v[104:105], v[124:127]
v_mfma_f32_16x16x16_bf16 v[116:119], v[38:39], v[104:105], v[116:119]
v_mfma_f32_16x16x16_bf16 v[120:123], v[38:39], v[106:107], v[120:123]
v_rcp_f32 v125, v124
s_mov_b64 vcc, 0
s_branch L_smb_s1
L_rre1:
s_mov_b64 s[4:5], vcc
s_mov_b64 exec, s[4:5]
global_load_dwordx4 v[48:51], v15, s[30:31] sc1
global_load_dwordx4 v[52:55], v15, s[30:31] offset:1024 sc1
s_mov_b64 exec, -1
s_waitcnt vmcnt(2)
s_nop 1
v_mfma_f32_16x16x32_bf16 v[68:71], v[40:43], v[60:63], 0
v_or_b32 v66, v40, v42
v_or3_b32 v67, v44, v46, v66
v_mfma_f32_16x16x32_bf16 v[68:71], v[44:47], v[60:63], v[68:71]
v_and_b32 v66, 1, v67
v_cmp_ne_u32 vcc, 0, v66
s_cbranch_vccz L_rok1
L_rre21:
s_mov_b64 exec, s[4:5]
global_load_dwordx4 v[48:51], v15, s[30:31] sc1
global_load_dwordx4 v[52:55], v15, s[30:31] offset:1024 sc1
s_mov_b64 exec, -1
s_add_u32 s25, s25, 1
s_cmp_gt_u32 s25, 1048576
s_cbranch_scc1 L_fail
s_waitcnt vmcnt(2)
v_or_b32 v66, v48, v50
v_or3_b32 v67, v52, v54, v66
v_and_b32 v66, 1, v67
v_cmp_ne_u32 vcc, 0, v66
s_nop 4
s_mov_b64 s[4:5], vcc
s_cbranch_vccnz L_rre21
s_branch L_rchk1
L_kv:
s_cmp_lg_u32 s21, 0
s_cbranch_scc1 L_norank_k
s_waitcnt vmcnt(2)
v_mov_b32 v2, 0
s_mov_b64 exec, 1
ds_write_b32 v2, v4
s_waitcnt lgkmcnt(0)
s_mov_b64 exec, -1
L_norank_k:
s_barrier
v_mov_b32 v2, 0
ds_read_b32 v4, v2
s_waitcnt lgkmcnt(0)
v_readfirstlane_b32 s20, v4
s_barrier
s_cmp_ge_u32 s20, 32
s_cbranch_scc1 L_overflow
s_load_dwordx2 s[52:53], s[0:1], 0
s_load_dwordx2 s[56:57], s[0:1], 24
s_load_dwordx2 s[60:61], s[0:1], 32
v_lshrrev_b32 v52, 4, v0
v_and_b32 v53, 15, v0
v_lshlrev_b32 v54, 2, v52
v_xor_b32 v54, v54, v53
v_lshlrev_b32 v55, 13, v52
v_lshl_add_u32 v1, v54, 4, v55
v_xor_b32 v2, 32, v1
v_bfe_u32 v53, v0, 2, 2
v_bfe_u32 v54, v0, 1, 1
v_and_b32 v55, 1, v0
v_and_b32 v56, 1, v52
v_lshl_add_u32 v57, v53, 1, v56
v_lshlrev_b32 v57, 1, v57
s_lshl_b32 s27, s21, 2
v_xor_b32 v57, s27, v57
v_add_u32 v57, v57, v54
v_lshlrev_b32 v57, 4, v57
v_lshl_add_u32 v57, v55, 3, v57
v_lshl_add_u32 v57, v53, 8, v57
v_lshl_add_u32 v3, v52, 11, v57
v_xor_b32 v4, 32, v3
s_lshl_b32 s31, s21, 12
s_lshl_b32 s30, s21, 17
s_lshl_b32 s27, s20, 8
s_add_u32 s30, s30, s27
s_and_b32 s27, s21, 1
s_lshl_b32 s27, s27, 7
v_lshlrev_b32 v7, 4, v0
v_xor_b32 v7, s27, v7
v_and_b32 v52, 15, v0
v_lshrrev_b32 v53, 4, v0
v_and_b32 v8, 3, v52
v_xor_b32 v53, v53, v8
v_lshlrev_b32 v53, 4, v53
v_lshl_add_u32 v53, v52, 10, v53
v_lshrrev_b32 v52, 2, v52
v_lshl_add_u32 v8, v52, 6, v53
v_xor_b32 v9, 64, v8
v_xor_b32 v10, 128, v8
v_xor_b32 v11, 192, v8
s_sub_u32 s35, s10, 1
s_lshl_b32 s32, s35, 15
s_lshl_b32 s33, s21, 13
s_add_u32 s32, s32, s33
s_mov_b32 s34, s33
s_mul_i32 s27, s35, 262144
s_lshl_b32 s28, s20, 13
s_add_u32 s27, s27, s28
s_add_u32 s28, s27, 16777216
s_add_u32 s40, s48, s28
s_addc_u32 s41, s49, 0
s_add_u32 s28, s27, 33554432
s_add_u32 s42, s48, s28
s_addc_u32 s43, s49, 0
v_lshlrev_b32 v14, 4, v0
s_lshl_b32 s27, s21, 10
v_add_u32 v14, s27, v14
s_lshl_b32 s27, s35, 2
s_lshl_b32 s28, s20, 7
s_add_u32 s27, s27, s28
s_add_u32 s27, s27, 589824
v_mov_b32 v15, s27
s_cmp_eq_u32 s21, 0
s_cselect_b32 s44, 1, 0
s_mov_b32 s45, 0
s_mov_b32 s46, 0
s_waitcnt lgkmcnt(0)
v_mov_b32 v56, 0
s_mov_b64 exec, s[44:45]
global_store_dword v15, v56, s[48:49] sc1
s_waitcnt vmcnt(0)
v_mov_b32 v56, 192
v_mov_b32 v57, 1
global_atomic_add v56, v57, s[8:9] sc1
s_mov_b64 exec, -1
s_mov_b32 s52, s52
s_and_b32 s53, s53, 0xffff
s_mov_b32 s54, 2097152
s_mov_b32 s55, 0x00020000
s_mov_b32 s56, s56
s_and_b32 s57, s57, 0xffff
s_mov_b32 s58, 4194304
s_mov_b32 s59, 0x00020000
s_mov_b32 s60, s60
s_and_b32 s61, s61, 0xffff
s_mov_b32 s62, 4194304
s_mov_b32 s63, 0x00020000
v_xor_b32 v12, 0, v7
s_add_u32 m0, s34, 0
s_add_u32 s29, s32, 0
buffer_load_dwordx4 v12, s[52:55], s29 offen lds
v_xor_b32 v13, 16, v7
s_add_u32 m0, s34, 1024
s_add_u32 s29, s32, 1024
buffer_load_dwordx4 v13, s[52:55], s29 offen lds
v_xor_b32 v12, 32, v7
s_add_u32 m0, s34, 2048
s_add_u32 s29, s32, 2048
buffer_load_dwordx4 v12, s[52:55], s29 offen lds
v_xor_b32 v13, 48, v7
s_add_u32 m0, s34, 3072
s_add_u32 s29, s32, 3072
buffer_load_dwordx4 v13, s[52:55], s29 offen lds
v_xor_b32 v12, 64, v7
s_add_u32 m0, s34, 4096
s_add_u32 s29, s32, 4096
buffer_load_dwordx4 v12, s[52:55], s29 offen lds
v_xor_b32 v13, 80, v7
s_add_u32 m0, s34, 5120
s_add_u32 s29, s32, 5120
buffer_load_dwordx4 v13, s[52:55], s29 offen lds
v_xor_b32 v12, 96, v7
s_add_u32 m0, s34, 6144
s_add_u32 s29, s32, 6144
buffer_load_dwordx4 v12, s[52:55], s29 offen lds
v_xor_b32 v13, 112, v7
s_add_u32 m0, s34, 7168
s_add_u32 s29, s32, 7168
buffer_load_dwordx4 v13, s[52:55], s29 offen lds
s_add_u32 m0, s31, 65536 + 0
s_add_u32 s29, s30, 0
buffer_load_dwordx4 v1, s[56:59], s29 offen lds
s_add_u32 m0, s31, 65536 + 1024
s_add_u32 s29, s30, 32768
buffer_load_dwordx4 v1, s[56:59], s29 offen lds
s_add_u32 m0, s31, 65536 + 2048
s_add_u32 s29, s30, 65536
buffer_load_dwordx4 v2, s[56:59], s29 offen lds
s_add_u32 m0, s31, 65536 + 3072
s_add_u32 s29, s30, 98304
buffer_load_dwordx4 v2, s[56:59], s29 offen lds
s_add_u32 m0, s31, 81920 + 0
s_add_u32 s29, s30, 524288
buffer_load_dwordx4 v1, s[56:59], s29 offen lds
s_add_u32 m0, s31, 81920 + 1024
s_add_u32 s29, s30, 557056
buffer_load_dwordx4 v1, s[56:59], s29 offen lds
s_add_u32 m0, s31, 81920 + 2048
s_add_u32 s29, s30, 589824
buffer_load_dwordx4 v2, s[56:59], s29 offen lds
s_add_u32 m0, s31, 81920 + 3072
s_add_u32 s29, s30, 622592
buffer_load_dwordx4 v2, s[56:59], s29 offen lds
s_waitcnt vmcnt(4) lgkmcnt(0)
s_barrier
s_add_u32 m0, s31, 98304 + 0
s_add_u32 s29, s30, 1048576
buffer_load_dwordx4 v1, s[56:59], s29 offen lds
s_add_u32 m0, s31, 98304 + 1024
s_add_u32 s29, s30, 1081344
buffer_load_dwordx4 v1, s[56:59], s29 offen lds
s_add_u32 m0, s31, 98304 + 2048
s_add_u32 s29, s30, 1114112
buffer_load_dwordx4 v2, s[56:59], s29 offen lds
s_add_u32 m0, s31, 98304 + 3072
s_add_u32 s29, s30, 1146880
buffer_load_dwordx4 v2, s[56:59], s29 offen lds
v_add_u32 v5, 65536, v3
v_add_u32 v6, 65536, v4
ds_read_b64_tr_b16 a[0:1], v5 offset:0
ds_read_b64_tr_b16 a[2:3], v5 offset:1024
ds_read_b64_tr_b16 a[4:5], v5 offset:8192
ds_read_b64_tr_b16 a[6:7], v5 offset:9216
ds_read_b64_tr_b16 a[64:65], v6 offset:0
ds_read_b64_tr_b16 a[66:67], v6 offset:1024
ds_read_b64_tr_b16 a[68:69], v6 offset:8192
ds_read_b64_tr_b16 a[70:71], v6 offset:9216
s_waitcnt vmcnt(4) lgkmcnt(0)
s_barrier
s_add_u32 m0, s31, 114688 + 0
s_add_u32 s29, s30, 1572864
buffer_load_dwordx4 v1, s[56:59], s29 offen lds
s_add_u32 m0, s31, 114688 + 1024
s_add_u32 s29, s30, 1605632
buffer_load_dwordx4 v1, s[56:59], s29 offen lds
s_add_u32 m0, s31, 114688 + 2048
s_add_u32 s29, s30, 1638400
buffer_load_dwordx4 v2, s[56:59], s29 offen lds
s_add_u32 m0, s31, 114688 + 3072
s_add_u32 s29, s30, 1671168
buffer_load_dwordx4 v2, s[56:59], s29 offen lds
v_add_u32 v5, 81920, v3
v_add_u32 v6, 81920, v4
ds_read_b64_tr_b16 a[8:9], v5 offset:0
ds_read_b64_tr_b16 a[10:11], v5 offset:1024
ds_read_b64_tr_b16 a[12:13], v5 offset:8192
ds_read_b64_tr_b16 a[14:15], v5 offset:9216
ds_read_b64_tr_b16 a[72:73], v6 offset:0
ds_read_b64_tr_b16 a[74:75], v6 offset:1024
ds_read_b64_tr_b16 a[76:77], v6 offset:8192
ds_read_b64_tr_b16 a[78:79], v6 offset:9216
s_waitcnt vmcnt(4) lgkmcnt(0)
s_barrier
s_add_u32 m0, s31, 131072 + 0
s_add_u32 s29, s30, 2097152
buffer_load_dwordx4 v1, s[56:59], s29 offen lds
s_add_u32 m0, s31, 131072 + 1024
s_add_u32 s29, s30, 2129920
buffer_load_dwordx4 v1, s[56:59], s29 offen lds
s_add_u32 m0, s31, 131072 + 2048
s_add_u32 s29, s30, 2162688
buffer_load_dwordx4 v2, s[56:59], s29 offen lds
s_add_u32 m0, s31, 131072 + 3072
s_add_u32 s29, s30, 2195456
buffer_load_dwordx4 v2, s[56:59], s29 offen lds
v_add_u32 v5, 98304, v3
v_add_u32 v6, 98304, v4
ds_read_b64_tr_b16 a[16:17], v5 offset:0
ds_read_b64_tr_b16 a[18:19], v5 offset:1024
ds_read_b64_tr_b16 a[20:21], v5 offset:8192
ds_read_b64_tr_b16 a[22:23], v5 offset:9216
ds_read_b64_tr_b16 a[80:81], v6 offset:0
ds_read_b64_tr_b16 a[82:83], v6 offset:1024
ds_read_b64_tr_b16 a[84:85], v6 offset:8192
ds_read_b64_tr_b16 a[86:87], v6 offset:9216
s_waitcnt vmcnt(4) lgkmcnt(0)
s_barrier
s_add_u32 m0, s31, 147456 + 0
s_add_u32 s29, s30, 2621440
buffer_load_dwordx4 v1, s[56:59], s29 offen lds
s_add_u32 m0, s31, 147456 + 1024
s_add_u32 s29, s30, 2654208
buffer_load_dwordx4 v1, s[56:59], s29 offen lds
s_add_u32 m0, s31, 147456 + 2048
s_add_u32 s29, s30, 2686976
buffer_load_dwordx4 v2, s[56:59], s29 offen lds
s_add_u32 m0, s31, 147456 + 3072
s_add_u32 s29, s30, 2719744
buffer_load_dwordx4 v2, s[56:59], s29 offen lds
v_add_u32 v5, 114688, v3
v_add_u32 v6, 114688, v4
ds_read_b64_tr_b16 a[24:25], v5 offset:0
ds_read_b64_tr_b16 a[26:27], v5 offset:1024
ds_read_b64_tr_b16 a[28:29], v5 offset:8192
ds_read_b64_tr_b16 a[30:31], v5 offset:9216
ds_read_b64_tr_b16 a[88:89], v6 offset:0
ds_read_b64_tr_b16 a[90:91], v6 offset:1024
ds_read_b64_tr_b16 a[92:93], v6 offset:8192
ds_read_b64_tr_b16 a[94:95], v6 offset:9216
s_waitcnt vmcnt(4) lgkmcnt(0)
s_barrier
s_add_u32 m0, s31, 65536 + 0
s_add_u32 s29, s30, 3145728
buffer_load_dwordx4 v1, s[56:59], s29 offen lds
s_add_u32 m0, s31, 65536 + 1024
s_add_u32 s29, s30, 3178496
buffer_load_dwordx4 v1, s[56:59], s29 offen lds
s_add_u32 m0, s31, 65536 + 2048
s_add_u32 s29, s30, 3211264
buffer_load_dwordx4 v2, s[56:59], s29 offen lds
s_add_u32 m0, s31, 65536 + 3072
s_add_u32 s29, s30, 3244032
buffer_load_dwordx4 v2, s[56:59], s29 offen lds
v_add_u32 v5, 131072, v3
v_add_u32 v6, 131072, v4
ds_read_b64_tr_b16 a[32:33], v5 offset:0
ds_read_b64_tr_b16 a[34:35], v5 offset:1024
ds_read_b64_tr_b16 a[36:37], v5 offset:8192
ds_read_b64_tr_b16 a[38:39], v5 offset:9216
ds_read_b64_tr_b16 a[96:97], v6 offset:0
ds_read_b64_tr_b16 a[98:99], v6 offset:1024
ds_read_b64_tr_b16 a[100:101], v6 offset:8192
ds_read_b64_tr_b16 a[102:103], v6 offset:9216
s_waitcnt vmcnt(4) lgkmcnt(0)
s_barrier
s_add_u32 m0, s31, 81920 + 0
s_add_u32 s29, s30, 3670016
buffer_load_dwordx4 v1, s[56:59], s29 offen lds
s_add_u32 m0, s31, 81920 + 1024
s_add_u32 s29, s30, 3702784
buffer_load_dwordx4 v1, s[56:59], s29 offen lds
s_add_u32 m0, s31, 81920 + 2048
s_add_u32 s29, s30, 3735552
buffer_load_dwordx4 v2, s[56:59], s29 offen lds
s_add_u32 m0, s31, 81920 + 3072
s_add_u32 s29, s30, 3768320
buffer_load_dwordx4 v2, s[56:59], s29 offen lds
v_add_u32 v5, 147456, v3
v_add_u32 v6, 147456, v4
ds_read_b64_tr_b16 a[40:41], v5 offset:0
ds_read_b64_tr_b16 a[42:43], v5 offset:1024
ds_read_b64_tr_b16 a[44:45], v5 offset:8192
ds_read_b64_tr_b16 a[46:47], v5 offset:9216
ds_read_b64_tr_b16 a[104:105], v6 offset:0
ds_read_b64_tr_b16 a[106:107], v6 offset:1024
ds_read_b64_tr_b16 a[108:109], v6 offset:8192
ds_read_b64_tr_b16 a[110:111], v6 offset:9216
s_waitcnt vmcnt(4) lgkmcnt(0)
s_barrier
s_add_u32 m0, s31, 98304 + 0
s_add_u32 s29, s30, 0
buffer_load_dwordx4 v1, s[60:63], s29 offen lds
s_add_u32 m0, s31, 98304 + 1024
s_add_u32 s29, s30, 32768
buffer_load_dwordx4 v1, s[60:63], s29 offen lds
s_add_u32 m0, s31, 98304 + 2048
s_add_u32 s29, s30, 65536
buffer_load_dwordx4 v2, s[60:63], s29 offen lds
s_add_u32 m0, s31, 98304 + 3072
s_add_u32 s29, s30, 98304
buffer_load_dwordx4 v2, s[60:63], s29 offen lds
v_add_u32 v5, 65536, v3
v_add_u32 v6, 65536, v4
ds_read_b64_tr_b16 a[48:49], v5 offset:0
ds_read_b64_tr_b16 a[50:51], v5 offset:1024
ds_read_b64_tr_b16 a[52:53], v5 offset:8192
ds_read_b64_tr_b16 a[54:55], v5 offset:9216
ds_read_b64_tr_b16 a[112:113], v6 offset:0
ds_read_b64_tr_b16 a[114:115], v6 offset:1024
ds_read_b64_tr_b16 a[116:117], v6 offset:8192
ds_read_b64_tr_b16 a[118:119], v6 offset:9216
s_waitcnt vmcnt(4) lgkmcnt(0)
s_barrier
s_add_u32 m0, s31, 114688 + 0
s_add_u32 s29, s30, 524288
buffer_load_dwordx4 v1, s[60:63], s29 offen lds
s_add_u32 m0, s31, 114688 + 1024
s_add_u32 s29, s30, 557056
buffer_load_dwordx4 v1, s[60:63], s29 offen lds
s_add_u32 m0, s31, 114688 + 2048
s_add_u32 s29, s30, 589824
buffer_load_dwordx4 v2, s[60:63], s29 offen lds
s_add_u32 m0, s31, 114688 + 3072
s_add_u32 s29, s30, 622592
buffer_load_dwordx4 v2, s[60:63], s29 offen lds
v_add_u32 v5, 81920, v3
v_add_u32 v6, 81920, v4
ds_read_b64_tr_b16 a[56:57], v5 offset:0
ds_read_b64_tr_b16 a[58:59], v5 offset:1024
ds_read_b64_tr_b16 a[60:61], v5 offset:8192
ds_read_b64_tr_b16 a[62:63], v5 offset:9216
ds_read_b64_tr_b16 a[120:121], v6 offset:0
ds_read_b64_tr_b16 a[122:123], v6 offset:1024
ds_read_b64_tr_b16 a[124:125], v6 offset:8192
ds_read_b64_tr_b16 a[126:127], v6 offset:9216
s_waitcnt vmcnt(4) lgkmcnt(0)
s_barrier
s_add_u32 m0, s31, 131072 + 0
s_add_u32 s29, s30, 1048576
buffer_load_dwordx4 v1, s[60:63], s29 offen lds
s_add_u32 m0, s31, 131072 + 1024
s_add_u32 s29, s30, 1081344
buffer_load_dwordx4 v1, s[60:63], s29 offen lds
s_add_u32 m0, s31, 131072 + 2048
s_add_u32 s29, s30, 1114112
buffer_load_dwordx4 v2, s[60:63], s29 offen lds
s_add_u32 m0, s31, 131072 + 3072
s_add_u32 s29, s30, 1146880
buffer_load_dwordx4 v2, s[60:63], s29 offen lds
v_add_u32 v5, 98304, v3
v_add_u32 v6, 98304, v4
ds_read_b64_tr_b16 a[128:129], v5 offset:0
ds_read_b64_tr_b16 a[130:131], v5 offset:1024
ds_read_b64_tr_b16 a[132:133], v5 offset:8192
ds_read_b64_tr_b16 a[134:135], v5 offset:9216
ds_read_b64_tr_b16 a[192:193], v6 offset:0
ds_read_b64_tr_b16 a[194:195], v6 offset:1024
ds_read_b64_tr_b16 a[196:197], v6 offset:8192
ds_read_b64_tr_b16 a[198:199], v6 offset:9216
s_waitcnt vmcnt(4) lgkmcnt(0)
s_barrier
s_add_u32 m0, s31, 147456 + 0
s_add_u32 s29, s30, 1572864
buffer_load_dwordx4 v1, s[60:63], s29 offen lds
s_add_u32 m0, s31, 147456 + 1024
s_add_u32 s29, s30, 1605632
buffer_load_dwordx4 v1, s[60:63], s29 offen lds
s_add_u32 m0, s31, 147456 + 2048
s_add_u32 s29, s30, 1638400
buffer_load_dwordx4 v2, s[60:63], s29 offen lds
s_add_u32 m0, s31, 147456 + 3072
s_add_u32 s29, s30, 1671168
buffer_load_dwordx4 v2, s[60:63], s29 offen lds
v_add_u32 v5, 114688, v3
v_add_u32 v6, 114688, v4
ds_read_b64_tr_b16 a[136:137], v5 offset:0
ds_read_b64_tr_b16 a[138:139], v5 offset:1024
ds_read_b64_tr_b16 a[140:141], v5 offset:8192
ds_read_b64_tr_b16 a[142:143], v5 offset:9216
ds_read_b64_tr_b16 a[200:201], v6 offset:0
ds_read_b64_tr_b16 a[202:203], v6 offset:1024
ds_read_b64_tr_b16 a[204:205], v6 offset:8192
ds_read_b64_tr_b16 a[206:207], v6 offset:9216
s_waitcnt vmcnt(4) lgkmcnt(0)
s_barrier
s_add_u32 m0, s31, 65536 + 0
s_add_u32 s29, s30, 2097152
buffer_load_dwordx4 v1, s[60:63], s29 offen lds
s_add_u32 m0, s31, 65536 + 1024
s_add_u32 s29, s30, 2129920
buffer_load_dwordx4 v1, s[60:63], s29 offen lds
s_add_u32 m0, s31, 65536 + 2048
s_add_u32 s29, s30, 2162688
buffer_load_dwordx4 v2, s[60:63], s29 offen lds
s_add_u32 m0, s31, 65536 + 3072
s_add_u32 s29, s30, 2195456
buffer_load_dwordx4 v2, s[60:63], s29 offen lds
v_add_u32 v5, 131072, v3
v_add_u32 v6, 131072, v4
ds_read_b64_tr_b16 a[144:145], v5 offset:0
ds_read_b64_tr_b16 a[146:147], v5 offset:1024
ds_read_b64_tr_b16 a[148:149], v5 offset:8192
ds_read_b64_tr_b16 a[150:151], v5 offset:9216
ds_read_b64_tr_b16 a[208:209], v6 offset:0
ds_read_b64_tr_b16 a[210:211], v6 offset:1024
ds_read_b64_tr_b16 a[212:213], v6 offset:8192
ds_read_b64_tr_b16 a[214:215], v6 offset:9216
s_waitcnt vmcnt(4) lgkmcnt(0)
s_barrier
s_add_u32 m0, s31, 81920 + 0
s_add_u32 s29, s30, 2621440
buffer_load_dwordx4 v1, s[60:63], s29 offen lds
s_add_u32 m0, s31, 81920 + 1024
s_add_u32 s29, s30, 2654208
buffer_load_dwordx4 v1, s[60:63], s29 offen lds
s_add_u32 m0, s31, 81920 + 2048
s_add_u32 s29, s30, 2686976
buffer_load_dwordx4 v2, s[60:63], s29 offen lds
s_add_u32 m0, s31, 81920 + 3072
s_add_u32 s29, s30, 2719744
buffer_load_dwordx4 v2, s[60:63], s29 offen lds
v_add_u32 v5, 147456, v3
v_add_u32 v6, 147456, v4
ds_read_b64_tr_b16 a[152:153], v5 offset:0
ds_read_b64_tr_b16 a[154:155], v5 offset:1024
ds_read_b64_tr_b16 a[156:157], v5 offset:8192
ds_read_b64_tr_b16 a[158:159], v5 offset:9216
ds_read_b64_tr_b16 a[216:217], v6 offset:0
ds_read_b64_tr_b16 a[218:219], v6 offset:1024
ds_read_b64_tr_b16 a[220:221], v6 offset:8192
ds_read_b64_tr_b16 a[222:223], v6 offset:9216
s_waitcnt vmcnt(4) lgkmcnt(0)
s_barrier
s_add_u32 m0, s31, 98304 + 0
s_add_u32 s29, s30, 3145728
buffer_load_dwordx4 v1, s[60:63], s29 offen lds
s_add_u32 m0, s31, 98304 + 1024
s_add_u32 s29, s30, 3178496
buffer_load_dwordx4 v1, s[60:63], s29 offen lds
s_add_u32 m0, s31, 98304 + 2048
s_add_u32 s29, s30, 3211264
buffer_load_dwordx4 v2, s[60:63], s29 offen lds
s_add_u32 m0, s31, 98304 + 3072
s_add_u32 s29, s30, 3244032
buffer_load_dwordx4 v2, s[60:63], s29 offen lds
v_add_u32 v5, 65536, v3
v_add_u32 v6, 65536, v4
ds_read_b64_tr_b16 a[160:161], v5 offset:0
ds_read_b64_tr_b16 a[162:163], v5 offset:1024
ds_read_b64_tr_b16 a[164:165], v5 offset:8192
ds_read_b64_tr_b16 a[166:167], v5 offset:9216
ds_read_b64_tr_b16 a[224:225], v6 offset:0
ds_read_b64_tr_b16 a[226:227], v6 offset:1024
ds_read_b64_tr_b16 a[228:229], v6 offset:8192
ds_read_b64_tr_b16 a[230:231], v6 offset:9216
s_waitcnt vmcnt(4) lgkmcnt(0)
s_barrier
s_add_u32 m0, s31, 114688 + 0
s_add_u32 s29, s30, 3670016
buffer_load_dwordx4 v1, s[60:63], s29 offen lds
s_add_u32 m0, s31, 114688 + 1024
s_add_u32 s29, s30, 3702784
buffer_load_dwordx4 v1, s[60:63], s29 offen lds
s_add_u32 m0, s31, 114688 + 2048
s_add_u32 s29, s30, 3735552
buffer_load_dwordx4 v2, s[60:63], s29 offen lds
s_add_u32 m0, s31, 114688 + 3072
s_add_u32 s29, s30, 3768320
buffer_load_dwordx4 v2, s[60:63], s29 offen lds
v_add_u32 v5, 81920, v3
v_add_u32 v6, 81920, v4
ds_read_b64_tr_b16 a[168:169], v5 offset:0
ds_read_b64_tr_b16 a[170:171], v5 offset:1024
ds_read_b64_tr_b16 a[172:173], v5 offset:8192
ds_read_b64_tr_b16 a[174:175], v5 offset:9216
ds_read_b64_tr_b16 a[232:233], v6 offset:0
ds_read_b64_tr_b16 a[234:235], v6 offset:1024
ds_read_b64_tr_b16 a[236:237], v6 offset:8192
ds_read_b64_tr_b16 a[238:239], v6 offset:9216
s_waitcnt vmcnt(4) lgkmcnt(0)
s_barrier
v_add_u32 v5, 98304, v3
v_add_u32 v6, 98304, v4
ds_read_b64_tr_b16 a[176:177], v5 offset:0
ds_read_b64_tr_b16 a[178:179], v5 offset:1024
ds_read_b64_tr_b16 a[180:181], v5 offset:8192
ds_read_b64_tr_b16 a[182:183], v5 offset:9216
ds_read_b64_tr_b16 a[240:241], v6 offset:0
ds_read_b64_tr_b16 a[242:243], v6 offset:1024
ds_read_b64_tr_b16 a[244:245], v6 offset:8192
ds_read_b64_tr_b16 a[246:247], v6 offset:9216
s_waitcnt vmcnt(0) lgkmcnt(0)
s_barrier
v_add_u32 v5, 114688, v3
v_add_u32 v6, 114688, v4
ds_read_b64_tr_b16 a[184:185], v5 offset:0
ds_read_b64_tr_b16 a[186:187], v5 offset:1024
ds_read_b64_tr_b16 a[188:189], v5 offset:8192
ds_read_b64_tr_b16 a[190:191], v5 offset:9216
ds_read_b64_tr_b16 a[248:249], v6 offset:0
ds_read_b64_tr_b16 a[250:251], v6 offset:1024
ds_read_b64_tr_b16 a[252:253], v6 offset:8192
ds_read_b64_tr_b16 a[254:255], v6 offset:9216
s_waitcnt lgkmcnt(0)
s_mov_b32 s36, 0
L_kv_seg0:
s_waitcnt vmcnt(0)
s_barrier
v_mov_b32 v16, s46
s_mov_b64 exec, s[44:45]
global_store_dword v15, v16, s[48:49] sc1
s_mov_b64 exec, -1
s_add_u32 s35, s35, 2
s_add_u32 s32, s32, 65536
s_add_u32 s34, s33, 32768
ds_read_b128 v[32:35], v8 offset:0
ds_read_b128 v[36:39], v8 offset:16384
ds_read_b128 v[40:43], v9 offset:0
ds_read_b128 v[44:47], v9 offset:16384
ds_read_b128 v[48:51], v10 offset:0
ds_read_b128 v[52:55], v10 offset:16384
s_cmp_ge_u32 s35, 64
s_cbranch_scc1 L_kv_nopf0
v_xor_b32 v12, 0, v7
s_add_u32 m0, s34, 0
s_add_u32 s29, s32, 0
buffer_load_dwordx4 v12, s[52:55], s29 offen lds
v_xor_b32 v13, 16, v7
s_add_u32 m0, s34, 1024
s_add_u32 s29, s32, 1024
buffer_load_dwordx4 v13, s[52:55], s29 offen lds
v_xor_b32 v12, 32, v7
s_add_u32 m0, s34, 2048
s_add_u32 s29, s32, 2048
buffer_load_dwordx4 v12, s[52:55], s29 offen lds
v_xor_b32 v13, 48, v7
s_add_u32 m0, s34, 3072
s_add_u32 s29, s32, 3072
buffer_load_dwordx4 v13, s[52:55], s29 offen lds
v_xor_b32 v12, 64, v7
s_add_u32 m0, s34, 4096
s_add_u32 s29, s32, 4096
buffer_load_dwordx4 v12, s[52:55], s29 offen lds
v_xor_b32 v13, 80, v7
s_add_u32 m0, s34, 5120
s_add_u32 s29, s32, 5120
buffer_load_dwordx4 v13, s[52:55], s29 offen lds
v_xor_b32 v12, 96, v7
s_add_u32 m0, s34, 6144
s_add_u32 s29, s32, 6144
buffer_load_dwordx4 v12, s[52:55], s29 offen lds
v_xor_b32 v13, 112, v7
s_add_u32 m0, s34, 7168
s_add_u32 s29, s32, 7168
buffer_load_dwordx4 v13, s[52:55], s29 offen lds
L_kv_nopf0:
s_waitcnt lgkmcnt(4)
v_mfma_f32_16x16x32_bf16 v[64:67], a[0:3], v[32:35], 0
ds_read_b128 v[56:59], v11 offset:0
v_mfma_f32_16x16x32_bf16 v[68:71], a[64:67], v[32:35], 0
v_mfma_f32_16x16x32_bf16 v[80:83], v[32:35], a[128:131], 0
v_mfma_f32_16x16x32_bf16 v[88:91], v[32:35], a[192:195], 0
v_mfma_f32_16x16x32_bf16 v[72:75], a[0:3], v[36:39], 0
ds_read_b128 v[60:63], v11 offset:16384
v_mfma_f32_16x16x32_bf16 v[76:79], a[64:67], v[36:39], 0
v_mfma_f32_16x16x32_bf16 v[84:87], v[36:39], a[128:131], 0
v_mfma_f32_16x16x32_bf16 v[92:95], v[36:39], a[192:195], 0
s_waitcnt lgkmcnt(4)
v_mfma_f32_16x16x32_bf16 v[64:67], a[4:7], v[40:43], v[64:67]
ds_read_b128 v[32:35], v8 offset:256
v_mfma_f32_16x16x32_bf16 v[68:71], a[68:71], v[40:43], v[68:71]
v_mfma_f32_16x16x32_bf16 v[80:83], v[40:43], a[132:135], v[80:83]
v_mfma_f32_16x16x32_bf16 v[88:91], v[40:43], a[196:199], v[88:91]
v_mfma_f32_16x16x32_bf16 v[72:75], a[4:7], v[44:47], v[72:75]
ds_read_b128 v[36:39], v8 offset:16640
v_mfma_f32_16x16x32_bf16 v[76:79], a[68:71], v[44:47], v[76:79]
v_mfma_f32_16x16x32_bf16 v[84:87], v[44:47], a[132:135], v[84:87]
v_mfma_f32_16x16x32_bf16 v[92:95], v[44:47], a[196:199], v[92:95]
s_waitcnt lgkmcnt(4)
v_mfma_f32_16x16x32_bf16 v[64:67], a[8:11], v[48:51], v[64:67]
ds_read_b128 v[40:43], v9 offset:256
v_mfma_f32_16x16x32_bf16 v[68:71], a[72:75], v[48:51], v[68:71]
v_mfma_f32_16x16x32_bf16 v[80:83], v[48:51], a[136:139], v[80:83]
v_mfma_f32_16x16x32_bf16 v[88:91], v[48:51], a[200:203], v[88:91]
v_mfma_f32_16x16x32_bf16 v[72:75], a[8:11], v[52:55], v[72:75]
ds_read_b128 v[44:47], v9 offset:16640
v_mfma_f32_16x16x32_bf16 v[76:79], a[72:75], v[52:55], v[76:79]
v_mfma_f32_16x16x32_bf16 v[84:87], v[52:55], a[136:139], v[84:87]
v_mfma_f32_16x16x32_bf16 v[92:95], v[52:55], a[200:203], v[92:95]
s_waitcnt lgkmcnt(4)
v_mfma_f32_16x16x32_bf16 v[64:67], a[12:15], v[56:59], v[64:67]
ds_read_b128 v[48:51], v10 offset:256
v_mfma_f32_16x16x32_bf16 v[68:71], a[76:79], v[56:59], v[68:71]
v_mfma_f32_16x16x32_bf16 v[80:83], v[56:59], a[140:143], v[80:83]
v_mfma_f32_16x16x32_bf16 v[88:91], v[56:59], a[204:207], v[88:91]
v_mfma_f32_16x16x32_bf16 v[72:75], a[12:15], v[60:63], v[72:75]
ds_read_b128 v[52:55], v10 offset:16640
v_mfma_f32_16x16x32_bf16 v[76:79], a[76:79], v[60:63], v[76:79]
v_mfma_f32_16x16x32_bf16 v[84:87], v[60:63], a[140:143], v[84:87]
v_mfma_f32_16x16x32_bf16 v[92:95], v[60:63], a[204:207], v[92:95]
s_waitcnt lgkmcnt(4)
v_mfma_f32_16x16x32_bf16 v[64:67], a[16:19], v[32:35], v[64:67]
ds_read_b128 v[56:59], v11 offset:256
v_mfma_f32_16x16x32_bf16 v[68:71], a[80:83], v[32:35], v[68:71]
v_mfma_f32_16x16x32_bf16 v[80:83], v[32:35], a[144:147], v[80:83]
v_mfma_f32_16x16x32_bf16 v[88:91], v[32:35], a[208:211], v[88:91]
v_mfma_f32_16x16x32_bf16 v[72:75], a[16:19], v[36:39], v[72:75]
ds_read_b128 v[60:63], v11 offset:16640
v_mfma_f32_16x16x32_bf16 v[76:79], a[80:83], v[36:39], v[76:79]
v_mfma_f32_16x16x32_bf16 v[84:87], v[36:39], a[144:147], v[84:87]
v_mfma_f32_16x16x32_bf16 v[92:95], v[36:39], a[208:211], v[92:95]
s_waitcnt lgkmcnt(4)
v_mfma_f32_16x16x32_bf16 v[64:67], a[20:23], v[40:43], v[64:67]
ds_read_b128 v[32:35], v8 offset:512
v_mfma_f32_16x16x32_bf16 v[68:71], a[84:87], v[40:43], v[68:71]
v_mfma_f32_16x16x32_bf16 v[80:83], v[40:43], a[148:151], v[80:83]
v_mfma_f32_16x16x32_bf16 v[88:91], v[40:43], a[212:215], v[88:91]
v_mfma_f32_16x16x32_bf16 v[72:75], a[20:23], v[44:47], v[72:75]
ds_read_b128 v[36:39], v8 offset:16896
v_mfma_f32_16x16x32_bf16 v[76:79], a[84:87], v[44:47], v[76:79]
v_mfma_f32_16x16x32_bf16 v[84:87], v[44:47], a[148:151], v[84:87]
v_mfma_f32_16x16x32_bf16 v[92:95], v[44:47], a[212:215], v[92:95]
s_waitcnt lgkmcnt(4)
v_mfma_f32_16x16x32_bf16 v[64:67], a[24:27], v[48:51], v[64:67]
ds_read_b128 v[40:43], v9 offset:512
v_mfma_f32_16x16x32_bf16 v[68:71], a[88:91], v[48:51], v[68:71]
v_mfma_f32_16x16x32_bf16 v[80:83], v[48:51], a[152:155], v[80:83]
v_mfma_f32_16x16x32_bf16 v[88:91], v[48:51], a[216:219], v[88:91]
v_mfma_f32_16x16x32_bf16 v[72:75], a[24:27], v[52:55], v[72:75]
ds_read_b128 v[44:47], v9 offset:16896
v_mfma_f32_16x16x32_bf16 v[76:79], a[88:91], v[52:55], v[76:79]
v_mfma_f32_16x16x32_bf16 v[84:87], v[52:55], a[152:155], v[84:87]
v_mfma_f32_16x16x32_bf16 v[92:95], v[52:55], a[216:219], v[92:95]
s_waitcnt lgkmcnt(4)
v_mfma_f32_16x16x32_bf16 v[64:67], a[28:31], v[56:59], v[64:67]
ds_read_b128 v[48:51], v10 offset:512
v_mfma_f32_16x16x32_bf16 v[68:71], a[92:95], v[56:59], v[68:71]
v_mfma_f32_16x16x32_bf16 v[80:83], v[56:59], a[156:159], v[80:83]
v_mfma_f32_16x16x32_bf16 v[88:91], v[56:59], a[220:223], v[88:91]
v_mfma_f32_16x16x32_bf16 v[72:75], a[28:31], v[60:63], v[72:75]
ds_read_b128 v[52:55], v10 offset:16896
v_mfma_f32_16x16x32_bf16 v[76:79], a[92:95], v[60:63], v[76:79]
v_mfma_f32_16x16x32_bf16 v[84:87], v[60:63], a[156:159], v[84:87]
v_mfma_f32_16x16x32_bf16 v[92:95], v[60:63], a[220:223], v[92:95]
s_waitcnt lgkmcnt(4)
v_mfma_f32_16x16x32_bf16 v[64:67], a[32:35], v[32:35], v[64:67]
ds_read_b128 v[56:59], v11 offset:512
v_mfma_f32_16x16x32_bf16 v[68:71], a[96:99], v[32:35], v[68:71]
v_mfma_f32_16x16x32_bf16 v[80:83], v[32:35], a[160:163], v[80:83]
v_mfma_f32_16x16x32_bf16 v[88:91], v[32:35], a[224:227], v[88:91]
v_mfma_f32_16x16x32_bf16 v[72:75], a[32:35], v[36:39], v[72:75]
ds_read_b128 v[60:63], v11 offset:16896
v_mfma_f32_16x16x32_bf16 v[76:79], a[96:99], v[36:39], v[76:79]
v_mfma_f32_16x16x32_bf16 v[84:87], v[36:39], a[160:163], v[84:87]
v_mfma_f32_16x16x32_bf16 v[92:95], v[36:39], a[224:227], v[92:95]
s_waitcnt lgkmcnt(4)
v_mfma_f32_16x16x32_bf16 v[64:67], a[36:39], v[40:43], v[64:67]
ds_read_b128 v[32:35], v8 offset:768
v_mfma_f32_16x16x32_bf16 v[68:71], a[100:103], v[40:43], v[68:71]
v_mfma_f32_16x16x32_bf16 v[80:83], v[40:43], a[164:167], v[80:83]
v_mfma_f32_16x16x32_bf16 v[88:91], v[40:43], a[228:231], v[88:91]
v_mfma_f32_16x16x32_bf16 v[72:75], a[36:39], v[44:47], v[72:75]
ds_read_b128 v[36:39], v8 offset:17152
v_mfma_f32_16x16x32_bf16 v[76:79], a[100:103], v[44:47], v[76:79]
v_mfma_f32_16x16x32_bf16 v[84:87], v[44:47], a[164:167], v[84:87]
v_mfma_f32_16x16x32_bf16 v[92:95], v[44:47], a[228:231], v[92:95]
s_waitcnt lgkmcnt(4)
v_mfma_f32_16x16x32_bf16 v[64:67], a[40:43], v[48:51], v[64:67]
ds_read_b128 v[40:43], v9 offset:768
v_mfma_f32_16x16x32_bf16 v[68:71], a[104:107], v[48:51], v[68:71]
v_mfma_f32_16x16x32_bf16 v[80:83], v[48:51], a[168:171], v[80:83]
v_mfma_f32_16x16x32_bf16 v[88:91], v[48:51], a[232:235], v[88:91]
v_mfma_f32_16x16x32_bf16 v[72:75], a[40:43], v[52:55], v[72:75]
ds_read_b128 v[44:47], v9 offset:17152
v_mfma_f32_16x16x32_bf16 v[76:79], a[104:107], v[52:55], v[76:79]
v_mfma_f32_16x16x32_bf16 v[84:87], v[52:55], a[168:171], v[84:87]
v_mfma_f32_16x16x32_bf16 v[92:95], v[52:55], a[232:235], v[92:95]
s_waitcnt lgkmcnt(4)
v_mfma_f32_16x16x32_bf16 v[64:67], a[44:47], v[56:59], v[64:67]
ds_read_b128 v[48:51], v10 offset:768
v_mfma_f32_16x16x32_bf16 v[68:71], a[108:111], v[56:59], v[68:71]
v_mfma_f32_16x16x32_bf16 v[80:83], v[56:59], a[172:175], v[80:83]
v_mfma_f32_16x16x32_bf16 v[88:91], v[56:59], a[236:239], v[88:91]
v_mfma_f32_16x16x32_bf16 v[72:75], a[44:47], v[60:63], v[72:75]
ds_read_b128 v[52:55], v10 offset:17152
v_mfma_f32_16x16x32_bf16 v[76:79], a[108:111], v[60:63], v[76:79]
v_mfma_f32_16x16x32_bf16 v[84:87], v[60:63], a[172:175], v[84:87]
v_mfma_f32_16x16x32_bf16 v[92:95], v[60:63], a[236:239], v[92:95]
s_waitcnt lgkmcnt(4)
v_mfma_f32_16x16x32_bf16 v[64:67], a[48:51], v[32:35], v[64:67]
ds_read_b128 v[56:59], v11 offset:768
v_mfma_f32_16x16x32_bf16 v[68:71], a[112:115], v[32:35], v[68:71]
v_mfma_f32_16x16x32_bf16 v[80:83], v[32:35], a[176:179], v[80:83]
v_mfma_f32_16x16x32_bf16 v[88:91], v[32:35], a[240:243], v[88:91]
v_mfma_f32_16x16x32_bf16 v[72:75], a[48:51], v[36:39], v[72:75]
ds_read_b128 v[60:63], v11 offset:17152
v_mfma_f32_16x16x32_bf16 v[76:79], a[112:115], v[36:39], v[76:79]
v_mfma_f32_16x16x32_bf16 v[84:87], v[36:39], a[176:179], v[84:87]
v_mfma_f32_16x16x32_bf16 v[92:95], v[36:39], a[240:243], v[92:95]
s_waitcnt lgkmcnt(4)
v_mfma_f32_16x16x32_bf16 v[64:67], a[52:55], v[40:43], v[64:67]
v_mfma_f32_16x16x32_bf16 v[68:71], a[116:119], v[40:43], v[68:71]
v_mfma_f32_16x16x32_bf16 v[80:83], v[40:43], a[180:183], v[80:83]
v_mfma_f32_16x16x32_bf16 v[88:91], v[40:43], a[244:247], v[88:91]
v_mfma_f32_16x16x32_bf16 v[72:75], a[52:55], v[44:47], v[72:75]
v_mfma_f32_16x16x32_bf16 v[76:79], a[116:119], v[44:47], v[76:79]
v_mfma_f32_16x16x32_bf16 v[84:87], v[44:47], a[180:183], v[84:87]
v_mfma_f32_16x16x32_bf16 v[92:95], v[44:47], a[244:247], v[92:95]
s_waitcnt lgkmcnt(2)
v_mfma_f32_16x16x32_bf16 v[64:67], a[56:59], v[48:51], v[64:67]
v_mfma_f32_16x16x32_bf16 v[68:71], a[120:123], v[48:51], v[68:71]
v_mfma_f32_16x16x32_bf16 v[80:83], v[48:51], a[184:187], v[80:83]
v_mfma_f32_16x16x32_bf16 v[88:91], v[48:51], a[248:251], v[88:91]
v_mfma_f32_16x16x32_bf16 v[72:75], a[56:59], v[52:55], v[72:75]
v_mfma_f32_16x16x32_bf16 v[76:79], a[120:123], v[52:55], v[76:79]
v_mfma_f32_16x16x32_bf16 v[84:87], v[52:55], a[184:187], v[84:87]
v_mfma_f32_16x16x32_bf16 v[92:95], v[52:55], a[248:251], v[92:95]
s_waitcnt lgkmcnt(0)
v_mfma_f32_16x16x32_bf16 v[64:67], a[60:63], v[56:59], v[64:67]
v_mfma_f32_16x16x32_bf16 v[68:71], a[124:127], v[56:59], v[68:71]
v_mfma_f32_16x16x32_bf16 v[80:83], v[56:59], a[188:191], v[80:83]
v_mfma_f32_16x16x32_bf16 v[88:91], v[56:59], a[252:255], v[88:91]
v_mfma_f32_16x16x32_bf16 v[72:75], a[60:63], v[60:63], v[72:75]
v_mfma_f32_16x16x32_bf16 v[76:79], a[124:127], v[60:63], v[76:79]
v_mfma_f32_16x16x32_bf16 v[84:87], v[60:63], a[188:191], v[84:87]
v_mfma_f32_16x16x32_bf16 v[92:95], v[60:63], a[252:255], v[92:95]
s_mov_b32 s27, 0x3e0293ee
v_mul_f32 v64, s27, v64
v_mul_f32 v65, s27, v65
v_mul_f32 v66, s27, v66
v_mul_f32 v67, s27, v67
v_mul_f32 v68, s27, v68
v_mul_f32 v69, s27, v69
v_mul_f32 v70, s27, v70
v_mul_f32 v71, s27, v71
v_mul_f32 v72, s27, v72
v_mul_f32 v73, s27, v73
v_mul_f32 v74, s27, v74
v_mul_f32 v75, s27, v75
v_mul_f32 v76, s27, v76
v_mul_f32 v77, s27, v77
v_mul_f32 v78, s27, v78
v_mul_f32 v79, s27, v79
v_cvt_pk_bf16_f32 v96, v64, v65
v_cvt_pk_bf16_f32 v97, v66, v67
v_cvt_pk_bf16_f32 v98, v68, v69
v_cvt_pk_bf16_f32 v99, v70, v71
global_store_dwordx4 v14, v[96:99], s[40:41]  sc1
v_cvt_pk_bf16_f32 v100, v72, v73
v_cvt_pk_bf16_f32 v101, v74, v75
v_cvt_pk_bf16_f32 v102, v76, v77
v_cvt_pk_bf16_f32 v103, v78, v79
v_add_u32 v5, 4096, v14
global_store_dwordx4 v5, v[100:103], s[40:41] sc1
v_lshlrev_b32 v6, 4, v0
s_lshl_b32 s27, s21, 11
v_add_u32 v6, s27, v6
v_cvt_pk_bf16_f32 v104, v80, v81
v_cvt_pk_bf16_f32 v105, v82, v83
v_cvt_pk_bf16_f32 v106, v84, v85
v_cvt_pk_bf16_f32 v107, v86, v87
global_store_dwordx4 v6, v[104:107], s[42:43] offset:0 sc1
v_cvt_pk_bf16_f32 v108, v88, v89
v_cvt_pk_bf16_f32 v109, v90, v91
v_cvt_pk_bf16_f32 v110, v92, v93
v_cvt_pk_bf16_f32 v111, v94, v95
global_store_dwordx4 v6, v[108:111], s[42:43] offset:1024 sc1
s_add_u32 s40, s40, 524288
s_addc_u32 s41, s41, 0
s_add_u32 s42, s42, 524288
s_addc_u32 s43, s43, 0
s_add_u32 s46, s46, 1
s_cmp_ge_u32 s35, 64
s_cbranch_scc1 L_kv_fin
L_kv_seg1:
s_waitcnt vmcnt(0)
s_barrier
v_mov_b32 v16, s46
s_mov_b64 exec, s[44:45]
global_store_dword v15, v16, s[48:49] sc1
s_mov_b64 exec, -1
s_add_u32 s35, s35, 2
s_add_u32 s32, s32, 65536
s_add_u32 s34, s33, 0
ds_read_b128 v[32:35], v8 offset:32768
ds_read_b128 v[36:39], v8 offset:49152
ds_read_b128 v[40:43], v9 offset:32768
ds_read_b128 v[44:47], v9 offset:49152
ds_read_b128 v[48:51], v10 offset:32768
ds_read_b128 v[52:55], v10 offset:49152
s_cmp_ge_u32 s35, 64
s_cbranch_scc1 L_kv_nopf1
v_xor_b32 v12, 0, v7
s_add_u32 m0, s34, 0
s_add_u32 s29, s32, 0
buffer_load_dwordx4 v12, s[52:55], s29 offen lds
v_xor_b32 v13, 16, v7
s_add_u32 m0, s34, 1024
s_add_u32 s29, s32, 1024
buffer_load_dwordx4 v13, s[52:55], s29 offen lds
v_xor_b32 v12, 32, v7
s_add_u32 m0, s34, 2048
s_add_u32 s29, s32, 2048
buffer_load_dwordx4 v12, s[52:55], s29 offen lds
v_xor_b32 v13, 48, v7
s_add_u32 m0, s34, 3072
s_add_u32 s29, s32, 3072
buffer_load_dwordx4 v13, s[52:55], s29 offen lds
v_xor_b32 v12, 64, v7
s_add_u32 m0, s34, 4096
s_add_u32 s29, s32, 4096
buffer_load_dwordx4 v12, s[52:55], s29 offen lds
v_xor_b32 v13, 80, v7
s_add_u32 m0, s34, 5120
s_add_u32 s29, s32, 5120
buffer_load_dwordx4 v13, s[52:55], s29 offen lds
v_xor_b32 v12, 96, v7
s_add_u32 m0, s34, 6144
s_add_u32 s29, s32, 6144
buffer_load_dwordx4 v12, s[52:55], s29 offen lds
v_xor_b32 v13, 112, v7
s_add_u32 m0, s34, 7168
s_add_u32 s29, s32, 7168
buffer_load_dwordx4 v13, s[52:55], s29 offen lds
L_kv_nopf1:
s_waitcnt lgkmcnt(4)
v_mfma_f32_16x16x32_bf16 v[64:67], a[0:3], v[32:35], 0
ds_read_b128 v[56:59], v11 offset:32768
v_mfma_f32_16x16x32_bf16 v[68:71], a[64:67], v[32:35], 0
v_mfma_f32_16x16x32_bf16 v[80:83], v[32:35], a[128:131], 0
v_mfma_f32_16x16x32_bf16 v[88:91], v[32:35], a[192:195], 0
v_mfma_f32_16x16x32_bf16 v[72:75], a[0:3], v[36:39], 0
ds_read_b128 v[60:63], v11 offset:49152
v_mfma_f32_16x16x32_bf16 v[76:79], a[64:67], v[36:39], 0
v_mfma_f32_16x16x32_bf16 v[84:87], v[36:39], a[128:131], 0
v_mfma_f32_16x16x32_bf16 v[92:95], v[36:39], a[192:195], 0
s_waitcnt lgkmcnt(4)
v_mfma_f32_16x16x32_bf16 v[64:67], a[4:7], v[40:43], v[64:67]
ds_read_b128 v[32:35], v8 offset:33024
v_mfma_f32_16x16x32_bf16 v[68:71], a[68:71], v[40:43], v[68:71]
v_mfma_f32_16x16x32_bf16 v[80:83], v[40:43], a[132:135], v[80:83]
v_mfma_f32_16x16x32_bf16 v[88:91], v[40:43], a[196:199], v[88:91]
v_mfma_f32_16x16x32_bf16 v[72:75], a[4:7], v[44:47], v[72:75]
ds_read_b128 v[36:39], v8 offset:49408
v_mfma_f32_16x16x32_bf16 v[76:79], a[68:71], v[44:47], v[76:79]
v_mfma_f32_16x16x32_bf16 v[84:87], v[44:47], a[132:135], v[84:87]
v_mfma_f32_16x16x32_bf16 v[92:95], v[44:47], a[196:199], v[92:95]
s_waitcnt lgkmcnt(4)
v_mfma_f32_16x16x32_bf16 v[64:67], a[8:11], v[48:51], v[64:67]
ds_read_b128 v[40:43], v9 offset:33024
v_mfma_f32_16x16x32_bf16 v[68:71], a[72:75], v[48:51], v[68:71]
v_mfma_f32_16x16x32_bf16 v[80:83], v[48:51], a[136:139], v[80:83]
v_mfma_f32_16x16x32_bf16 v[88:91], v[48:51], a[200:203], v[88:91]
v_mfma_f32_16x16x32_bf16 v[72:75], a[8:11], v[52:55], v[72:75]
ds_read_b128 v[44:47], v9 offset:49408
v_mfma_f32_16x16x32_bf16 v[76:79], a[72:75], v[52:55], v[76:79]
v_mfma_f32_16x16x32_bf16 v[84:87], v[52:55], a[136:139], v[84:87]
v_mfma_f32_16x16x32_bf16 v[92:95], v[52:55], a[200:203], v[92:95]
s_waitcnt lgkmcnt(4)
v_mfma_f32_16x16x32_bf16 v[64:67], a[12:15], v[56:59], v[64:67]
ds_read_b128 v[48:51], v10 offset:33024
v_mfma_f32_16x16x32_bf16 v[68:71], a[76:79], v[56:59], v[68:71]
v_mfma_f32_16x16x32_bf16 v[80:83], v[56:59], a[140:143], v[80:83]
v_mfma_f32_16x16x32_bf16 v[88:91], v[56:59], a[204:207], v[88:91]
v_mfma_f32_16x16x32_bf16 v[72:75], a[12:15], v[60:63], v[72:75]
ds_read_b128 v[52:55], v10 offset:49408
v_mfma_f32_16x16x32_bf16 v[76:79], a[76:79], v[60:63], v[76:79]
v_mfma_f32_16x16x32_bf16 v[84:87], v[60:63], a[140:143], v[84:87]
v_mfma_f32_16x16x32_bf16 v[92:95], v[60:63], a[204:207], v[92:95]
s_waitcnt lgkmcnt(4)
v_mfma_f32_16x16x32_bf16 v[64:67], a[16:19], v[32:35], v[64:67]
ds_read_b128 v[56:59], v11 offset:33024
v_mfma_f32_16x16x32_bf16 v[68:71], a[80:83], v[32:35], v[68:71]
v_mfma_f32_16x16x32_bf16 v[80:83], v[32:35], a[144:147], v[80:83]
v_mfma_f32_16x16x32_bf16 v[88:91], v[32:35], a[208:211], v[88:91]
v_mfma_f32_16x16x32_bf16 v[72:75], a[16:19], v[36:39], v[72:75]
ds_read_b128 v[60:63], v11 offset:49408
v_mfma_f32_16x16x32_bf16 v[76:79], a[80:83], v[36:39], v[76:79]
v_mfma_f32_16x16x32_bf16 v[84:87], v[36:39], a[144:147], v[84:87]
v_mfma_f32_16x16x32_bf16 v[92:95], v[36:39], a[208:211], v[92:95]
s_waitcnt lgkmcnt(4)
v_mfma_f32_16x16x32_bf16 v[64:67], a[20:23], v[40:43], v[64:67]
ds_read_b128 v[32:35], v8 offset:33280
v_mfma_f32_16x16x32_bf16 v[68:71], a[84:87], v[40:43], v[68:71]
v_mfma_f32_16x16x32_bf16 v[80:83], v[40:43], a[148:151], v[80:83]
v_mfma_f32_16x16x32_bf16 v[88:91], v[40:43], a[212:215], v[88:91]
v_mfma_f32_16x16x32_bf16 v[72:75], a[20:23], v[44:47], v[72:75]
ds_read_b128 v[36:39], v8 offset:49664
v_mfma_f32_16x16x32_bf16 v[76:79], a[84:87], v[44:47], v[76:79]
v_mfma_f32_16x16x32_bf16 v[84:87], v[44:47], a[148:151], v[84:87]
v_mfma_f32_16x16x32_bf16 v[92:95], v[44:47], a[212:215], v[92:95]
s_waitcnt lgkmcnt(4)
v_mfma_f32_16x16x32_bf16 v[64:67], a[24:27], v[48:51], v[64:67]
ds_read_b128 v[40:43], v9 offset:33280
v_mfma_f32_16x16x32_bf16 v[68:71], a[88:91], v[48:51], v[68:71]
v_mfma_f32_16x16x32_bf16 v[80:83], v[48:51], a[152:155], v[80:83]
v_mfma_f32_16x16x32_bf16 v[88:91], v[48:51], a[216:219], v[88:91]
v_mfma_f32_16x16x32_bf16 v[72:75], a[24:27], v[52:55], v[72:75]
ds_read_b128 v[44:47], v9 offset:49664
v_mfma_f32_16x16x32_bf16 v[76:79], a[88:91], v[52:55], v[76:79]
v_mfma_f32_16x16x32_bf16 v[84:87], v[52:55], a[152:155], v[84:87]
v_mfma_f32_16x16x32_bf16 v[92:95], v[52:55], a[216:219], v[92:95]
s_waitcnt lgkmcnt(4)
v_mfma_f32_16x16x32_bf16 v[64:67], a[28:31], v[56:59], v[64:67]
ds_read_b128 v[48:51], v10 offset:33280
v_mfma_f32_16x16x32_bf16 v[68:71], a[92:95], v[56:59], v[68:71]
v_mfma_f32_16x16x32_bf16 v[80:83], v[56:59], a[156:159], v[80:83]
v_mfma_f32_16x16x32_bf16 v[88:91], v[56:59], a[220:223], v[88:91]
v_mfma_f32_16x16x32_bf16 v[72:75], a[28:31], v[60:63], v[72:75]
ds_read_b128 v[52:55], v10 offset:49664
v_mfma_f32_16x16x32_bf16 v[76:79], a[92:95], v[60:63], v[76:79]
v_mfma_f32_16x16x32_bf16 v[84:87], v[60:63], a[156:159], v[84:87]
v_mfma_f32_16x16x32_bf16 v[92:95], v[60:63], a[220:223], v[92:95]
s_waitcnt lgkmcnt(4)
v_mfma_f32_16x16x32_bf16 v[64:67], a[32:35], v[32:35], v[64:67]
ds_read_b128 v[56:59], v11 offset:33280
v_mfma_f32_16x16x32_bf16 v[68:71], a[96:99], v[32:35], v[68:71]
v_mfma_f32_16x16x32_bf16 v[80:83], v[32:35], a[160:163], v[80:83]
v_mfma_f32_16x16x32_bf16 v[88:91], v[32:35], a[224:227], v[88:91]
v_mfma_f32_16x16x32_bf16 v[72:75], a[32:35], v[36:39], v[72:75]
ds_read_b128 v[60:63], v11 offset:49664
v_mfma_f32_16x16x32_bf16 v[76:79], a[96:99], v[36:39], v[76:79]
v_mfma_f32_16x16x32_bf16 v[84:87], v[36:39], a[160:163], v[84:87]
v_mfma_f32_16x16x32_bf16 v[92:95], v[36:39], a[224:227], v[92:95]
s_waitcnt lgkmcnt(4)
v_mfma_f32_16x16x32_bf16 v[64:67], a[36:39], v[40:43], v[64:67]
ds_read_b128 v[32:35], v8 offset:33536
v_mfma_f32_16x16x32_bf16 v[68:71], a[100:103], v[40:43], v[68:71]
v_mfma_f32_16x16x32_bf16 v[80:83], v[40:43], a[164:167], v[80:83]
v_mfma_f32_16x16x32_bf16 v[88:91], v[40:43], a[228:231], v[88:91]
v_mfma_f32_16x16x32_bf16 v[72:75], a[36:39], v[44:47], v[72:75]
ds_read_b128 v[36:39], v8 offset:49920
v_mfma_f32_16x16x32_bf16 v[76:79], a[100:103], v[44:47], v[76:79]
v_mfma_f32_16x16x32_bf16 v[84:87], v[44:47], a[164:167], v[84:87]
v_mfma_f32_16x16x32_bf16 v[92:95], v[44:47], a[228:231], v[92:95]
s_waitcnt lgkmcnt(4)
v_mfma_f32_16x16x32_bf16 v[64:67], a[40:43], v[48:51], v[64:67]
ds_read_b128 v[40:43], v9 offset:33536
v_mfma_f32_16x16x32_bf16 v[68:71], a[104:107], v[48:51], v[68:71]
v_mfma_f32_16x16x32_bf16 v[80:83], v[48:51], a[168:171], v[80:83]
v_mfma_f32_16x16x32_bf16 v[88:91], v[48:51], a[232:235], v[88:91]
v_mfma_f32_16x16x32_bf16 v[72:75], a[40:43], v[52:55], v[72:75]
ds_read_b128 v[44:47], v9 offset:49920
v_mfma_f32_16x16x32_bf16 v[76:79], a[104:107], v[52:55], v[76:79]
v_mfma_f32_16x16x32_bf16 v[84:87], v[52:55], a[168:171], v[84:87]
v_mfma_f32_16x16x32_bf16 v[92:95], v[52:55], a[232:235], v[92:95]
s_waitcnt lgkmcnt(4)
v_mfma_f32_16x16x32_bf16 v[64:67], a[44:47], v[56:59], v[64:67]
ds_read_b128 v[48:51], v10 offset:33536
v_mfma_f32_16x16x32_bf16 v[68:71], a[108:111], v[56:59], v[68:71]
v_mfma_f32_16x16x32_bf16 v[80:83], v[56:59], a[172:175], v[80:83]
v_mfma_f32_16x16x32_bf16 v[88:91], v[56:59], a[236:239], v[88:91]
v_mfma_f32_16x16x32_bf16 v[72:75], a[44:47], v[60:63], v[72:75]
ds_read_b128 v[52:55], v10 offset:49920
v_mfma_f32_16x16x32_bf16 v[76:79], a[108:111], v[60:63], v[76:79]
v_mfma_f32_16x16x32_bf16 v[84:87], v[60:63], a[172:175], v[84:87]
v_mfma_f32_16x16x32_bf16 v[92:95], v[60:63], a[236:239], v[92:95]
s_waitcnt lgkmcnt(4)
v_mfma_f32_16x16x32_bf16 v[64:67], a[48:51], v[32:35], v[64:67]
ds_read_b128 v[56:59], v11 offset:33536
v_mfma_f32_16x16x32_bf16 v[68:71], a[112:115], v[32:35], v[68:71]
v_mfma_f32_16x16x32_bf16 v[80:83], v[32:35], a[176:179], v[80:83]
v_mfma_f32_16x16x32_bf16 v[88:91], v[32:35], a[240:243], v[88:91]
v_mfma_f32_16x16x32_bf16 v[72:75], a[48:51], v[36:39], v[72:75]
ds_read_b128 v[60:63], v11 offset:49920
v_mfma_f32_16x16x32_bf16 v[76:79], a[112:115], v[36:39], v[76:79]
v_mfma_f32_16x16x32_bf16 v[84:87], v[36:39], a[176:179], v[84:87]
v_mfma_f32_16x16x32_bf16 v[92:95], v[36:39], a[240:243], v[92:95]
s_waitcnt lgkmcnt(4)
v_mfma_f32_16x16x32_bf16 v[64:67], a[52:55], v[40:43], v[64:67]
v_mfma_f32_16x16x32_bf16 v[68:71], a[116:119], v[40:43], v[68:71]
v_mfma_f32_16x16x32_bf16 v[80:83], v[40:43], a[180:183], v[80:83]
v_mfma_f32_16x16x32_bf16 v[88:91], v[40:43], a[244:247], v[88:91]
v_mfma_f32_16x16x32_bf16 v[72:75], a[52:55], v[44:47], v[72:75]
v_mfma_f32_16x16x32_bf16 v[76:79], a[116:119], v[44:47], v[76:79]
v_mfma_f32_16x16x32_bf16 v[84:87], v[44:47], a[180:183], v[84:87]
v_mfma_f32_16x16x32_bf16 v[92:95], v[44:47], a[244:247], v[92:95]
s_waitcnt lgkmcnt(2)
v_mfma_f32_16x16x32_bf16 v[64:67], a[56:59], v[48:51], v[64:67]
v_mfma_f32_16x16x32_bf16 v[68:71], a[120:123], v[48:51], v[68:71]
v_mfma_f32_16x16x32_bf16 v[80:83], v[48:51], a[184:187], v[80:83]
v_mfma_f32_16x16x32_bf16 v[88:91], v[48:51], a[248:251], v[88:91]
v_mfma_f32_16x16x32_bf16 v[72:75], a[56:59], v[52:55], v[72:75]
v_mfma_f32_16x16x32_bf16 v[76:79], a[120:123], v[52:55], v[76:79]
v_mfma_f32_16x16x32_bf16 v[84:87], v[52:55], a[184:187], v[84:87]
v_mfma_f32_16x16x32_bf16 v[92:95], v[52:55], a[248:251], v[92:95]
s_waitcnt lgkmcnt(0)
v_mfma_f32_16x16x32_bf16 v[64:67], a[60:63], v[56:59], v[64:67]
v_mfma_f32_16x16x32_bf16 v[68:71], a[124:127], v[56:59], v[68:71]
v_mfma_f32_16x16x32_bf16 v[80:83], v[56:59], a[188:191], v[80:83]
v_mfma_f32_16x16x32_bf16 v[88:91], v[56:59], a[252:255], v[88:91]
v_mfma_f32_16x16x32_bf16 v[72:75], a[60:63], v[60:63], v[72:75]
v_mfma_f32_16x16x32_bf16 v[76:79], a[124:127], v[60:63], v[76:79]
v_mfma_f32_16x16x32_bf16 v[84:87], v[60:63], a[188:191], v[84:87]
v_mfma_f32_16x16x32_bf16 v[92:95], v[60:63], a[252:255], v[92:95]
s_mov_b32 s27, 0x3e0293ee
v_mul_f32 v64, s27, v64
v_mul_f32 v65, s27, v65
v_mul_f32 v66, s27, v66
v_mul_f32 v67, s27, v67
v_mul_f32 v68, s27, v68
v_mul_f32 v69, s27, v69
v_mul_f32 v70, s27, v70
v_mul_f32 v71, s27, v71
v_mul_f32 v72, s27, v72
v_mul_f32 v73, s27, v73
v_mul_f32 v74, s27, v74
v_mul_f32 v75, s27, v75
v_mul_f32 v76, s27, v76
v_mul_f32 v77, s27, v77
v_mul_f32 v78, s27, v78
v_mul_f32 v79, s27, v79
v_cvt_pk_bf16_f32 v96, v64, v65
v_cvt_pk_bf16_f32 v97, v66, v67
v_cvt_pk_bf16_f32 v98, v68, v69
v_cvt_pk_bf16_f32 v99, v70, v71
global_store_dwordx4 v14, v[96:99], s[40:41]  sc1
v_cvt_pk_bf16_f32 v100, v72, v73
v_cvt_pk_bf16_f32 v101, v74, v75
v_cvt_pk_bf16_f32 v102, v76, v77
v_cvt_pk_bf16_f32 v103, v78, v79
v_add_u32 v5, 4096, v14
global_store_dwordx4 v5, v[100:103], s[40:41] sc1
v_lshlrev_b32 v6, 4, v0
s_lshl_b32 s27, s21, 11
v_add_u32 v6, s27, v6
v_cvt_pk_bf16_f32 v104, v80, v81
v_cvt_pk_bf16_f32 v105, v82, v83
v_cvt_pk_bf16_f32 v106, v84, v85
v_cvt_pk_bf16_f32 v107, v86, v87
global_store_dwordx4 v6, v[104:107], s[42:43] offset:0 sc1
v_cvt_pk_bf16_f32 v108, v88, v89
v_cvt_pk_bf16_f32 v109, v90, v91
v_cvt_pk_bf16_f32 v110, v92, v93
v_cvt_pk_bf16_f32 v111, v94, v95
global_store_dwordx4 v6, v[108:111], s[42:43] offset:1024 sc1
s_add_u32 s40, s40, 524288
s_addc_u32 s41, s41, 0
s_add_u32 s42, s42, 524288
s_addc_u32 s43, s43, 0
s_add_u32 s46, s46, 1
s_cmp_ge_u32 s35, 64
s_cbranch_scc1 L_kv_fin
s_branch L_kv_seg0
L_kv_fin:
s_waitcnt vmcnt(0)
s_barrier
v_mov_b32 v16, s46
s_mov_b64 exec, s[44:45]
global_store_dword v15, v16, s[48:49] sc1
s_mov_b64 exec, -1
s_waitcnt vmcnt(0)
s_endpgm
L_af:
s_cmp_lg_u32 s21, 0
s_cbranch_scc1 L_norank_a
s_waitcnt vmcnt(2)
v_mov_b32 v2, 0
s_mov_b64 exec, 1
ds_write_b32 v2, v4
s_waitcnt lgkmcnt(0)
s_mov_b64 exec, -1
L_norank_a:
s_barrier
v_mov_b32 v2, 0
ds_read_b32 v4, v2
s_waitcnt lgkmcnt(0)
v_readfirstlane_b32 s20, v4
s_barrier
s_cmp_ge_u32 s20, 32
s_cbranch_scc1 L_overflow
s_mov_b32 s26, 0
s_load_dwordx2 s[52:53], s[0:1], 0
s_load_dwordx2 s[56:57], s[0:1], 16
s_load_dwordx2 s[60:61], s[0:1], 40
s_load_dwordx2 s[64:65], s[0:1], 80
s_load_dwordx4 s[68:71], s[0:1], 64
s_load_dwordx4 s[72:75], s[0:1], 88
v_lshlrev_b32 v1, 4, v0
s_sub_u32 s35, s10, 3
s_and_b32 s27, s21, 1
s_lshr_b32 s28, s21, 1
s_lshl_b32 s95, s27, 12
s_add_u32 s16, s95, 81920
s_lshl_b32 s29, s21, 10
s_add_u32 s14, s16, s29
s_xor_b32 s15, s95, 4096
s_add_u32 s15, s15, 81920
s_add_u32 s15, s15, s29
s_lshl_b32 s29, s28, 12
s_add_u32 s17, s29, 106496
s_lshl_b32 s29, s28, 11
s_add_u32 s18, s95, s29
s_add_u32 s18, s18, 90112
s_lshl_b32 s95, s27, 11
s_add_u32 s25, s95, 151552
s_lshl_b32 s29, s21, 2
s_add_u32 s19, s25, s29
s_xor_b32 s23, s19, 2048
s_lshl_b32 s29, s28, 2
s_add_u32 s25, s25, s29
s_add_u32 s25, s25, 16
s_lshl_b32 s29, s21, 8
s_add_u32 s37, s29, 155648
s_lshl_b32 s29, s27, 8
s_add_u32 s38, s29, 156288
s_lshl_b32 s29, s28, 14
s_add_u32 s39, s29, 114688
s_mov_b32 s94, 0x3e0293ee
s_cmp_eq_u32 s21, 0
s_cselect_b32 s12, 1, 0
s_mov_b32 s13, 0
s_and_b32 s27, s21, 1
s_lshl_b32 s27, s27, 7
v_lshlrev_b32 v10, 4, v0
v_xor_b32 v10, s27, v10
v_and_b32 v52, 15, v0
v_lshrrev_b32 v53, 4, v0
v_and_b32 v2, 3, v52
v_xor_b32 v53, v53, v2
v_lshlrev_b32 v53, 4, v53
v_lshl_add_u32 v53, v52, 10, v53
v_lshrrev_b32 v52, 2, v52
v_lshl_add_u32 v2, v52, 6, v53
v_xor_b32 v3, 64, v2
v_xor_b32 v4, 128, v2
v_xor_b32 v5, 192, v2
s_and_b32 s27, s21, 1
s_lshl_b32 s27, s27, 14
v_add_u32 v2, s27, v2
v_xor_b32 v6, 16384, v2
v_add_u32 v3, s27, v3
v_xor_b32 v7, 16384, v3
v_add_u32 v4, s27, v4
v_xor_b32 v8, 16384, v4
v_add_u32 v5, s27, v5
v_xor_b32 v9, 16384, v5
v_and_b32 v52, 15, v0
v_lshrrev_b32 v53, 4, v0
v_bfe_u32 v54, v0, 2, 2
v_and_b32 v55, 3, v0
v_lshrrev_b32 v56, 1, v54
v_lshlrev_b32 v56, 3, v56
v_lshl_add_u32 v56, v53, 1, v56
v_and_b32 v57, 1, v54
v_add_u32 v56, v56, v57
v_lshlrev_b32 v56, 10, v56
v_lshl_add_u32 v56, v55, 4, v56
v_lshl_add_u32 v56, v54, 6, v56
s_lshl_b32 s27, s21, 8
s_add_u32 s27, s27, 32768
v_add_u32 v13, s27, v56
s_lshl_b32 s27, s21, 5
v_add_u32 v56, s27, v52
v_lshlrev_b32 v56, 5, v56
v_lshl_add_u32 v56, v53, 3, v56
v_add_u32 v14, 147456, v56
v_lshlrev_b32 v56, 18, v53
v_lshl_add_u32 v56, v52, 4, v56
s_lshl_b32 s27, s20, 10
s_lshl_b32 s28, s21, 8
s_add_u32 s27, s27, s28
v_add_u32 v15, s27, v56
s_and_b32 s27, s20, 1
s_lshl_b32 s27, s27, 14
s_lshr_b32 s28, s20, 1
s_lshl_b32 s28, s28, 6
s_add_u32 s27, s27, s28
s_lshl_b32 s28, s21, 4
s_add_u32 s27, s27, s28
v_lshlrev_b32 v56, 10, v52
v_and_b32 v57, 1, v53
v_lshl_add_u32 v56, v57, 3, v56
v_add_u32 v16, s27, v56
s_and_b32 s27, s21, 1
s_lshl_b32 s27, s27, 4
v_add_u32 v56, s27, v52
v_lshlrev_b32 v57, 2, v53
v_add_u32 v58, 0, v57
v_cmp_le_u32 s[76:77], v58, v56
v_add_u32 v58, 1, v57
v_cmp_le_u32 s[78:79], v58, v56
v_add_u32 v58, 2, v57
v_cmp_le_u32 s[80:81], v58, v56
v_add_u32 v58, 3, v57
v_cmp_le_u32 s[82:83], v58, v56
v_add_u32 v58, 16, v57
v_cmp_le_u32 s[84:85], v58, v56
v_add_u32 v58, 17, v57
v_cmp_le_u32 s[86:87], v58, v56
v_add_u32 v58, 18, v57
v_cmp_le_u32 s[88:89], v58, v56
v_add_u32 v58, 19, v57
v_cmp_le_u32 s[90:91], v58, v56
s_lshl_b32 s32, s35, 15
s_lshl_b32 s33, s21, 13
s_add_u32 s32, s32, s33
s_add_u32 s34, s33, 0
s_lshl_b32 s93, s35, 15
s_mul_i32 s27, s35, 262144
s_lshl_b32 s28, s20, 13
s_add_u32 s27, s27, s28
s_lshl_b32 s28, s21, 11
s_add_u32 s27, s27, s28
s_add_u32 s28, s27, 16777216
s_add_u32 s40, s48, s28
s_addc_u32 s41, s49, 0
s_add_u32 s28, s27, 33554432
s_add_u32 s42, s48, s28
s_addc_u32 s43, s49, 0
s_mul_i32 s27, s35, 131072
s_lshl_b32 s28, s20, 12
s_add_u32 s27, s27, s28
s_add_u32 s27, s27, 50462720
s_lshl_b32 s28, s21, 10
s_add_u32 s28, s28, s27
s_add_u32 s44, s48, s28
s_addc_u32 s45, s49, 0
s_lshr_b32 s28, s21, 1
s_lshl_b32 s28, s28, 11
s_add_u32 s28, s28, s27
s_add_u32 s46, s48, s28
s_addc_u32 s47, s49, 0
s_lshl_b32 s27, s20, 15
s_lshl_b32 s28, s21, 13
s_add_u32 s50, s27, s28
s_mov_b32 s51, 0
s_lshl_b32 s92, s35, 8
s_add_u32 s92, s92, 524288
s_mov_b32 s36, 1
s_mov_b32 s22, 0
s_waitcnt lgkmcnt(0)
s_mov_b32 s52, s52
s_and_b32 s53, s53, 0xffff
s_mov_b32 s54, 2097152
s_mov_b32 s55, 0x00020000
s_mov_b32 s56, s56
s_and_b32 s57, s57, 0xffff
s_mov_b32 s58, 4194304
s_mov_b32 s59, 0x00020000
s_mov_b32 s60, s60
s_and_b32 s61, s61, 0xffff
s_mov_b32 s62, 4194304
s_mov_b32 s63, 0x00020000
s_mov_b32 s64, s64
s_and_b32 s65, s65, 0xffff
s_mov_b32 s66, 1409024
s_mov_b32 s67, 0x00020000
s_lshl_b32 s27, s20, 2
s_add_u32 s27, s27, s92
v_mov_b32 v52, s27
v_mov_b32 v53, 0
v_mov_b32 v54, 192
v_mov_b32 v55, 1
s_cmp_lg_u32 s21, 0
s_cbranch_scc1 L_af_i0
s_cmp_eq_u32 s35, 4
s_cselect_b32 s28, 55, 60
s_lshl_b32 s28, s28, 17
s_add_u32 s4, s44, s28
s_addc_u32 s5, s45, 0
v_mov_b32 v56, 2139193217
v_mov_b32 v57, 2139193217
v_mov_b32 v58, 2139193217
v_mov_b32 v59, 2139193217
global_store_dwordx4 v1, v[56:59], s[4:5] offset:0 sc1
global_store_dwordx4 v1, v[56:59], s[4:5] offset:1024 sc1
global_store_dwordx4 v1, v[56:59], s[4:5] offset:2048 sc1
global_store_dwordx4 v1, v[56:59], s[4:5] offset:3072 sc1
s_sub_u32 s4, s4, 655360
s_subb_u32 s5, s5, 0
global_store_dwordx4 v1, v[56:59], s[4:5] offset:0 sc1
global_store_dwordx4 v1, v[56:59], s[4:5] offset:1024 sc1
global_store_dwordx4 v1, v[56:59], s[4:5] offset:2048 sc1
global_store_dwordx4 v1, v[56:59], s[4:5] offset:3072 sc1
s_mov_b64 exec, 1
global_store_dword v52, v53, s[48:49]
s_waitcnt vmcnt(0)
global_atomic_add v54, v55, s[8:9] sc1
s_mov_b64 exec, -1
L_af_i0:
s_mul_i32 s27, s20, 43
s_and_b32 s28, s20, 1
s_sub_u32 s27, s27, s28
s_lshl_b32 s27, s27, 1
s_mul_i32 s28, s21, 352256
s_add_u32 s27, s27, s28
v_lshrrev_b32 v52, 1, v0
v_lshlrev_b32 v52, 2, v52
v_add_u32 v52, s27, v52
v_and_b32 v53, 1, v0
v_cmp_eq_u32 vcc, 1, v53
v_mov_b32 v54, s68
v_mov_b32 v55, s70
v_cndmask_b32 v40, v54, v55, vcc
v_mov_b32 v54, s69
v_mov_b32 v55, s71
v_cndmask_b32 v41, v54, v55, vcc
v_mov_b32 v53, 0
v_lshl_add_u64 v[40:41], v[52:53], 0, v[40:41]
s_mov_b32 s30, 2752
s_mov_b32 s31, 0
s_mul_i32 s29, s21, 22528
s_mov_b32 s95, 0
s_mov_b32 exec_lo, -1
s_mov_b32 exec_hi, 0xfff
L_af_fs:
s_add_u32 m0, s29, 0
s_nop 0
global_load_lds_dword v[40:41], off
v_lshl_add_u64 v[40:41], v[40:41], 0, s[30:31]
s_add_u32 m0, s29, 176
s_nop 0
global_load_lds_dword v[40:41], off
v_lshl_add_u64 v[40:41], v[40:41], 0, s[30:31]
s_add_u32 m0, s29, 352
s_nop 0
global_load_lds_dword v[40:41], off
v_lshl_add_u64 v[40:41], v[40:41], 0, s[30:31]
s_add_u32 m0, s29, 528
s_nop 0
global_load_lds_dword v[40:41], off
v_lshl_add_u64 v[40:41], v[40:41], 0, s[30:31]
s_add_u32 m0, s29, 704
s_nop 0
global_load_lds_dword v[40:41], off
v_lshl_add_u64 v[40:41], v[40:41], 0, s[30:31]
s_add_u32 m0, s29, 880
s_nop 0
global_load_lds_dword v[40:41], off
v_lshl_add_u64 v[40:41], v[40:41], 0, s[30:31]
s_add_u32 m0, s29, 1056
s_nop 0
global_load_lds_dword v[40:41], off
v_lshl_add_u64 v[40:41], v[40:41], 0, s[30:31]
s_add_u32 m0, s29, 1232
s_nop 0
global_load_lds_dword v[40:41], off
v_lshl_add_u64 v[40:41], v[40:41], 0, s[30:31]
s_add_u32 m0, s29, 1408
s_nop 0
global_load_lds_dword v[40:41], off
v_lshl_add_u64 v[40:41], v[40:41], 0, s[30:31]
s_add_u32 m0, s29, 1584
s_nop 0
global_load_lds_dword v[40:41], off
v_lshl_add_u64 v[40:41], v[40:41], 0, s[30:31]
s_add_u32 m0, s29, 1760
s_nop 0
global_load_lds_dword v[40:41], off
v_lshl_add_u64 v[40:41], v[40:41], 0, s[30:31]
s_add_u32 m0, s29, 1936
s_nop 0
global_load_lds_dword v[40:41], off
v_lshl_add_u64 v[40:41], v[40:41], 0, s[30:31]
s_add_u32 m0, s29, 2112
s_nop 0
global_load_lds_dword v[40:41], off
v_lshl_add_u64 v[40:41], v[40:41], 0, s[30:31]
s_add_u32 m0, s29, 2288
s_nop 0
global_load_lds_dword v[40:41], off
v_lshl_add_u64 v[40:41], v[40:41], 0, s[30:31]
s_add_u32 m0, s29, 2464
s_nop 0
global_load_lds_dword v[40:41], off
v_lshl_add_u64 v[40:41], v[40:41], 0, s[30:31]
s_add_u32 m0, s29, 2640
s_nop 0
global_load_lds_dword v[40:41], off
v_lshl_add_u64 v[40:41], v[40:41], 0, s[30:31]
s_add_u32 s29, s29, 2816
s_add_u32 s95, s95, 1
s_waitcnt vmcnt(0)
s_cmp_lt_u32 s95, 8
s_cbranch_scc1 L_af_fs
s_mov_b64 exec, -1
v_lshrrev_b32 v52, 4, v0
v_bfe_u32 v53, v0, 2, 2
v_and_b32 v54, 3, v0
v_lshl_add_u32 v52, v52, 3, v53
v_mul_u32_u24 v52, 176, v52
v_lshl_add_u32 v52, v54, 3, v52
s_lshl_b32 s27, s21, 5
v_add_u32 v44, s27, v52
v_add_u32 v45, 45056, v44
s_lshr_b32 s27, s21, 1
s_lshl_b32 s27, s27, 5
s_add_u32 s27, s27, 128
s_and_b32 s28, s21, 1
s_mul_i32 s28, s28, 45056
s_add_u32 s27, s27, s28
v_add_u32 v46, s27, v52
s_and_b32 s28, s21, 1
s_lshl_b32 s28, s28, 13
s_add_u32 s28, s28, s39
v_add_u32 v47, s28, v1
s_waitcnt vmcnt(0)
s_barrier
ds_read_b64_tr_b16 v[192:193], v44 offset:0
ds_read_b64_tr_b16 v[194:195], v44 offset:704
ds_read_b64_tr_b16 v[196:197], v44 offset:5632
ds_read_b64_tr_b16 v[198:199], v44 offset:6336
ds_read_b64_tr_b16 v[200:201], v44 offset:11264
ds_read_b64_tr_b16 v[202:203], v44 offset:11968
ds_read_b64_tr_b16 v[204:205], v44 offset:16896
ds_read_b64_tr_b16 v[206:207], v44 offset:17600
s_waitcnt lgkmcnt(0)
ds_read_b64_tr_b16 v[208:209], v44 offset:22528
ds_read_b64_tr_b16 v[210:211], v44 offset:23232
ds_read_b64_tr_b16 v[212:213], v44 offset:28160
ds_read_b64_tr_b16 v[214:215], v44 offset:28864
ds_read_b64_tr_b16 v[216:217], v44 offset:33792
ds_read_b64_tr_b16 v[218:219], v44 offset:34496
ds_read_b64_tr_b16 v[220:221], v44 offset:39424
ds_read_b64_tr_b16 v[222:223], v44 offset:40128
s_waitcnt lgkmcnt(0)
ds_read_b64_tr_b16 v[224:225], v45 offset:0
ds_read_b64_tr_b16 v[226:227], v45 offset:704
ds_read_b64_tr_b16 v[228:229], v45 offset:5632
ds_read_b64_tr_b16 v[230:231], v45 offset:6336
ds_read_b64_tr_b16 v[232:233], v45 offset:11264
ds_read_b64_tr_b16 v[234:235], v45 offset:11968
ds_read_b64_tr_b16 v[236:237], v45 offset:16896
ds_read_b64_tr_b16 v[238:239], v45 offset:17600
s_waitcnt lgkmcnt(0)
ds_read_b64_tr_b16 v[240:241], v45 offset:22528
ds_read_b64_tr_b16 v[242:243], v45 offset:23232
ds_read_b64_tr_b16 v[244:245], v45 offset:28160
ds_read_b64_tr_b16 v[246:247], v45 offset:28864
ds_read_b64_tr_b16 v[248:249], v45 offset:33792
ds_read_b64_tr_b16 v[250:251], v45 offset:34496
ds_read_b64_tr_b16 v[252:253], v45 offset:39424
ds_read_b64_tr_b16 v[254:255], v45 offset:40128
s_waitcnt lgkmcnt(0)
ds_read_b64_tr_b16 v[64:65], v46 offset:0
ds_read_b64_tr_b16 v[66:67], v46 offset:704
ds_read_b64_tr_b16 v[68:69], v46 offset:5632
ds_read_b64_tr_b16 v[70:71], v46 offset:6336
ds_read_b64_tr_b16 v[72:73], v46 offset:11264
ds_read_b64_tr_b16 v[74:75], v46 offset:11968
ds_read_b64_tr_b16 v[76:77], v46 offset:16896
ds_read_b64_tr_b16 v[78:79], v46 offset:17600
s_waitcnt lgkmcnt(0)
ds_read_b64_tr_b16 v[80:81], v46 offset:22528
ds_read_b64_tr_b16 v[82:83], v46 offset:23232
ds_read_b64_tr_b16 v[84:85], v46 offset:28160
ds_read_b64_tr_b16 v[86:87], v46 offset:28864
ds_read_b64_tr_b16 v[88:89], v46 offset:33792
ds_read_b64_tr_b16 v[90:91], v46 offset:34496
ds_read_b64_tr_b16 v[92:93], v46 offset:39424
ds_read_b64_tr_b16 v[94:95], v46 offset:40128
s_waitcnt lgkmcnt(0)
s_cmp_lt_u32 s21, 2
s_cbranch_scc1 L_af_t4
s_mov_b32 exec_lo, 0xff00ff00
s_mov_b32 exec_hi, 0xff00ff00
v_mov_b32 v64, 0
v_mov_b32 v65, 0
v_mov_b32 v66, 0
v_mov_b32 v67, 0
v_mov_b32 v68, 0
v_mov_b32 v69, 0
v_mov_b32 v70, 0
v_mov_b32 v71, 0
v_mov_b32 v72, 0
v_mov_b32 v73, 0
v_mov_b32 v74, 0
v_mov_b32 v75, 0
v_mov_b32 v76, 0
v_mov_b32 v77, 0
v_mov_b32 v78, 0
v_mov_b32 v79, 0
v_mov_b32 v80, 0
v_mov_b32 v81, 0
v_mov_b32 v82, 0
v_mov_b32 v83, 0
v_mov_b32 v84, 0
v_mov_b32 v85, 0
v_mov_b32 v86, 0
v_mov_b32 v87, 0
v_mov_b32 v88, 0
v_mov_b32 v89, 0
v_mov_b32 v90, 0
v_mov_b32 v91, 0
v_mov_b32 v92, 0
v_mov_b32 v93, 0
v_mov_b32 v94, 0
v_mov_b32 v95, 0
s_mov_b64 exec, -1
v_lshrrev_b32 v52, 4, v0
v_lshlrev_b32 v52, 4, v52
s_and_b32 s27, s21, 1
s_lshl_b32 s27, s27, 9
v_add_u32 v52, s27, v52
s_mov_b32 exec_lo, 0x01000100
s_mov_b32 exec_hi, 0x01000100
global_load_dwordx4 v[64:67], v52, s[72:73] offset:0
global_load_dwordx4 v[68:71], v52, s[72:73] offset:64
global_load_dwordx4 v[72:75], v52, s[72:73] offset:128
global_load_dwordx4 v[76:79], v52, s[72:73] offset:192
global_load_dwordx4 v[80:83], v52, s[72:73] offset:256
global_load_dwordx4 v[84:87], v52, s[72:73] offset:320
global_load_dwordx4 v[88:91], v52, s[72:73] offset:384
global_load_dwordx4 v[92:95], v52, s[72:73] offset:448
s_mov_b64 exec, -1
s_waitcnt vmcnt(0)
L_af_t4:
ds_write_b128 v47, v[64:67] offset:0
ds_write_b128 v47, v[68:71] offset:1024
ds_write_b128 v47, v[72:75] offset:2048
ds_write_b128 v47, v[76:79] offset:3072
ds_write_b128 v47, v[80:83] offset:4096
ds_write_b128 v47, v[84:87] offset:5120
ds_write_b128 v47, v[88:91] offset:6144
ds_write_b128 v47, v[92:95] offset:7168
s_waitcnt lgkmcnt(0)
s_barrier
v_lshrrev_b32 v52, 4, v0
v_and_b32 v53, 15, v0
v_lshlrev_b32 v54, 2, v52
v_xor_b32 v54, v54, v53
v_lshlrev_b32 v55, 13, v52
v_lshl_add_u32 v20, v54, 4, v55
v_xor_b32 v21, 32, v20
v_bfe_u32 v53, v0, 2, 2
v_bfe_u32 v54, v0, 1, 1
v_and_b32 v55, 1, v0
v_and_b32 v56, 1, v52
v_lshl_add_u32 v57, v53, 1, v56
v_lshlrev_b32 v57, 1, v57
s_lshl_b32 s27, s21, 2
v_xor_b32 v57, s27, v57
v_add_u32 v57, v57, v54
v_lshlrev_b32 v57, 4, v57
v_lshl_add_u32 v57, v55, 3, v57
v_lshl_add_u32 v57, v53, 8, v57
v_lshl_add_u32 v22, v52, 11, v57
v_xor_b32 v23, 32, v22
s_lshl_b32 s31, s21, 12
s_lshl_b32 s30, s21, 17
s_lshl_b32 s27, s20, 8
s_add_u32 s30, s30, s27
v_xor_b32 v28, 0, v1
v_xor_b32 v29, 64, v1
v_xor_b32 v30, 128, v1
v_xor_b32 v31, 192, v1
v_lshrrev_b32 v52, 4, v0
v_bfe_u32 v53, v0, 2, 2
v_and_b32 v54, 3, v0
v_lshl_add_u32 v52, v52, 2, v53
v_lshlrev_b32 v52, 10, v52
v_lshl_add_u32 v52, v54, 4, v52
v_lshl_add_u32 v52, v53, 6, v52
s_lshl_b32 s27, s21, 8
v_add_u32 v32, s27, v52
s_lshl_b32 s95, s20, 17
s_lshl_b32 s27, s21, 12
s_add_u32 s95, s95, s27
v_xor_b32 v33, 64, v32
v_xor_b32 v34, 128, v32
v_xor_b32 v35, 192, v32
s_add_u32 m0, s31, 0 + 0
s_add_u32 s29, s30, 0
buffer_load_dwordx4 v20, s[56:59], s29 offen lds
s_add_u32 m0, s31, 0 + 1024
s_add_u32 s29, s30, 32768
buffer_load_dwordx4 v20, s[56:59], s29 offen lds
s_add_u32 m0, s31, 0 + 2048
s_add_u32 s29, s30, 65536
buffer_load_dwordx4 v21, s[56:59], s29 offen lds
s_add_u32 m0, s31, 0 + 3072
s_add_u32 s29, s30, 98304
buffer_load_dwordx4 v21, s[56:59], s29 offen lds
s_waitcnt vmcnt(0) lgkmcnt(0)
s_barrier
s_add_u32 m0, s31, 16384 + 0
s_add_u32 s29, s30, 524288
buffer_load_dwordx4 v20, s[56:59], s29 offen lds
s_add_u32 m0, s31, 16384 + 1024
s_add_u32 s29, s30, 557056
buffer_load_dwordx4 v20, s[56:59], s29 offen lds
s_add_u32 m0, s31, 16384 + 2048
s_add_u32 s29, s30, 589824
buffer_load_dwordx4 v21, s[56:59], s29 offen lds
s_add_u32 m0, s31, 16384 + 3072
s_add_u32 s29, s30, 622592
buffer_load_dwordx4 v21, s[56:59], s29 offen lds
v_add_u32 v24, 0, v22
v_add_u32 v25, 0, v23
ds_read_b64_tr_b16 a[0:1], v24 offset:0
ds_read_b64_tr_b16 a[2:3], v24 offset:1024
ds_read_b64_tr_b16 a[4:5], v24 offset:8192
ds_read_b64_tr_b16 a[6:7], v24 offset:9216
ds_read_b64_tr_b16 a[64:65], v25 offset:0
ds_read_b64_tr_b16 a[66:67], v25 offset:1024
ds_read_b64_tr_b16 a[68:69], v25 offset:8192
ds_read_b64_tr_b16 a[70:71], v25 offset:9216
s_waitcnt vmcnt(0) lgkmcnt(0)
s_barrier
s_add_u32 m0, s31, 32768 + 0
s_add_u32 s29, s30, 1048576
buffer_load_dwordx4 v20, s[56:59], s29 offen lds
s_add_u32 m0, s31, 32768 + 1024
s_add_u32 s29, s30, 1081344
buffer_load_dwordx4 v20, s[56:59], s29 offen lds
s_add_u32 m0, s31, 32768 + 2048
s_add_u32 s29, s30, 1114112
buffer_load_dwordx4 v21, s[56:59], s29 offen lds
s_add_u32 m0, s31, 32768 + 3072
s_add_u32 s29, s30, 1146880
buffer_load_dwordx4 v21, s[56:59], s29 offen lds
v_add_u32 v24, 16384, v22
v_add_u32 v25, 16384, v23
ds_read_b64_tr_b16 a[8:9], v24 offset:0
ds_read_b64_tr_b16 a[10:11], v24 offset:1024
ds_read_b64_tr_b16 a[12:13], v24 offset:8192
ds_read_b64_tr_b16 a[14:15], v24 offset:9216
ds_read_b64_tr_b16 a[72:73], v25 offset:0
ds_read_b64_tr_b16 a[74:75], v25 offset:1024
ds_read_b64_tr_b16 a[76:77], v25 offset:8192
ds_read_b64_tr_b16 a[78:79], v25 offset:9216
s_waitcnt vmcnt(0) lgkmcnt(0)
s_barrier
s_add_u32 m0, s31, 49152 + 0
s_add_u32 s29, s30, 1572864
buffer_load_dwordx4 v20, s[56:59], s29 offen lds
s_add_u32 m0, s31, 49152 + 1024
s_add_u32 s29, s30, 1605632
buffer_load_dwordx4 v20, s[56:59], s29 offen lds
s_add_u32 m0, s31, 49152 + 2048
s_add_u32 s29, s30, 1638400
buffer_load_dwordx4 v21, s[56:59], s29 offen lds
s_add_u32 m0, s31, 49152 + 3072
s_add_u32 s29, s30, 1671168
buffer_load_dwordx4 v21, s[56:59], s29 offen lds
v_add_u32 v24, 32768, v22
v_add_u32 v25, 32768, v23
ds_read_b64_tr_b16 a[16:17], v24 offset:0
ds_read_b64_tr_b16 a[18:19], v24 offset:1024
ds_read_b64_tr_b16 a[20:21], v24 offset:8192
ds_read_b64_tr_b16 a[22:23], v24 offset:9216
ds_read_b64_tr_b16 a[80:81], v25 offset:0
ds_read_b64_tr_b16 a[82:83], v25 offset:1024
ds_read_b64_tr_b16 a[84:85], v25 offset:8192
ds_read_b64_tr_b16 a[86:87], v25 offset:9216
s_waitcnt vmcnt(0) lgkmcnt(0)
s_barrier
s_add_u32 m0, s31, 65536 + 0
s_add_u32 s29, s30, 2097152
buffer_load_dwordx4 v20, s[56:59], s29 offen lds
s_add_u32 m0, s31, 65536 + 1024
s_add_u32 s29, s30, 2129920
buffer_load_dwordx4 v20, s[56:59], s29 offen lds
s_add_u32 m0, s31, 65536 + 2048
s_add_u32 s29, s30, 2162688
buffer_load_dwordx4 v21, s[56:59], s29 offen lds
s_add_u32 m0, s31, 65536 + 3072
s_add_u32 s29, s30, 2195456
buffer_load_dwordx4 v21, s[56:59], s29 offen lds
v_add_u32 v24, 49152, v22
v_add_u32 v25, 49152, v23
ds_read_b64_tr_b16 a[24:25], v24 offset:0
ds_read_b64_tr_b16 a[26:27], v24 offset:1024
ds_read_b64_tr_b16 a[28:29], v24 offset:8192
ds_read_b64_tr_b16 a[30:31], v24 offset:9216
ds_read_b64_tr_b16 a[88:89], v25 offset:0
ds_read_b64_tr_b16 a[90:91], v25 offset:1024
ds_read_b64_tr_b16 a[92:93], v25 offset:8192
ds_read_b64_tr_b16 a[94:95], v25 offset:9216
s_waitcnt vmcnt(0) lgkmcnt(0)
s_barrier
s_add_u32 m0, s31, 81920 + 0
s_add_u32 s29, s30, 2621440
buffer_load_dwordx4 v20, s[56:59], s29 offen lds
s_add_u32 m0, s31, 81920 + 1024
s_add_u32 s29, s30, 2654208
buffer_load_dwordx4 v20, s[56:59], s29 offen lds
s_add_u32 m0, s31, 81920 + 2048
s_add_u32 s29, s30, 2686976
buffer_load_dwordx4 v21, s[56:59], s29 offen lds
s_add_u32 m0, s31, 81920 + 3072
s_add_u32 s29, s30, 2719744
buffer_load_dwordx4 v21, s[56:59], s29 offen lds
v_add_u32 v24, 65536, v22
v_add_u32 v25, 65536, v23
ds_read_b64_tr_b16 a[32:33], v24 offset:0
ds_read_b64_tr_b16 a[34:35], v24 offset:1024
ds_read_b64_tr_b16 a[36:37], v24 offset:8192
ds_read_b64_tr_b16 a[38:39], v24 offset:9216
ds_read_b64_tr_b16 a[96:97], v25 offset:0
ds_read_b64_tr_b16 a[98:99], v25 offset:1024
ds_read_b64_tr_b16 a[100:101], v25 offset:8192
ds_read_b64_tr_b16 a[102:103], v25 offset:9216
s_waitcnt vmcnt(0) lgkmcnt(0)
s_barrier
s_add_u32 m0, s31, 0 + 0
s_add_u32 s29, s30, 3145728
buffer_load_dwordx4 v20, s[56:59], s29 offen lds
s_add_u32 m0, s31, 0 + 1024
s_add_u32 s29, s30, 3178496
buffer_load_dwordx4 v20, s[56:59], s29 offen lds
s_add_u32 m0, s31, 0 + 2048
s_add_u32 s29, s30, 3211264
buffer_load_dwordx4 v21, s[56:59], s29 offen lds
s_add_u32 m0, s31, 0 + 3072
s_add_u32 s29, s30, 3244032
buffer_load_dwordx4 v21, s[56:59], s29 offen lds
v_add_u32 v24, 81920, v22
v_add_u32 v25, 81920, v23
ds_read_b64_tr_b16 a[40:41], v24 offset:0
ds_read_b64_tr_b16 a[42:43], v24 offset:1024
ds_read_b64_tr_b16 a[44:45], v24 offset:8192
ds_read_b64_tr_b16 a[46:47], v24 offset:9216
ds_read_b64_tr_b16 a[104:105], v25 offset:0
ds_read_b64_tr_b16 a[106:107], v25 offset:1024
ds_read_b64_tr_b16 a[108:109], v25 offset:8192
ds_read_b64_tr_b16 a[110:111], v25 offset:9216
s_waitcnt vmcnt(0) lgkmcnt(0)
s_barrier
s_add_u32 m0, s31, 16384 + 0
s_add_u32 s29, s30, 3670016
buffer_load_dwordx4 v20, s[56:59], s29 offen lds
s_add_u32 m0, s31, 16384 + 1024
s_add_u32 s29, s30, 3702784
buffer_load_dwordx4 v20, s[56:59], s29 offen lds
s_add_u32 m0, s31, 16384 + 2048
s_add_u32 s29, s30, 3735552
buffer_load_dwordx4 v21, s[56:59], s29 offen lds
s_add_u32 m0, s31, 16384 + 3072
s_add_u32 s29, s30, 3768320
buffer_load_dwordx4 v21, s[56:59], s29 offen lds
v_add_u32 v24, 0, v22
v_add_u32 v25, 0, v23
ds_read_b64_tr_b16 a[48:49], v24 offset:0
ds_read_b64_tr_b16 a[50:51], v24 offset:1024
ds_read_b64_tr_b16 a[52:53], v24 offset:8192
ds_read_b64_tr_b16 a[54:55], v24 offset:9216
ds_read_b64_tr_b16 a[112:113], v25 offset:0
ds_read_b64_tr_b16 a[114:115], v25 offset:1024
ds_read_b64_tr_b16 a[116:117], v25 offset:8192
ds_read_b64_tr_b16 a[118:119], v25 offset:9216
s_waitcnt vmcnt(0) lgkmcnt(0)
s_barrier
s_add_u32 m0, s31, 32768 + 0
s_add_u32 s29, s95, 0
buffer_load_dwordx4 v28, s[60:63], s29 offen lds
s_add_u32 m0, s31, 32768 + 1024
s_add_u32 s29, s95, 1024
buffer_load_dwordx4 v29, s[60:63], s29 offen lds
s_add_u32 m0, s31, 32768 + 2048
s_add_u32 s29, s95, 2048
buffer_load_dwordx4 v30, s[60:63], s29 offen lds
s_add_u32 m0, s31, 32768 + 3072
s_add_u32 s29, s95, 3072
buffer_load_dwordx4 v31, s[60:63], s29 offen lds
v_add_u32 v24, 16384, v22
v_add_u32 v25, 16384, v23
ds_read_b64_tr_b16 a[56:57], v24 offset:0
ds_read_b64_tr_b16 a[58:59], v24 offset:1024
ds_read_b64_tr_b16 a[60:61], v24 offset:8192
ds_read_b64_tr_b16 a[62:63], v24 offset:9216
ds_read_b64_tr_b16 a[120:121], v25 offset:0
ds_read_b64_tr_b16 a[122:123], v25 offset:1024
ds_read_b64_tr_b16 a[124:125], v25 offset:8192
ds_read_b64_tr_b16 a[126:127], v25 offset:9216
s_waitcnt vmcnt(0) lgkmcnt(0)
s_barrier
s_add_u32 m0, s31, 49152 + 0
s_add_u32 s29, s95, 16384
buffer_load_dwordx4 v28, s[60:63], s29 offen lds
s_add_u32 m0, s31, 49152 + 1024
s_add_u32 s29, s95, 17408
buffer_load_dwordx4 v29, s[60:63], s29 offen lds
s_add_u32 m0, s31, 49152 + 2048
s_add_u32 s29, s95, 18432
buffer_load_dwordx4 v30, s[60:63], s29 offen lds
s_add_u32 m0, s31, 49152 + 3072
s_add_u32 s29, s95, 19456
buffer_load_dwordx4 v31, s[60:63], s29 offen lds
v_add_u32 v24, 32768, v32
ds_read_b64_tr_b16 a[128:129], v24 offset:0
ds_read_b64_tr_b16 a[144:145], v24 offset:8
v_add_u32 v25, 32768, v33
ds_read_b64_tr_b16 a[160:161], v25 offset:0
ds_read_b64_tr_b16 a[176:177], v25 offset:8
v_add_u32 v24, 32768, v34
ds_read_b64_tr_b16 a[192:193], v24 offset:0
ds_read_b64_tr_b16 a[208:209], v24 offset:8
v_add_u32 v25, 32768, v35
ds_read_b64_tr_b16 a[224:225], v25 offset:0
ds_read_b64_tr_b16 a[240:241], v25 offset:8
s_waitcnt vmcnt(0) lgkmcnt(0)
s_barrier
s_add_u32 m0, s31, 65536 + 0
s_add_u32 s29, s95, 32768
buffer_load_dwordx4 v28, s[60:63], s29 offen lds
s_add_u32 m0, s31, 65536 + 1024
s_add_u32 s29, s95, 33792
buffer_load_dwordx4 v29, s[60:63], s29 offen lds
s_add_u32 m0, s31, 65536 + 2048
s_add_u32 s29, s95, 34816
buffer_load_dwordx4 v30, s[60:63], s29 offen lds
s_add_u32 m0, s31, 65536 + 3072
s_add_u32 s29, s95, 35840
buffer_load_dwordx4 v31, s[60:63], s29 offen lds
v_add_u32 v24, 49152, v32
ds_read_b64_tr_b16 a[130:131], v24 offset:0
ds_read_b64_tr_b16 a[146:147], v24 offset:8
v_add_u32 v25, 49152, v33
ds_read_b64_tr_b16 a[162:163], v25 offset:0
ds_read_b64_tr_b16 a[178:179], v25 offset:8
v_add_u32 v24, 49152, v34
ds_read_b64_tr_b16 a[194:195], v24 offset:0
ds_read_b64_tr_b16 a[210:211], v24 offset:8
v_add_u32 v25, 49152, v35
ds_read_b64_tr_b16 a[226:227], v25 offset:0
ds_read_b64_tr_b16 a[242:243], v25 offset:8
s_waitcnt vmcnt(0) lgkmcnt(0)
s_barrier
s_add_u32 m0, s31, 81920 + 0
s_add_u32 s29, s95, 49152
buffer_load_dwordx4 v28, s[60:63], s29 offen lds
s_add_u32 m0, s31, 81920 + 1024
s_add_u32 s29, s95, 50176
buffer_load_dwordx4 v29, s[60:63], s29 offen lds
s_add_u32 m0, s31, 81920 + 2048
s_add_u32 s29, s95, 51200
buffer_load_dwordx4 v30, s[60:63], s29 offen lds
s_add_u32 m0, s31, 81920 + 3072
s_add_u32 s29, s95, 52224
buffer_load_dwordx4 v31, s[60:63], s29 offen lds
v_add_u32 v24, 65536, v32
ds_read_b64_tr_b16 a[132:133], v24 offset:0
ds_read_b64_tr_b16 a[148:149], v24 offset:8
v_add_u32 v25, 65536, v33
ds_read_b64_tr_b16 a[164:165], v25 offset:0
ds_read_b64_tr_b16 a[180:181], v25 offset:8
v_add_u32 v24, 65536, v34
ds_read_b64_tr_b16 a[196:197], v24 offset:0
ds_read_b64_tr_b16 a[212:213], v24 offset:8
v_add_u32 v25, 65536, v35
ds_read_b64_tr_b16 a[228:229], v25 offset:0
ds_read_b64_tr_b16 a[244:245], v25 offset:8
s_waitcnt vmcnt(0) lgkmcnt(0)
s_barrier
s_add_u32 m0, s31, 0 + 0
s_add_u32 s29, s95, 65536
buffer_load_dwordx4 v28, s[60:63], s29 offen lds
s_add_u32 m0, s31, 0 + 1024
s_add_u32 s29, s95, 66560
buffer_load_dwordx4 v29, s[60:63], s29 offen lds
s_add_u32 m0, s31, 0 + 2048
s_add_u32 s29, s95, 67584
buffer_load_dwordx4 v30, s[60:63], s29 offen lds
s_add_u32 m0, s31, 0 + 3072
s_add_u32 s29, s95, 68608
buffer_load_dwordx4 v31, s[60:63], s29 offen lds
v_add_u32 v24, 81920, v32
ds_read_b64_tr_b16 a[134:135], v24 offset:0
ds_read_b64_tr_b16 a[150:151], v24 offset:8
v_add_u32 v25, 81920, v33
ds_read_b64_tr_b16 a[166:167], v25 offset:0
ds_read_b64_tr_b16 a[182:183], v25 offset:8
v_add_u32 v24, 81920, v34
ds_read_b64_tr_b16 a[198:199], v24 offset:0
ds_read_b64_tr_b16 a[214:215], v24 offset:8
v_add_u32 v25, 81920, v35
ds_read_b64_tr_b16 a[230:231], v25 offset:0
ds_read_b64_tr_b16 a[246:247], v25 offset:8
s_waitcnt vmcnt(0) lgkmcnt(0)
s_barrier
s_add_u32 m0, s31, 16384 + 0
s_add_u32 s29, s95, 81920
buffer_load_dwordx4 v28, s[60:63], s29 offen lds
s_add_u32 m0, s31, 16384 + 1024
s_add_u32 s29, s95, 82944
buffer_load_dwordx4 v29, s[60:63], s29 offen lds
s_add_u32 m0, s31, 16384 + 2048
s_add_u32 s29, s95, 83968
buffer_load_dwordx4 v30, s[60:63], s29 offen lds
s_add_u32 m0, s31, 16384 + 3072
s_add_u32 s29, s95, 84992
buffer_load_dwordx4 v31, s[60:63], s29 offen lds
v_add_u32 v24, 0, v32
ds_read_b64_tr_b16 a[136:137], v24 offset:0
ds_read_b64_tr_b16 a[152:153], v24 offset:8
v_add_u32 v25, 0, v33
ds_read_b64_tr_b16 a[168:169], v25 offset:0
ds_read_b64_tr_b16 a[184:185], v25 offset:8
v_add_u32 v24, 0, v34
ds_read_b64_tr_b16 a[200:201], v24 offset:0
ds_read_b64_tr_b16 a[216:217], v24 offset:8
v_add_u32 v25, 0, v35
ds_read_b64_tr_b16 a[232:233], v25 offset:0
ds_read_b64_tr_b16 a[248:249], v25 offset:8
s_waitcnt vmcnt(0) lgkmcnt(0)
s_barrier
s_add_u32 m0, s31, 32768 + 0
s_add_u32 s29, s95, 98304
buffer_load_dwordx4 v28, s[60:63], s29 offen lds
s_add_u32 m0, s31, 32768 + 1024
s_add_u32 s29, s95, 99328
buffer_load_dwordx4 v29, s[60:63], s29 offen lds
s_add_u32 m0, s31, 32768 + 2048
s_add_u32 s29, s95, 100352
buffer_load_dwordx4 v30, s[60:63], s29 offen lds
s_add_u32 m0, s31, 32768 + 3072
s_add_u32 s29, s95, 101376
buffer_load_dwordx4 v31, s[60:63], s29 offen lds
v_add_u32 v24, 16384, v32
ds_read_b64_tr_b16 a[138:139], v24 offset:0
ds_read_b64_tr_b16 a[154:155], v24 offset:8
v_add_u32 v25, 16384, v33
ds_read_b64_tr_b16 a[170:171], v25 offset:0
ds_read_b64_tr_b16 a[186:187], v25 offset:8
v_add_u32 v24, 16384, v34
ds_read_b64_tr_b16 a[202:203], v24 offset:0
ds_read_b64_tr_b16 a[218:219], v24 offset:8
v_add_u32 v25, 16384, v35
ds_read_b64_tr_b16 a[234:235], v25 offset:0
ds_read_b64_tr_b16 a[250:251], v25 offset:8
s_waitcnt vmcnt(0) lgkmcnt(0)
s_barrier
s_add_u32 m0, s31, 49152 + 0
s_add_u32 s29, s95, 114688
buffer_load_dwordx4 v28, s[60:63], s29 offen lds
s_add_u32 m0, s31, 49152 + 1024
s_add_u32 s29, s95, 115712
buffer_load_dwordx4 v29, s[60:63], s29 offen lds
s_add_u32 m0, s31, 49152 + 2048
s_add_u32 s29, s95, 116736
buffer_load_dwordx4 v30, s[60:63], s29 offen lds
s_add_u32 m0, s31, 49152 + 3072
s_add_u32 s29, s95, 117760
buffer_load_dwordx4 v31, s[60:63], s29 offen lds
v_add_u32 v24, 32768, v32
ds_read_b64_tr_b16 a[140:141], v24 offset:0
ds_read_b64_tr_b16 a[156:157], v24 offset:8
v_add_u32 v25, 32768, v33
ds_read_b64_tr_b16 a[172:173], v25 offset:0
ds_read_b64_tr_b16 a[188:189], v25 offset:8
v_add_u32 v24, 32768, v34
ds_read_b64_tr_b16 a[204:205], v24 offset:0
ds_read_b64_tr_b16 a[220:221], v24 offset:8
v_add_u32 v25, 32768, v35
ds_read_b64_tr_b16 a[236:237], v25 offset:0
ds_read_b64_tr_b16 a[252:253], v25 offset:8
s_waitcnt vmcnt(0) lgkmcnt(0)
s_barrier
v_add_u32 v24, 49152, v32
ds_read_b64_tr_b16 a[142:143], v24 offset:0
ds_read_b64_tr_b16 a[158:159], v24 offset:8
v_add_u32 v25, 49152, v33
ds_read_b64_tr_b16 a[174:175], v25 offset:0
ds_read_b64_tr_b16 a[190:191], v25 offset:8
v_add_u32 v24, 49152, v34
ds_read_b64_tr_b16 a[206:207], v24 offset:0
ds_read_b64_tr_b16 a[222:223], v24 offset:8
v_add_u32 v25, 49152, v35
ds_read_b64_tr_b16 a[238:239], v25 offset:0
ds_read_b64_tr_b16 a[254:255], v25 offset:8
s_waitcnt lgkmcnt(0)
s_barrier
s_mul_i32 s27, s20, 43
s_and_b32 s28, s20, 1
s_sub_u32 s27, s27, s28
s_mul_i32 s28, s21, 11
s_add_u32 s27, s27, s28
s_lshl_b32 s27, s27, 10
s_add_u32 s95, s28, 0
s_bfe_u32 s30, s95, 0x10003
s_lshl_b32 s30, s30, 1
s_and_b32 s29, s95, 1
s_add_u32 s30, s30, s29
s_lshl_b32 s30, s30, 6
v_xor_b32 v11, s30, v1
s_lshl_b32 s95, s95, 10
s_add_u32 m0, s95, 32768
s_add_u32 s29, s27, 0
buffer_load_dwordx4 v11, s[64:67], s29 offen lds
s_add_u32 s95, s28, 1
s_bfe_u32 s30, s95, 0x10003
s_lshl_b32 s30, s30, 1
s_and_b32 s29, s95, 1
s_add_u32 s30, s30, s29
s_lshl_b32 s30, s30, 6
v_xor_b32 v12, s30, v1
s_lshl_b32 s95, s95, 10
s_add_u32 m0, s95, 32768
s_add_u32 s29, s27, 1024
buffer_load_dwordx4 v12, s[64:67], s29 offen lds
s_add_u32 s95, s28, 2
s_bfe_u32 s30, s95, 0x10003
s_lshl_b32 s30, s30, 1
s_and_b32 s29, s95, 1
s_add_u32 s30, s30, s29
s_lshl_b32 s30, s30, 6
v_xor_b32 v11, s30, v1
s_lshl_b32 s95, s95, 10
s_add_u32 m0, s95, 32768
s_add_u32 s29, s27, 2048
buffer_load_dwordx4 v11, s[64:67], s29 offen lds
s_add_u32 s95, s28, 3
s_bfe_u32 s30, s95, 0x10003
s_lshl_b32 s30, s30, 1
s_and_b32 s29, s95, 1
s_add_u32 s30, s30, s29
s_lshl_b32 s30, s30, 6
v_xor_b32 v12, s30, v1
s_lshl_b32 s95, s95, 10
s_add_u32 m0, s95, 32768
s_add_u32 s29, s27, 3072
buffer_load_dwordx4 v12, s[64:67], s29 offen lds
s_add_u32 s95, s28, 4
s_bfe_u32 s30, s95, 0x10003
s_lshl_b32 s30, s30, 1
s_and_b32 s29, s95, 1
s_add_u32 s30, s30, s29
s_lshl_b32 s30, s30, 6
v_xor_b32 v11, s30, v1
s_lshl_b32 s95, s95, 10
s_add_u32 m0, s95, 32768
s_add_u32 s29, s27, 4096
buffer_load_dwordx4 v11, s[64:67], s29 offen lds
s_add_u32 s95, s28, 5
s_bfe_u32 s30, s95, 0x10003
s_lshl_b32 s30, s30, 1
s_and_b32 s29, s95, 1
s_add_u32 s30, s30, s29
s_lshl_b32 s30, s30, 6
v_xor_b32 v12, s30, v1
s_lshl_b32 s95, s95, 10
s_add_u32 m0, s95, 32768
s_add_u32 s29, s27, 5120
buffer_load_dwordx4 v12, s[64:67], s29 offen lds
s_add_u32 s95, s28, 6
s_bfe_u32 s30, s95, 0x10003
s_lshl_b32 s30, s30, 1
s_and_b32 s29, s95, 1
s_add_u32 s30, s30, s29
s_lshl_b32 s30, s30, 6
v_xor_b32 v11, s30, v1
s_lshl_b32 s95, s95, 10
s_add_u32 m0, s95, 32768
s_add_u32 s29, s27, 6144
buffer_load_dwordx4 v11, s[64:67], s29 offen lds
s_add_u32 s95, s28, 7
s_bfe_u32 s30, s95, 0x10003
s_lshl_b32 s30, s30, 1
s_and_b32 s29, s95, 1
s_add_u32 s30, s30, s29
s_lshl_b32 s30, s30, 6
v_xor_b32 v12, s30, v1
s_lshl_b32 s95, s95, 10
s_add_u32 m0, s95, 32768
s_add_u32 s29, s27, 7168
buffer_load_dwordx4 v12, s[64:67], s29 offen lds
s_add_u32 s95, s28, 8
s_bfe_u32 s30, s95, 0x10003
s_lshl_b32 s30, s30, 1
s_and_b32 s29, s95, 1
s_add_u32 s30, s30, s29
s_lshl_b32 s30, s30, 6
v_xor_b32 v11, s30, v1
s_lshl_b32 s95, s95, 10
s_add_u32 m0, s95, 32768
s_add_u32 s29, s27, 8192
buffer_load_dwordx4 v11, s[64:67], s29 offen lds
s_add_u32 s95, s28, 9
s_bfe_u32 s30, s95, 0x10003
s_lshl_b32 s30, s30, 1
s_and_b32 s29, s95, 1
s_add_u32 s30, s30, s29
s_lshl_b32 s30, s30, 6
v_xor_b32 v12, s30, v1
s_lshl_b32 s95, s95, 10
s_add_u32 m0, s95, 32768
s_add_u32 s29, s27, 9216
buffer_load_dwordx4 v12, s[64:67], s29 offen lds
s_add_u32 s95, s28, 10
s_bfe_u32 s30, s95, 0x10003
s_lshl_b32 s30, s30, 1
s_and_b32 s29, s95, 1
s_add_u32 s30, s30, s29
s_lshl_b32 s30, s30, 6
v_xor_b32 v11, s30, v1
s_lshl_b32 s95, s95, 10
s_add_u32 m0, s95, 32768
s_add_u32 s29, s27, 10240
buffer_load_dwordx4 v11, s[64:67], s29 offen lds
v_xor_b32 v11, 0, v10
s_add_u32 m0, s34, 0
s_add_u32 s29, s32, 0
buffer_load_dwordx4 v11, s[52:55], s29 offen lds
v_xor_b32 v12, 16, v10
s_add_u32 m0, s34, 1024
s_add_u32 s29, s32, 1024
buffer_load_dwordx4 v12, s[52:55], s29 offen lds
v_xor_b32 v11, 32, v10
s_add_u32 m0, s34, 2048
s_add_u32 s29, s32, 2048
buffer_load_dwordx4 v11, s[52:55], s29 offen lds
v_xor_b32 v12, 48, v10
s_add_u32 m0, s34, 3072
s_add_u32 s29, s32, 3072
buffer_load_dwordx4 v12, s[52:55], s29 offen lds
v_xor_b32 v11, 64, v10
s_add_u32 m0, s34, 4096
s_add_u32 s29, s32, 4096
buffer_load_dwordx4 v11, s[52:55], s29 offen lds
v_xor_b32 v12, 80, v10
s_add_u32 m0, s34, 5120
s_add_u32 s29, s32, 5120
buffer_load_dwordx4 v12, s[52:55], s29 offen lds
v_xor_b32 v11, 96, v10
s_add_u32 m0, s34, 6144
s_add_u32 s29, s32, 6144
buffer_load_dwordx4 v11, s[52:55], s29 offen lds
v_xor_b32 v12, 112, v10
s_add_u32 m0, s34, 7168
s_add_u32 s29, s32, 7168
buffer_load_dwordx4 v12, s[52:55], s29 offen lds
v_mov_b32 v20, 0
v_mov_b32 v21, 0
v_mov_b32 v22, 0
v_mov_b32 v23, 0
s_lshl_b32 s27, s21, 10
s_add_u32 s28, s27, 147456
v_add_u32 v24, s28, v1
ds_write_b128 v24, v[20:23]
s_add_u32 s28, s27, 77824
v_add_u32 v24, s28, v1
ds_write_b128 v24, v[20:23]
s_waitcnt vmcnt(0) lgkmcnt(0)
s_barrier
s_and_b32 s27, s20, 1
s_xor_b32 s27, s27, 1
s_mul_i32 s27, s27, 44032
s_add_u32 s27, s27, 32768
v_add_u32 v24, s27, v1
ds_write_b128 v24, v[20:23]
s_waitcnt lgkmcnt(0)
s_barrier
s_sub_u32 s27, s10, 3
s_lshl_b32 s27, s27, 22
s_add_u32 s27, s27, 67108864
s_add_u32 s27, s48, s27
s_addc_u32 s28, s49, 0
s_mov_b32 s60, s27
s_and_b32 s61, s28, 0xffff
s_mov_b32 s62, 3145728
s_mov_b32 s63, 0x00020000
v_mov_b32 v20, -1
v_mov_b32 v21, -1
v_mov_b32 v22, -1
v_mov_b32 v23, -1
s_add_u32 s29, s50, 0x200000
s_add_u32 s95, s29, 4096
buffer_store_dwordx4 v[20:23], v1, s[60:63], s29 offen offset:0
buffer_store_dwordx4 v[20:23], v1, s[60:63], s29 offen offset:1024
buffer_store_dwordx4 v[20:23], v1, s[60:63], s29 offen offset:2048
buffer_store_dwordx4 v[20:23], v1, s[60:63], s29 offen offset:3072
buffer_store_dwordx4 v[20:23], v1, s[60:63], s95 offen offset:0
buffer_store_dwordx4 v[20:23], v1, s[60:63], s95 offen offset:1024
buffer_store_dwordx4 v[20:23], v1, s[60:63], s95 offen offset:2048
buffer_store_dwordx4 v[20:23], v1, s[60:63], s95 offen offset:3072
s_mov_b32 s64, s74
s_and_b32 s65, s75, 0xffff
s_mov_b32 s66, 2097152
s_mov_b32 s67, 0x00020000
s_mov_b32 s24, 0
v_mov_b32 v18, 192
s_branch L_wc_a_e
L_wc_a:
s_sleep 8
L_wc_a_e:
global_load_dword v19, v18, s[8:9] sc1
s_add_u32 s24, s24, 1
s_waitcnt vmcnt(0)
v_readfirstlane_b32 s27, v19
s_cmp_eq_u32 s27, 256
s_cbranch_scc1 L_wc_a_d
s_cmp_ge_u32 s27, 65536
s_cbranch_scc1 L_fallback
s_cmp_le_u32 s24, 32768
s_cbranch_scc1 L_wc_a
v_mov_b32 v21, s27
s_or_b32 s27, s27, 65536
v_mov_b32 v20, s27
s_mov_b64 exec, 1
global_atomic_cmpswap v18, v[20:21], s[8:9] sc1
s_mov_b64 exec, -1
s_waitcnt vmcnt(0)
s_branch L_wc_a_e
L_wc_a_d:
L_af_seg:
s_cmp_lt_u32 s35, 59
s_cbranch_scc1 L_af_nowb
s_cmp_lg_u32 s21, 0
s_cbranch_scc1 L_af_nowb
s_cmp_lg_u32 s20, 0
s_cbranch_scc1 L_af_nowb
buffer_wbl2 sc1
L_af_nowb:
s_mul_i32 s27, s35, 32768
s_lshr_b32 s95, s27, 16
s_mul_i32 s27, s95, 2
s_sub_u32 s27, s35, s27
s_lshl_b32 s27, s27, 2
s_lshl_b32 s28, s20, 7
s_add_u32 s27, s27, s28
s_add_u32 s11, s27, 589824
s_mov_b32 s24, 0
s_branch L_af_kv_e
L_af_kv:
s_sleep 2
L_af_kv_e:
v_mov_b32 v17, s11
global_load_dword v17, v17, s[48:49] sc1
s_add_u32 s24, s24, 1
s_cmp_gt_u32 s24, 1048576
s_cbranch_scc1 L_af_fail
s_waitcnt vmcnt(0)
v_readfirstlane_b32 s27, v17
s_cmp_gt_u32 s27, s95
s_cbranch_scc0 L_af_kv
s_lshl_b32 s27, s21, 11
s_add_u32 m0, s27, 98304
s_nop 0
global_load_lds_dwordx4 v1, s[40:41] sc1
global_load_lds_dwordx4 v1, s[40:41] offset:1024 sc1
s_add_u32 m0, s27, 106496
s_nop 0
global_load_lds_dwordx4 v1, s[42:43] sc1
global_load_lds_dwordx4 v1, s[42:43] offset:1024 sc1
v_add_u32 v17, s39, v1
ds_read_b128 v[64:67], v2 offset:0
ds_read_b128 v[68:71], v6 offset:0
ds_read_b128 v[72:75], v17 offset:0
ds_read_b128 v[76:79], v3 offset:0
ds_read_b128 v[80:83], v7 offset:0
ds_read_b128 v[84:87], v17 offset:1024
ds_read_b128 v[88:91], v4 offset:0
ds_read_b128 v[92:95], v8 offset:0
ds_read_b128 v[96:99], v17 offset:2048
s_waitcnt lgkmcnt(6)
v_mfma_f32_16x16x32_bf16 v[112:115], a[0:3], v[64:67], 0
ds_read_b128 v[100:103], v5 offset:0
v_mfma_f32_16x16x32_bf16 v[116:119], a[64:67], v[64:67], 0
v_mfma_f32_16x16x32_bf16 v[128:131], v[192:195], v[64:67], 0
ds_read_b128 v[104:107], v9 offset:0
v_mfma_f32_16x16x32_bf16 v[120:123], a[0:3], v[68:71], 0
v_mfma_f32_16x16x32_bf16 v[124:127], a[64:67], v[68:71], 0
ds_read_b128 v[108:111], v17 offset:3072
v_mfma_f32_16x16x32_bf16 v[132:135], v[192:195], v[68:71], 0
v_mfma_f32_16x16x32_bf16 v[136:139], v[72:75], v[64:67], 0
s_waitcnt lgkmcnt(6)
v_mfma_f32_16x16x32_bf16 v[112:115], a[4:7], v[76:79], v[112:115]
ds_read_b128 v[64:67], v2 offset:256
v_mfma_f32_16x16x32_bf16 v[116:119], a[68:71], v[76:79], v[116:119]
v_mfma_f32_16x16x32_bf16 v[128:131], v[196:199], v[76:79], v[128:131]
ds_read_b128 v[68:71], v6 offset:256
v_mfma_f32_16x16x32_bf16 v[120:123], a[4:7], v[80:83], v[120:123]
v_mfma_f32_16x16x32_bf16 v[124:127], a[68:71], v[80:83], v[124:127]
ds_read_b128 v[72:75], v17 offset:4096
v_mfma_f32_16x16x32_bf16 v[132:135], v[196:199], v[80:83], v[132:135]
v_mfma_f32_16x16x32_bf16 v[136:139], v[84:87], v[76:79], v[136:139]
s_waitcnt lgkmcnt(6)
v_mfma_f32_16x16x32_bf16 v[112:115], a[8:11], v[88:91], v[112:115]
ds_read_b128 v[76:79], v3 offset:256
v_mfma_f32_16x16x32_bf16 v[116:119], a[72:75], v[88:91], v[116:119]
v_mfma_f32_16x16x32_bf16 v[128:131], v[200:203], v[88:91], v[128:131]
ds_read_b128 v[80:83], v7 offset:256
v_mfma_f32_16x16x32_bf16 v[120:123], a[8:11], v[92:95], v[120:123]
v_mfma_f32_16x16x32_bf16 v[124:127], a[72:75], v[92:95], v[124:127]
ds_read_b128 v[84:87], v17 offset:5120
v_mfma_f32_16x16x32_bf16 v[132:135], v[200:203], v[92:95], v[132:135]
v_mfma_f32_16x16x32_bf16 v[136:139], v[96:99], v[88:91], v[136:139]
s_waitcnt lgkmcnt(6)
v_mfma_f32_16x16x32_bf16 v[112:115], a[12:15], v[100:103], v[112:115]
ds_read_b128 v[88:91], v4 offset:256
v_mfma_f32_16x16x32_bf16 v[116:119], a[76:79], v[100:103], v[116:119]
v_mfma_f32_16x16x32_bf16 v[128:131], v[204:207], v[100:103], v[128:131]
ds_read_b128 v[92:95], v8 offset:256
v_mfma_f32_16x16x32_bf16 v[120:123], a[12:15], v[104:107], v[120:123]
v_mfma_f32_16x16x32_bf16 v[124:127], a[76:79], v[104:107], v[124:127]
ds_read_b128 v[96:99], v17 offset:6144
v_mfma_f32_16x16x32_bf16 v[132:135], v[204:207], v[104:107], v[132:135]
v_mfma_f32_16x16x32_bf16 v[136:139], v[108:111], v[100:103], v[136:139]
s_waitcnt lgkmcnt(6)
v_mfma_f32_16x16x32_bf16 v[112:115], a[16:19], v[64:67], v[112:115]
ds_read_b128 v[100:103], v5 offset:256
v_mfma_f32_16x16x32_bf16 v[116:119], a[80:83], v[64:67], v[116:119]
v_mfma_f32_16x16x32_bf16 v[128:131], v[208:211], v[64:67], v[128:131]
ds_read_b128 v[104:107], v9 offset:256
v_mfma_f32_16x16x32_bf16 v[120:123], a[16:19], v[68:71], v[120:123]
v_mfma_f32_16x16x32_bf16 v[124:127], a[80:83], v[68:71], v[124:127]
ds_read_b128 v[108:111], v17 offset:7168
v_mfma_f32_16x16x32_bf16 v[132:135], v[208:211], v[68:71], v[132:135]
v_mfma_f32_16x16x32_bf16 v[136:139], v[72:75], v[64:67], v[136:139]
s_waitcnt lgkmcnt(6)
v_mfma_f32_16x16x32_bf16 v[112:115], a[20:23], v[76:79], v[112:115]
ds_read_b128 v[64:67], v2 offset:512
v_mfma_f32_16x16x32_bf16 v[116:119], a[84:87], v[76:79], v[116:119]
v_mfma_f32_16x16x32_bf16 v[128:131], v[212:215], v[76:79], v[128:131]
ds_read_b128 v[68:71], v6 offset:512
v_mfma_f32_16x16x32_bf16 v[120:123], a[20:23], v[80:83], v[120:123]
v_mfma_f32_16x16x32_bf16 v[124:127], a[84:87], v[80:83], v[124:127]
ds_read_b128 v[72:75], v17 offset:8192
v_mfma_f32_16x16x32_bf16 v[132:135], v[212:215], v[80:83], v[132:135]
v_mfma_f32_16x16x32_bf16 v[136:139], v[84:87], v[76:79], v[136:139]
s_waitcnt lgkmcnt(6)
v_mfma_f32_16x16x32_bf16 v[112:115], a[24:27], v[88:91], v[112:115]
ds_read_b128 v[76:79], v3 offset:512
v_mfma_f32_16x16x32_bf16 v[116:119], a[88:91], v[88:91], v[116:119]
v_mfma_f32_16x16x32_bf16 v[128:131], v[216:219], v[88:91], v[128:131]
ds_read_b128 v[80:83], v7 offset:512
v_mfma_f32_16x16x32_bf16 v[120:123], a[24:27], v[92:95], v[120:123]
v_mfma_f32_16x16x32_bf16 v[124:127], a[88:91], v[92:95], v[124:127]
ds_read_b128 v[84:87], v17 offset:9216
v_mfma_f32_16x16x32_bf16 v[132:135], v[216:219], v[92:95], v[132:135]
v_mfma_f32_16x16x32_bf16 v[136:139], v[96:99], v[88:91], v[136:139]
s_waitcnt lgkmcnt(6)
v_mfma_f32_16x16x32_bf16 v[112:115], a[28:31], v[100:103], v[112:115]
ds_read_b128 v[88:91], v4 offset:512
v_mfma_f32_16x16x32_bf16 v[116:119], a[92:95], v[100:103], v[116:119]
v_mfma_f32_16x16x32_bf16 v[128:131], v[220:223], v[100:103], v[128:131]
ds_read_b128 v[92:95], v8 offset:512
v_mfma_f32_16x16x32_bf16 v[120:123], a[28:31], v[104:107], v[120:123]
v_mfma_f32_16x16x32_bf16 v[124:127], a[92:95], v[104:107], v[124:127]
ds_read_b128 v[96:99], v17 offset:10240
v_mfma_f32_16x16x32_bf16 v[132:135], v[220:223], v[104:107], v[132:135]
v_mfma_f32_16x16x32_bf16 v[136:139], v[108:111], v[100:103], v[136:139]
s_waitcnt lgkmcnt(6)
v_mfma_f32_16x16x32_bf16 v[112:115], a[32:35], v[64:67], v[112:115]
ds_read_b128 v[100:103], v5 offset:512
v_mfma_f32_16x16x32_bf16 v[116:119], a[96:99], v[64:67], v[116:119]
v_mfma_f32_16x16x32_bf16 v[128:131], v[224:227], v[64:67], v[128:131]
ds_read_b128 v[104:107], v9 offset:512
v_mfma_f32_16x16x32_bf16 v[120:123], a[32:35], v[68:71], v[120:123]
v_mfma_f32_16x16x32_bf16 v[124:127], a[96:99], v[68:71], v[124:127]
ds_read_b128 v[108:111], v17 offset:11264
v_mfma_f32_16x16x32_bf16 v[132:135], v[224:227], v[68:71], v[132:135]
v_mfma_f32_16x16x32_bf16 v[136:139], v[72:75], v[64:67], v[136:139]
s_waitcnt lgkmcnt(6)
v_mfma_f32_16x16x32_bf16 v[112:115], a[36:39], v[76:79], v[112:115]
ds_read_b128 v[64:67], v2 offset:768
v_mfma_f32_16x16x32_bf16 v[116:119], a[100:103], v[76:79], v[116:119]
v_mfma_f32_16x16x32_bf16 v[128:131], v[228:231], v[76:79], v[128:131]
ds_read_b128 v[68:71], v6 offset:768
v_mfma_f32_16x16x32_bf16 v[120:123], a[36:39], v[80:83], v[120:123]
v_mfma_f32_16x16x32_bf16 v[124:127], a[100:103], v[80:83], v[124:127]
ds_read_b128 v[72:75], v17 offset:12288
v_mfma_f32_16x16x32_bf16 v[132:135], v[228:231], v[80:83], v[132:135]
v_mfma_f32_16x16x32_bf16 v[136:139], v[84:87], v[76:79], v[136:139]
s_waitcnt lgkmcnt(6)
v_mfma_f32_16x16x32_bf16 v[112:115], a[40:43], v[88:91], v[112:115]
ds_read_b128 v[76:79], v3 offset:768
v_mfma_f32_16x16x32_bf16 v[116:119], a[104:107], v[88:91], v[116:119]
v_mfma_f32_16x16x32_bf16 v[128:131], v[232:235], v[88:91], v[128:131]
ds_read_b128 v[80:83], v7 offset:768
v_mfma_f32_16x16x32_bf16 v[120:123], a[40:43], v[92:95], v[120:123]
v_mfma_f32_16x16x32_bf16 v[124:127], a[104:107], v[92:95], v[124:127]
ds_read_b128 v[84:87], v17 offset:13312
v_mfma_f32_16x16x32_bf16 v[132:135], v[232:235], v[92:95], v[132:135]
v_mfma_f32_16x16x32_bf16 v[136:139], v[96:99], v[88:91], v[136:139]
s_waitcnt lgkmcnt(6)
v_mfma_f32_16x16x32_bf16 v[112:115], a[44:47], v[100:103], v[112:115]
ds_read_b128 v[88:91], v4 offset:768
v_mfma_f32_16x16x32_bf16 v[116:119], a[108:111], v[100:103], v[116:119]
v_mfma_f32_16x16x32_bf16 v[128:131], v[236:239], v[100:103], v[128:131]
ds_read_b128 v[92:95], v8 offset:768
v_mfma_f32_16x16x32_bf16 v[120:123], a[44:47], v[104:107], v[120:123]
v_mfma_f32_16x16x32_bf16 v[124:127], a[108:111], v[104:107], v[124:127]
ds_read_b128 v[96:99], v17 offset:14336
v_mfma_f32_16x16x32_bf16 v[132:135], v[236:239], v[104:107], v[132:135]
v_mfma_f32_16x16x32_bf16 v[136:139], v[108:111], v[100:103], v[136:139]
s_waitcnt lgkmcnt(6)
v_mfma_f32_16x16x32_bf16 v[112:115], a[48:51], v[64:67], v[112:115]
ds_read_b128 v[100:103], v5 offset:768
v_mfma_f32_16x16x32_bf16 v[116:119], a[112:115], v[64:67], v[116:119]
v_mfma_f32_16x16x32_bf16 v[128:131], v[240:243], v[64:67], v[128:131]
ds_read_b128 v[104:107], v9 offset:768
v_mfma_f32_16x16x32_bf16 v[120:123], a[48:51], v[68:71], v[120:123]
v_mfma_f32_16x16x32_bf16 v[124:127], a[112:115], v[68:71], v[124:127]
ds_read_b128 v[108:111], v17 offset:15360
v_mfma_f32_16x16x32_bf16 v[132:135], v[240:243], v[68:71], v[132:135]
v_mfma_f32_16x16x32_bf16 v[136:139], v[72:75], v[64:67], v[136:139]
s_waitcnt lgkmcnt(6)
v_mfma_f32_16x16x32_bf16 v[112:115], a[52:55], v[76:79], v[112:115]
v_mfma_f32_16x16x32_bf16 v[116:119], a[116:119], v[76:79], v[116:119]
v_mfma_f32_16x16x32_bf16 v[128:131], v[244:247], v[76:79], v[128:131]
v_mfma_f32_16x16x32_bf16 v[120:123], a[52:55], v[80:83], v[120:123]
v_mfma_f32_16x16x32_bf16 v[124:127], a[116:119], v[80:83], v[124:127]
v_mfma_f32_16x16x32_bf16 v[132:135], v[244:247], v[80:83], v[132:135]
v_mfma_f32_16x16x32_bf16 v[136:139], v[84:87], v[76:79], v[136:139]
s_waitcnt lgkmcnt(3)
v_mfma_f32_16x16x32_bf16 v[112:115], a[56:59], v[88:91], v[112:115]
v_mfma_f32_16x16x32_bf16 v[116:119], a[120:123], v[88:91], v[116:119]
v_mfma_f32_16x16x32_bf16 v[128:131], v[248:251], v[88:91], v[128:131]
v_mfma_f32_16x16x32_bf16 v[120:123], a[56:59], v[92:95], v[120:123]
v_mfma_f32_16x16x32_bf16 v[124:127], a[120:123], v[92:95], v[124:127]
v_mfma_f32_16x16x32_bf16 v[132:135], v[248:251], v[92:95], v[132:135]
v_mfma_f32_16x16x32_bf16 v[136:139], v[96:99], v[88:91], v[136:139]
s_waitcnt lgkmcnt(0)
v_mfma_f32_16x16x32_bf16 v[112:115], a[60:63], v[100:103], v[112:115]
v_mfma_f32_16x16x32_bf16 v[116:119], a[124:127], v[100:103], v[116:119]
v_mfma_f32_16x16x32_bf16 v[128:131], v[252:255], v[100:103], v[128:131]
v_mfma_f32_16x16x32_bf16 v[120:123], a[60:63], v[104:107], v[120:123]
v_mfma_f32_16x16x32_bf16 v[124:127], a[124:127], v[104:107], v[124:127]
v_mfma_f32_16x16x32_bf16 v[132:135], v[252:255], v[104:107], v[132:135]
v_mfma_f32_16x16x32_bf16 v[136:139], v[108:111], v[100:103], v[136:139]
v_cvt_pk_bf16_f32 v40, v112, v113
v_cvt_pk_bf16_f32 v41, v114, v115
v_cvt_pk_bf16_f32 v42, v116, v117
v_cvt_pk_bf16_f32 v43, v118, v119
v_add_u32 v11, s14, v1
ds_write_b128 v11, v[40:43]
v_cvt_pk_bf16_f32 v44, v120, v121
v_cvt_pk_bf16_f32 v45, v122, v123
v_cvt_pk_bf16_f32 v46, v124, v125
v_cvt_pk_bf16_f32 v47, v126, v127
v_add_u32 v12, s15, v1
ds_write_b128 v12, v[44:47]
s_mov_b32 s27, 0xbfb8aa3b
v_mul_f32 v128, s27, v128
v_mul_f32 v129, s27, v129
v_mul_f32 v132, s27, v132
v_mul_f32 v133, s27, v133
v_mul_f32 v136, s27, v136
v_mul_f32 v137, s27, v137
v_exp_f32 v128, v128
v_exp_f32 v129, v129
v_exp_f32 v132, v132
v_exp_f32 v133, v133
v_exp_f32 v136, v136
v_exp_f32 v137, v137
v_add_f32 v128, 1.0, v128
v_add_f32 v129, 1.0, v129
v_add_f32 v132, 1.0, v132
v_add_f32 v133, 1.0, v133
v_add_f32 v136, 1.0, v136
v_add_f32 v137, 1.0, v137
v_rcp_f32 v128, v128
v_rcp_f32 v129, v129
v_rcp_f32 v132, v132
v_rcp_f32 v133, v133
v_rcp_f32 v136, v136
v_rcp_f32 v137, v137
v_lshl_add_u32 v48, v0, 2, s37
ds_write_b32 v48, v136
v_mul_f32 v130, v128, v130
v_mul_f32 v131, v129, v131
v_mul_f32 v134, v132, v134
v_mul_f32 v135, v133, v135
v_mul_f32 v138, v136, v138
v_mul_f32 v139, v137, v139
v_cvt_pk_bf16_f32 v130, v130, v131
v_lshl_add_u32 v49, v1, 1, s19
ds_write_b32 v49, v130
v_cvt_pk_bf16_f32 v134, v134, v135
v_lshl_add_u32 v50, v1, 1, s23
ds_write_b32 v50, v134
v_cvt_pk_bf16_f32 v138, v138, v139
v_lshl_add_u32 v51, v1, 1, s25
ds_write_b32 v51, v138
s_waitcnt vmcnt(0) lgkmcnt(0)
s_barrier
s_add_u32 s32, s32, 163840
s_add_u32 s27, s35, 5
s_cmp_ge_u32 s27, 64
s_cbranch_scc1 L_af_nopf
v_xor_b32 v11, 0, v10
s_add_u32 m0, s34, 0
s_add_u32 s29, s32, 0
buffer_load_dwordx4 v11, s[52:55], s29 offen lds
v_xor_b32 v12, 16, v10
s_add_u32 m0, s34, 1024
s_add_u32 s29, s32, 1024
buffer_load_dwordx4 v12, s[52:55], s29 offen lds
v_xor_b32 v11, 32, v10
s_add_u32 m0, s34, 2048
s_add_u32 s29, s32, 2048
buffer_load_dwordx4 v11, s[52:55], s29 offen lds
v_xor_b32 v12, 48, v10
s_add_u32 m0, s34, 3072
s_add_u32 s29, s32, 3072
buffer_load_dwordx4 v12, s[52:55], s29 offen lds
v_xor_b32 v11, 64, v10
s_add_u32 m0, s34, 4096
s_add_u32 s29, s32, 4096
buffer_load_dwordx4 v11, s[52:55], s29 offen lds
v_xor_b32 v12, 80, v10
s_add_u32 m0, s34, 5120
s_add_u32 s29, s32, 5120
buffer_load_dwordx4 v12, s[52:55], s29 offen lds
v_xor_b32 v11, 96, v10
s_add_u32 m0, s34, 6144
s_add_u32 s29, s32, 6144
buffer_load_dwordx4 v11, s[52:55], s29 offen lds
v_xor_b32 v12, 112, v10
s_add_u32 m0, s34, 7168
s_add_u32 s29, s32, 7168
buffer_load_dwordx4 v12, s[52:55], s29 offen lds
s_branch L_af_pfd
L_af_nopf:
v_lshlrev_b32 v60, 3, v1
s_add_u32 s29, s51, s50
buffer_load_dword v60, v60, s[60:63], s29 offen
L_af_pfd:
v_lshl_add_u32 v48, v1, 1, 0
v_add_u32 v48, 151552, v48
ds_read_b128 v[144:147], v48 offset:0
ds_read_b64 v[152:153], v48 offset:16
ds_read_b128 v[148:151], v48 offset:2048
ds_read_b64 v[154:155], v48 offset:2064
v_and_b32 v49, 15, v0
v_lshlrev_b32 v49, 2, v49
v_add_u32 v50, s38, v49
v_add_u32 v49, 156288, v49
ds_read_b32 v156, v49
ds_read_b32 v157, v49 offset:256
ds_read_b32 v158, v50
v_xor_b32 v11, 0, v13
ds_read_b64_tr_b16 v[128:129], v11 offset:0
ds_read_b64_tr_b16 v[130:131], v11 offset:16384
ds_read_b64_tr_b16 v[132:133], v11 offset:32768
v_xor_b32 v12, 0, v13
ds_read_b64_tr_b16 v[136:137], v12 offset:8
ds_read_b64_tr_b16 v[138:139], v12 offset:16392
ds_read_b64_tr_b16 v[140:141], v12 offset:32776
s_waitcnt lgkmcnt(3)
v_mfma_f32_16x16x32_bf16 v[64:67], v[128:131], v[144:147], 0
v_mfma_f32_16x16x32_bf16 v[68:71], v[128:131], v[148:151], 0
v_mfma_f32_16x16x16_bf16 v[64:67], v[132:133], v[152:153], v[64:67]
v_mfma_f32_16x16x16_bf16 v[68:71], v[132:133], v[154:155], v[68:71]
v_xor_b32 v11, 64, v13
ds_read_b64_tr_b16 v[128:129], v11 offset:0
ds_read_b64_tr_b16 v[130:131], v11 offset:16384
ds_read_b64_tr_b16 v[132:133], v11 offset:32768
s_waitcnt lgkmcnt(3)
v_mfma_f32_16x16x32_bf16 v[72:75], v[136:139], v[144:147], 0
v_mfma_f32_16x16x32_bf16 v[76:79], v[136:139], v[148:151], 0
v_mfma_f32_16x16x16_bf16 v[72:75], v[140:141], v[152:153], v[72:75]
v_mfma_f32_16x16x16_bf16 v[76:79], v[140:141], v[154:155], v[76:79]
v_xor_b32 v12, 64, v13
ds_read_b64_tr_b16 v[136:137], v12 offset:8
ds_read_b64_tr_b16 v[138:139], v12 offset:16392
ds_read_b64_tr_b16 v[140:141], v12 offset:32776
s_waitcnt lgkmcnt(3)
v_mfma_f32_16x16x32_bf16 v[80:83], v[128:131], v[144:147], 0
v_mfma_f32_16x16x32_bf16 v[84:87], v[128:131], v[148:151], 0
v_mfma_f32_16x16x16_bf16 v[80:83], v[132:133], v[152:153], v[80:83]
v_mfma_f32_16x16x16_bf16 v[84:87], v[132:133], v[154:155], v[84:87]
v_xor_b32 v11, 128, v13
ds_read_b64_tr_b16 v[128:129], v11 offset:0
ds_read_b64_tr_b16 v[130:131], v11 offset:16384
ds_read_b64_tr_b16 v[132:133], v11 offset:32768
s_waitcnt lgkmcnt(3)
v_mfma_f32_16x16x32_bf16 v[88:91], v[136:139], v[144:147], 0
v_mfma_f32_16x16x32_bf16 v[92:95], v[136:139], v[148:151], 0
v_mfma_f32_16x16x16_bf16 v[88:91], v[140:141], v[152:153], v[88:91]
v_mfma_f32_16x16x16_bf16 v[92:95], v[140:141], v[154:155], v[92:95]
v_xor_b32 v12, 128, v13
ds_read_b64_tr_b16 v[136:137], v12 offset:8
ds_read_b64_tr_b16 v[138:139], v12 offset:16392
ds_read_b64_tr_b16 v[140:141], v12 offset:32776
s_waitcnt lgkmcnt(3)
v_mfma_f32_16x16x32_bf16 v[96:99], v[128:131], v[144:147], 0
v_mfma_f32_16x16x32_bf16 v[100:103], v[128:131], v[148:151], 0
v_mfma_f32_16x16x16_bf16 v[96:99], v[132:133], v[152:153], v[96:99]
v_mfma_f32_16x16x16_bf16 v[100:103], v[132:133], v[154:155], v[100:103]
v_xor_b32 v11, 192, v13
ds_read_b64_tr_b16 v[128:129], v11 offset:0
ds_read_b64_tr_b16 v[130:131], v11 offset:16384
ds_read_b64_tr_b16 v[132:133], v11 offset:32768
s_waitcnt lgkmcnt(3)
v_mfma_f32_16x16x32_bf16 v[104:107], v[136:139], v[144:147], 0
v_mfma_f32_16x16x32_bf16 v[108:111], v[136:139], v[148:151], 0
v_mfma_f32_16x16x16_bf16 v[104:107], v[140:141], v[152:153], v[104:107]
v_mfma_f32_16x16x16_bf16 v[108:111], v[140:141], v[154:155], v[108:111]
v_xor_b32 v12, 192, v13
ds_read_b64_tr_b16 v[136:137], v12 offset:8
ds_read_b64_tr_b16 v[138:139], v12 offset:16392
ds_read_b64_tr_b16 v[140:141], v12 offset:32776
s_waitcnt lgkmcnt(3)
v_mfma_f32_16x16x32_bf16 v[112:115], v[128:131], v[144:147], 0
v_mfma_f32_16x16x32_bf16 v[116:119], v[128:131], v[148:151], 0
v_mfma_f32_16x16x16_bf16 v[112:115], v[132:133], v[152:153], v[112:115]
v_mfma_f32_16x16x16_bf16 v[116:119], v[132:133], v[154:155], v[116:119]
s_waitcnt lgkmcnt(0)
v_mfma_f32_16x16x32_bf16 v[120:123], v[136:139], v[144:147], 0
v_mfma_f32_16x16x32_bf16 v[124:127], v[136:139], v[148:151], 0
v_mfma_f32_16x16x16_bf16 v[120:123], v[140:141], v[152:153], v[120:123]
v_mfma_f32_16x16x16_bf16 v[124:127], v[140:141], v[154:155], v[124:127]
v_add_u32 v17, s16, v1
v_add_u32 v18, 98304, v1
v_add_u32 v19, s17, v1
ds_read_b128 v[20:23], v17 offset:0
ds_read_b128 v[160:163], v18 offset:0
ds_read_b128 v[176:179], v18 offset:4096
ds_read_b128 v[24:27], v17 offset:1024
ds_read_b128 v[164:167], v18 offset:1024
ds_read_b128 v[180:183], v18 offset:5120
ds_read_b128 v[28:31], v17 offset:2048
ds_read_b128 v[168:171], v18 offset:2048
ds_read_b128 v[184:187], v18 offset:6144
ds_read_b128 v[32:35], v17 offset:3072
ds_read_b128 v[172:175], v18 offset:3072
ds_read_b128 v[188:191], v18 offset:7168
v_sub_f32 v156, 1.0, v156
v_sub_f32 v157, 1.0, v157
s_waitcnt lgkmcnt(9)
v_mfma_f32_16x16x32_bf16 v[52:55], v[160:163], v[20:23], 0
v_mfma_f32_16x16x32_bf16 v[56:59], v[176:179], v[20:23], 0
s_waitcnt lgkmcnt(6)
v_mfma_f32_16x16x32_bf16 v[52:55], v[164:167], v[24:27], v[52:55]
v_mfma_f32_16x16x32_bf16 v[56:59], v[180:183], v[24:27], v[56:59]
s_waitcnt lgkmcnt(3)
v_mfma_f32_16x16x32_bf16 v[52:55], v[168:171], v[28:31], v[52:55]
v_mfma_f32_16x16x32_bf16 v[56:59], v[184:187], v[28:31], v[56:59]
s_waitcnt lgkmcnt(0)
v_mfma_f32_16x16x32_bf16 v[52:55], v[172:175], v[32:35], v[52:55]
v_mfma_f32_16x16x32_bf16 v[56:59], v[188:191], v[32:35], v[56:59]
ds_read_b128 v[36:39], v19 offset:0
ds_read_b128 v[40:43], v19 offset:1024
ds_read_b128 v[44:47], v19 offset:2048
ds_read_b128 v[48:51], v19 offset:3072
v_mul_f32 v64, v156, v64
v_mul_f32 v65, v156, v65
v_mul_f32 v66, v156, v66
v_mul_f32 v67, v156, v67
v_mul_f32 v68, v157, v68
v_mul_f32 v69, v157, v69
v_mul_f32 v70, v157, v70
v_mul_f32 v71, v157, v71
v_mul_f32 v72, v156, v72
v_mul_f32 v73, v156, v73
v_mul_f32 v74, v156, v74
v_mul_f32 v75, v156, v75
v_mul_f32 v76, v157, v76
v_mul_f32 v77, v157, v77
v_mul_f32 v78, v157, v78
v_mul_f32 v79, v157, v79
v_mul_f32 v80, v156, v80
v_mul_f32 v81, v156, v81
v_mul_f32 v82, v156, v82
v_mul_f32 v83, v156, v83
v_mul_f32 v84, v157, v84
v_mul_f32 v85, v157, v85
v_mul_f32 v86, v157, v86
v_mul_f32 v87, v157, v87
v_mul_f32 v88, v156, v88
v_mul_f32 v89, v156, v89
v_mul_f32 v90, v156, v90
v_mul_f32 v91, v156, v91
v_mul_f32 v92, v157, v92
v_mul_f32 v93, v157, v93
v_mul_f32 v94, v157, v94
v_mul_f32 v95, v157, v95
v_mul_f32 v96, v156, v96
v_mul_f32 v97, v156, v97
v_mul_f32 v98, v156, v98
v_mul_f32 v99, v156, v99
v_mul_f32 v100, v157, v100
v_mul_f32 v101, v157, v101
v_mul_f32 v102, v157, v102
v_mul_f32 v103, v157, v103
v_mul_f32 v104, v156, v104
v_mul_f32 v105, v156, v105
v_mul_f32 v106, v156, v106
v_mul_f32 v107, v156, v107
v_mul_f32 v108, v157, v108
v_mul_f32 v109, v157, v109
v_mul_f32 v110, v157, v110
v_mul_f32 v111, v157, v111
v_mul_f32 v112, v156, v112
v_mul_f32 v113, v156, v113
v_mul_f32 v114, v156, v114
v_mul_f32 v115, v156, v115
v_mul_f32 v116, v157, v116
v_mul_f32 v117, v157, v117
v_mul_f32 v118, v157, v118
v_mul_f32 v119, v157, v119
v_mul_f32 v120, v156, v120
v_mul_f32 v121, v156, v121
v_mul_f32 v122, v156, v122
v_mul_f32 v123, v156, v123
v_mul_f32 v124, v157, v124
v_mul_f32 v125, v157, v125
v_mul_f32 v126, v157, v126
v_mul_f32 v127, v157, v127
v_mov_b32 v17, 0xff7fffff
v_cndmask_b32 v52, v17, v52, s[76:77]
v_cndmask_b32 v53, v17, v53, s[78:79]
v_cndmask_b32 v54, v17, v54, s[80:81]
v_cndmask_b32 v55, v17, v55, s[82:83]
v_cndmask_b32 v56, v17, v56, s[84:85]
v_cndmask_b32 v57, v17, v57, s[86:87]
v_cndmask_b32 v58, v17, v58, s[88:89]
v_cndmask_b32 v59, v17, v59, s[90:91]
v_max3_f32 v160, v52, v53, v54
v_max3_f32 v161, v55, v56, v57
v_max3_f32 v160, v160, v58, v59
v_max_f32 v160, v160, v161
s_cmp_lg_u32 s21, 0
s_cbranch_scc1 L_af_w1
s_lshl_b32 s28, s20, 7
s_add_u32 s11, s28, 598016
s_sub_u32 s95, s35, 2
s_cmp_ge_u32 s35, 54
s_cselect_b32 s95, s95, s35
s_cmp_eq_u32 s35, 63
s_cselect_b32 s95, 60, s95
s_mov_b32 s24, 0
s_branch L_af_ch_e
L_af_ch:
s_sleep 2
L_af_ch_e:
v_mov_b32 v17, s11
global_load_dword v17, v17, s[48:49] sc1
s_add_u32 s24, s24, 1
s_cmp_gt_u32 s24, 1048576
s_cbranch_scc1 L_af_fail
s_waitcnt vmcnt(0)
v_readfirstlane_b32 s27, v17
s_cmp_gt_u32 s27, s95
s_cbranch_scc0 L_af_ch
L_af_w1:
s_waitcnt lgkmcnt(0)
s_barrier
global_load_dwordx4 v[164:167], v1, s[44:45] sc1
s_mov_b32 s28, 2139193217
v_mov_b32 v180, 0x3f803f80
v_mov_b32 v181, 0x3f803f80
v_mov_b32 v182, 0x3f803f80
v_mov_b32 v183, 0x3f803f80
v_mov_b32 v169, 0
v_mov_b32 v171, 0
v_mov_b32 v173, 0
v_mov_b32 v175, 0
v_lshlrev_b32 v18, 3, v0
v_add_u32 v18, 147456, v18
s_lshl_b32 s27, s21, 9
s_add_u32 s27, s27, 157696
v_lshl_add_u32 v19, v0, 3, s27
s_and_b32 s27, s27, 0xfffffdff
v_lshl_add_u32 v17, v0, 3, s27
s_waitcnt vmcnt(0)
v_cmp_eq_u32 vcc, s28, v164
v_cmp_eq_u32 s[4:5], s28, v165
s_or_b64 vcc, vcc, s[4:5]
v_cmp_eq_u32 s[4:5], s28, v166
s_or_b64 vcc, vcc, s[4:5]
v_cmp_eq_u32 s[4:5], s28, v167
s_or_b64 vcc, vcc, s[4:5]
s_cbranch_vccz L_af_kvok
s_mov_b32 s24, 0
global_load_dwordx4 v[184:187], v1, s[44:45] sc1
s_sleep 6
L_af_kvre:
global_load_dwordx4 v[188:191], v1, s[44:45] sc1
s_add_u32 s24, s24, 1
s_cmp_gt_u32 s24, 1048576
s_cbranch_scc1 L_af_fail
s_waitcnt vmcnt(1)
v_cmp_eq_u32 vcc, s28, v184
v_cmp_eq_u32 s[4:5], s28, v185
s_or_b64 vcc, vcc, s[4:5]
v_cmp_eq_u32 s[4:5], s28, v186
s_or_b64 vcc, vcc, s[4:5]
v_cmp_eq_u32 s[4:5], s28, v187
s_or_b64 vcc, vcc, s[4:5]
s_cbranch_vccz L_af_kva
global_load_dwordx4 v[184:187], v1, s[44:45] sc1
s_waitcnt vmcnt(1)
v_cmp_eq_u32 vcc, s28, v188
v_cmp_eq_u32 s[4:5], s28, v189
s_or_b64 vcc, vcc, s[4:5]
v_cmp_eq_u32 s[4:5], s28, v190
s_or_b64 vcc, vcc, s[4:5]
v_cmp_eq_u32 s[4:5], s28, v191
s_or_b64 vcc, vcc, s[4:5]
s_cbranch_vccnz L_af_kvre
v_mov_b64 v[164:165], v[188:189]
v_mov_b64 v[166:167], v[190:191]
s_branch L_af_kvok
L_af_kva:
v_mov_b64 v[164:165], v[184:185]
v_mov_b64 v[166:167], v[186:187]
L_af_kvok:
ds_write2_b32 v14, v164, v165 offset0:0 offset1:128
ds_write_b64 v19, v[166:167]
s_waitcnt lgkmcnt(0)
s_barrier
ds_read_b64_tr_b16 v[128:129], v18 offset:0
ds_read_b64_tr_b16 v[130:131], v18 offset:512
ds_read_b64_tr_b16 v[132:133], v18 offset:1024
ds_read_b64_tr_b16 v[134:135], v18 offset:1536
ds_read_b64_tr_b16 v[136:137], v18 offset:2048
ds_read_b64_tr_b16 v[138:139], v18 offset:2560
ds_read_b64_tr_b16 v[140:141], v18 offset:3072
ds_read_b64_tr_b16 v[142:143], v18 offset:3584
ds_read_b64 v[176:177], v17
ds_read_b64 v[178:179], v17 offset:512
s_waitcnt lgkmcnt(8)
v_mfma_f32_16x16x32_bf16 v[60:63], v[128:131], v[20:23], 0
s_waitcnt lgkmcnt(6)
v_mfma_f32_16x16x32_bf16 v[60:63], v[132:135], v[24:27], v[60:63]
s_waitcnt lgkmcnt(4)
v_mfma_f32_16x16x32_bf16 v[60:63], v[136:139], v[28:31], v[60:63]
s_waitcnt lgkmcnt(2)
v_mfma_f32_16x16x32_bf16 v[60:63], v[140:143], v[32:35], v[60:63]
s_waitcnt lgkmcnt(0)
v_mov_b32 v168, v176
v_mov_b32 v170, v177
v_mov_b32 v172, v178
v_mov_b32 v174, v179
s_nop 2
v_mul_f32 v60, s94, v60
v_mul_f32 v61, s94, v61
v_max3_f32 v17, v160, v60, v61
v_mov_b32 v18, v17
s_nop 1
v_permlane32_swap_b32 v17, v18
v_max_f32 v17, v17, v18
v_mov_b32 v18, v17
s_nop 1
v_permlane16_swap_b32 v17, v18
v_max_f32 v17, v17, v18
v_sub_f32 v52, v52, v17
v_sub_f32 v53, v53, v17
v_sub_f32 v54, v54, v17
v_sub_f32 v55, v55, v17
v_sub_f32 v56, v56, v17
v_sub_f32 v57, v57, v17
v_sub_f32 v58, v58, v17
v_sub_f32 v59, v59, v17
v_sub_f32 v60, v60, v17
v_sub_f32 v61, v61, v17
v_exp_f32 v52, v52
v_exp_f32 v53, v53
v_exp_f32 v54, v54
v_exp_f32 v55, v55
v_exp_f32 v56, v56
v_exp_f32 v57, v57
v_exp_f32 v58, v58
v_exp_f32 v59, v59
v_exp_f32 v60, v60
v_exp_f32 v61, v61
v_cvt_pk_bf16_f32 v20, v52, v53
v_cvt_pk_bf16_f32 v21, v54, v55
v_cvt_pk_bf16_f32 v22, v56, v57
v_cvt_pk_bf16_f32 v23, v58, v59
v_cvt_pk_bf16_f32 v24, v60, v61
v_mov_b32 v25, 0
v_mfma_f32_16x16x32_bf16 v[28:31], v[180:183], v[20:23], 0
v_mfma_f32_16x16x32_bf16 v[52:55], v[36:39], v[20:23], 0
v_mfma_f32_16x16x32_bf16 v[56:59], v[40:43], v[20:23], 0
v_mfma_f32_16x16x32_bf16 v[60:63], v[44:47], v[20:23], 0
v_mfma_f32_16x16x32_bf16 v[32:35], v[48:51], v[20:23], 0
v_mfma_f32_16x16x16_bf16 v[28:31], v[180:181], v[24:25], v[28:31]
v_mfma_f32_16x16x16_bf16 v[52:55], v[168:169], v[24:25], v[52:55]
v_mfma_f32_16x16x16_bf16 v[56:59], v[170:171], v[24:25], v[56:59]
v_mfma_f32_16x16x16_bf16 v[60:63], v[172:173], v[24:25], v[60:63]
v_mfma_f32_16x16x16_bf16 v[32:35], v[174:175], v[24:25], v[32:35]
v_rcp_f32 v17, v28
s_nop 0
v_mul_f32 v17, v158, v17
v_mul_f32 v52, v17, v52
v_mul_f32 v53, v17, v53
v_mul_f32 v54, v17, v54
v_mul_f32 v55, v17, v55
v_mul_f32 v56, v17, v56
v_mul_f32 v57, v17, v57
v_mul_f32 v58, v17, v58
v_mul_f32 v59, v17, v59
v_mul_f32 v60, v17, v60
v_mul_f32 v61, v17, v61
v_mul_f32 v62, v17, v62
v_mul_f32 v63, v17, v63
v_mul_f32 v32, v17, v32
v_mul_f32 v33, v17, v33
v_mul_f32 v34, v17, v34
v_mul_f32 v35, v17, v35
v_cvt_pk_bf16_f32 v36, v52, v53
v_cvt_pk_bf16_f32 v37, v54, v55
v_cvt_pk_bf16_f32 v38, v56, v57
v_cvt_pk_bf16_f32 v39, v58, v59
v_cvt_pk_bf16_f32 v40, v60, v61
v_cvt_pk_bf16_f32 v41, v62, v63
v_cvt_pk_bf16_f32 v42, v32, v33
v_cvt_pk_bf16_f32 v43, v34, v35
v_add_u32 v18, s18, v1
ds_write_b128 v18, v[36:39]
ds_write_b128 v18, v[40:43] offset:1024
v_add_u32 v19, 90112, v1
s_waitcnt vmcnt(0) lgkmcnt(0)
s_barrier
ds_read_b128 v[160:163], v19 offset:0
ds_read_b128 v[164:167], v19 offset:4096
ds_read_b128 v[168:171], v19 offset:1024
ds_read_b128 v[172:175], v19 offset:5120
ds_read_b128 v[176:179], v19 offset:2048
ds_read_b128 v[180:183], v19 offset:6144
ds_read_b128 v[184:187], v19 offset:3072
ds_read_b128 v[188:191], v19 offset:7168
s_add_u32 s29, s51, s50
s_add_u32 s95, s29, 4096
s_waitcnt lgkmcnt(6)
v_mfma_f32_16x16x32_bf16 v[64:67], a[128:131], v[160:163], v[64:67]
v_mfma_f32_16x16x32_bf16 v[68:71], a[128:131], v[164:167], v[68:71]
v_mfma_f32_16x16x32_bf16 v[72:75], a[144:147], v[160:163], v[72:75]
v_mfma_f32_16x16x32_bf16 v[76:79], a[144:147], v[164:167], v[76:79]
s_waitcnt lgkmcnt(4)
v_mfma_f32_16x16x32_bf16 v[64:67], a[132:135], v[168:171], v[64:67]
v_mfma_f32_16x16x32_bf16 v[68:71], a[132:135], v[172:175], v[68:71]
v_mfma_f32_16x16x32_bf16 v[72:75], a[148:151], v[168:171], v[72:75]
v_mfma_f32_16x16x32_bf16 v[76:79], a[148:151], v[172:175], v[76:79]
s_waitcnt lgkmcnt(2)
v_mfma_f32_16x16x32_bf16 v[64:67], a[136:139], v[176:179], v[64:67]
v_mfma_f32_16x16x32_bf16 v[68:71], a[136:139], v[180:183], v[68:71]
v_mfma_f32_16x16x32_bf16 v[72:75], a[152:155], v[176:179], v[72:75]
v_mfma_f32_16x16x32_bf16 v[76:79], a[152:155], v[180:183], v[76:79]
s_waitcnt lgkmcnt(0)
v_mfma_f32_16x16x32_bf16 v[64:67], a[140:143], v[184:187], v[64:67]
v_mfma_f32_16x16x32_bf16 v[72:75], a[156:159], v[184:187], v[72:75]
v_mfma_f32_16x16x32_bf16 v[68:71], a[140:143], v[188:191], v[68:71]
v_mfma_f32_16x16x32_bf16 v[76:79], a[156:159], v[188:191], v[76:79]
v_mfma_f32_16x16x32_bf16 v[80:83], a[160:163], v[160:163], v[80:83]
v_mfma_f32_16x16x32_bf16 v[84:87], a[160:163], v[164:167], v[84:87]
v_mfma_f32_16x16x32_bf16 v[88:91], a[176:179], v[160:163], v[88:91]
v_cvt_pk_bf16_f32 v20, v64, v65
v_mfma_f32_16x16x32_bf16 v[92:95], a[176:179], v[164:167], v[92:95]
v_cvt_pk_bf16_f32 v21, v66, v67
v_mfma_f32_16x16x32_bf16 v[80:83], a[164:167], v[168:171], v[80:83]
v_cvt_pk_bf16_f32 v22, v72, v73
v_mfma_f32_16x16x32_bf16 v[84:87], a[164:167], v[172:175], v[84:87]
v_cvt_pk_bf16_f32 v23, v74, v75
v_mfma_f32_16x16x32_bf16 v[88:91], a[180:183], v[168:171], v[88:91]
v_min_u32 v20, -2, v20
v_mfma_f32_16x16x32_bf16 v[92:95], a[180:183], v[172:175], v[92:95]
buffer_store_dwordx4 v[20:23], v1, s[60:63], s29 offen offset:0
v_mfma_f32_16x16x32_bf16 v[80:83], a[168:171], v[176:179], v[80:83]
v_cvt_pk_bf16_f32 v24, v68, v69
v_mfma_f32_16x16x32_bf16 v[84:87], a[168:171], v[180:183], v[84:87]
v_cvt_pk_bf16_f32 v25, v70, v71
v_mfma_f32_16x16x32_bf16 v[88:91], a[184:187], v[176:179], v[88:91]
v_cvt_pk_bf16_f32 v26, v76, v77
v_mfma_f32_16x16x32_bf16 v[92:95], a[184:187], v[180:183], v[92:95]
v_cvt_pk_bf16_f32 v27, v78, v79
v_mfma_f32_16x16x32_bf16 v[80:83], a[172:175], v[184:187], v[80:83]
v_min_u32 v24, -2, v24
v_mfma_f32_16x16x32_bf16 v[88:91], a[188:191], v[184:187], v[88:91]
buffer_store_dwordx4 v[24:27], v1, s[60:63], s29 offen offset:1024
v_mfma_f32_16x16x32_bf16 v[84:87], a[172:175], v[188:191], v[84:87]
v_mfma_f32_16x16x32_bf16 v[92:95], a[188:191], v[188:191], v[92:95]
v_mfma_f32_16x16x32_bf16 v[96:99], a[192:195], v[160:163], v[96:99]
v_mfma_f32_16x16x32_bf16 v[100:103], a[192:195], v[164:167], v[100:103]
v_mfma_f32_16x16x32_bf16 v[104:107], a[208:211], v[160:163], v[104:107]
v_cvt_pk_bf16_f32 v28, v80, v81
v_mfma_f32_16x16x32_bf16 v[108:111], a[208:211], v[164:167], v[108:111]
v_cvt_pk_bf16_f32 v29, v82, v83
v_mfma_f32_16x16x32_bf16 v[96:99], a[196:199], v[168:171], v[96:99]
v_cvt_pk_bf16_f32 v30, v88, v89
v_mfma_f32_16x16x32_bf16 v[100:103], a[196:199], v[172:175], v[100:103]
v_cvt_pk_bf16_f32 v31, v90, v91
v_mfma_f32_16x16x32_bf16 v[104:107], a[212:215], v[168:171], v[104:107]
v_min_u32 v28, -2, v28
v_mfma_f32_16x16x32_bf16 v[108:111], a[212:215], v[172:175], v[108:111]
buffer_store_dwordx4 v[28:31], v1, s[60:63], s29 offen offset:2048
v_mfma_f32_16x16x32_bf16 v[96:99], a[200:203], v[176:179], v[96:99]
v_cvt_pk_bf16_f32 v32, v84, v85
v_mfma_f32_16x16x32_bf16 v[100:103], a[200:203], v[180:183], v[100:103]
v_cvt_pk_bf16_f32 v33, v86, v87
v_mfma_f32_16x16x32_bf16 v[104:107], a[216:219], v[176:179], v[104:107]
v_cvt_pk_bf16_f32 v34, v92, v93
v_mfma_f32_16x16x32_bf16 v[108:111], a[216:219], v[180:183], v[108:111]
v_cvt_pk_bf16_f32 v35, v94, v95
v_mfma_f32_16x16x32_bf16 v[96:99], a[204:207], v[184:187], v[96:99]
v_min_u32 v32, -2, v32
v_mfma_f32_16x16x32_bf16 v[104:107], a[220:223], v[184:187], v[104:107]
buffer_store_dwordx4 v[32:35], v1, s[60:63], s29 offen offset:3072
v_mfma_f32_16x16x32_bf16 v[100:103], a[204:207], v[188:191], v[100:103]
v_mfma_f32_16x16x32_bf16 v[108:111], a[220:223], v[188:191], v[108:111]
v_mfma_f32_16x16x32_bf16 v[112:115], a[224:227], v[160:163], v[112:115]
v_mfma_f32_16x16x32_bf16 v[116:119], a[224:227], v[164:167], v[116:119]
v_mfma_f32_16x16x32_bf16 v[120:123], a[240:243], v[160:163], v[120:123]
v_cvt_pk_bf16_f32 v20, v96, v97
v_mfma_f32_16x16x32_bf16 v[124:127], a[240:243], v[164:167], v[124:127]
v_cvt_pk_bf16_f32 v21, v98, v99
v_mfma_f32_16x16x32_bf16 v[112:115], a[228:231], v[168:171], v[112:115]
v_cvt_pk_bf16_f32 v22, v104, v105
v_mfma_f32_16x16x32_bf16 v[116:119], a[228:231], v[172:175], v[116:119]
v_cvt_pk_bf16_f32 v23, v106, v107
v_mfma_f32_16x16x32_bf16 v[120:123], a[244:247], v[168:171], v[120:123]
v_min_u32 v20, -2, v20
v_mfma_f32_16x16x32_bf16 v[124:127], a[244:247], v[172:175], v[124:127]
buffer_store_dwordx4 v[20:23], v1, s[60:63], s95 offen offset:0
v_mfma_f32_16x16x32_bf16 v[112:115], a[232:235], v[176:179], v[112:115]
v_cvt_pk_bf16_f32 v24, v100, v101
v_mfma_f32_16x16x32_bf16 v[116:119], a[232:235], v[180:183], v[116:119]
v_cvt_pk_bf16_f32 v25, v102, v103
v_mfma_f32_16x16x32_bf16 v[120:123], a[248:251], v[176:179], v[120:123]
v_cvt_pk_bf16_f32 v26, v108, v109
v_mfma_f32_16x16x32_bf16 v[124:127], a[248:251], v[180:183], v[124:127]
v_cvt_pk_bf16_f32 v27, v110, v111
v_mfma_f32_16x16x32_bf16 v[112:115], a[236:239], v[184:187], v[112:115]
v_min_u32 v24, -2, v24
v_mfma_f32_16x16x32_bf16 v[120:123], a[252:255], v[184:187], v[120:123]
buffer_store_dwordx4 v[24:27], v1, s[60:63], s95 offen offset:1024
v_mfma_f32_16x16x32_bf16 v[116:119], a[236:239], v[188:191], v[116:119]
v_mfma_f32_16x16x32_bf16 v[124:127], a[252:255], v[188:191], v[124:127]
v_cvt_pk_bf16_f32 v28, v112, v113
v_cvt_pk_bf16_f32 v29, v114, v115
v_cvt_pk_bf16_f32 v30, v120, v121
v_cvt_pk_bf16_f32 v31, v122, v123
v_min_u32 v28, -2, v28
buffer_store_dwordx4 v[28:31], v1, s[60:63], s95 offen offset:2048
v_cvt_pk_bf16_f32 v32, v116, v117
v_cvt_pk_bf16_f32 v33, v118, v119
v_cvt_pk_bf16_f32 v34, v124, v125
v_cvt_pk_bf16_f32 v35, v126, v127
v_min_u32 v32, -2, v32
buffer_store_dwordx4 v[32:35], v1, s[60:63], s95 offen offset:3072
v_and_b32 v48, 1, v0
v_lshlrev_b32 v48, 4, v48
v_mov_b32 v49, 0x3f80
v_lshlrev_b32 v48, v48, v49
v_bfe_u32 v49, v0, 1, 3
v_cmp_eq_u32 vcc, 0, v49
s_nop 1
v_cndmask_b32 v40, 0, v48, vcc
v_cmp_eq_u32 vcc, 1, v49
s_nop 1
v_cndmask_b32 v41, 0, v48, vcc
v_cmp_eq_u32 vcc, 2, v49
s_nop 1
v_cndmask_b32 v42, 0, v48, vcc
v_cmp_eq_u32 vcc, 3, v49
s_nop 1
v_cndmask_b32 v43, 0, v48, vcc
s_cmp_ge_u32 s35, 59
s_cbranch_scc1 L_af_last
s_waitcnt vmcnt(0)
s_barrier
v_mov_b32 v48, s92
v_mov_b32 v49, s36
v_lshl_add_u32 v50, v0, 2, s92
s_lshl_b32 s27, s20, 2
v_add_u32 v48, s27, v48
s_mov_b64 exec, s[12:13]
global_store_dword v48, v49, s[48:49]
s_mov_b32 s24, 0
s_mov_b32 exec_lo, -1
s_mov_b32 exec_hi, 0
s_branch L_af_ar_e
L_af_ar:
s_sleep 1
L_af_ar_e:
global_load_dword v49, v50, s[48:49] sc1
s_add_u32 s24, s24, 1
s_cmp_gt_u32 s24, 1048576
s_cbranch_scc1 L_af_fail
s_waitcnt vmcnt(0)
v_cmp_gt_u32 vcc, s36, v49
s_cbranch_vccnz L_af_ar
s_mov_b64 exec, -1
s_add_u32 s29, s51, 0
buffer_load_dwordx4 v[160:163], v15, s[60:63], s29 offen sc1
s_add_u32 s29, s51, 32768
buffer_load_dwordx4 v[164:167], v15, s[60:63], s29 offen sc1
s_add_u32 s29, s51, 65536
buffer_load_dwordx4 v[168:171], v15, s[60:63], s29 offen sc1
s_add_u32 s29, s51, 98304
buffer_load_dwordx4 v[172:175], v15, s[60:63], s29 offen sc1
s_add_u32 s29, s51, 131072
buffer_load_dwordx4 v[176:179], v15, s[60:63], s29 offen sc1
s_add_u32 s29, s51, 163840
buffer_load_dwordx4 v[180:183], v15, s[60:63], s29 offen sc1
s_add_u32 s29, s51, 196608
buffer_load_dwordx4 v[184:187], v15, s[60:63], s29 offen sc1
s_add_u32 s29, s51, 229376
buffer_load_dwordx4 v[188:191], v15, s[60:63], s29 offen sc1
s_waitcnt vmcnt(7)
v_mfma_f32_16x16x32_bf16 v[44:47], v[40:43], v[160:163], 0
s_waitcnt vmcnt(6)
v_mfma_f32_16x16x32_bf16 v[44:47], v[40:43], v[164:167], v[44:47]
s_waitcnt vmcnt(5)
v_mfma_f32_16x16x32_bf16 v[44:47], v[40:43], v[168:171], v[44:47]
s_waitcnt vmcnt(4)
v_mfma_f32_16x16x32_bf16 v[44:47], v[40:43], v[172:175], v[44:47]
s_waitcnt vmcnt(3)
v_mfma_f32_16x16x32_bf16 v[44:47], v[40:43], v[176:179], v[44:47]
s_waitcnt vmcnt(2)
v_mfma_f32_16x16x32_bf16 v[44:47], v[40:43], v[180:183], v[44:47]
s_waitcnt vmcnt(1)
v_mfma_f32_16x16x32_bf16 v[44:47], v[40:43], v[184:187], v[44:47]
s_waitcnt vmcnt(0)
v_mfma_f32_16x16x32_bf16 v[44:47], v[40:43], v[188:191], v[44:47]
s_branch L_af_sum
L_af_last:
s_nop 7
s_nop 7
s_nop 7
s_nop 7
s_nop 7
s_nop 7
s_nop 7
s_nop 7
s_mov_b32 s24, 0
L_af_lre:
s_add_u32 s29, s51, 0
buffer_load_dwordx4 v[160:163], v15, s[60:63], s29 offen sc1
s_add_u32 s29, s51, 32768
buffer_load_dwordx4 v[164:167], v15, s[60:63], s29 offen sc1
s_add_u32 s29, s51, 65536
buffer_load_dwordx4 v[168:171], v15, s[60:63], s29 offen sc1
s_add_u32 s29, s51, 98304
buffer_load_dwordx4 v[172:175], v15, s[60:63], s29 offen sc1
s_add_u32 s29, s51, 131072
buffer_load_dwordx4 v[176:179], v15, s[60:63], s29 offen sc1
s_add_u32 s29, s51, 163840
buffer_load_dwordx4 v[180:183], v15, s[60:63], s29 offen sc1
s_add_u32 s29, s51, 196608
buffer_load_dwordx4 v[184:187], v15, s[60:63], s29 offen sc1
s_add_u32 s29, s51, 229376
buffer_load_dwordx4 v[188:191], v15, s[60:63], s29 offen sc1
s_waitcnt vmcnt(7)
v_mfma_f32_16x16x32_bf16 v[44:47], v[40:43], v[160:163], 0
s_waitcnt vmcnt(6)
v_mfma_f32_16x16x32_bf16 v[44:47], v[40:43], v[164:167], v[44:47]
s_waitcnt vmcnt(5)
v_mfma_f32_16x16x32_bf16 v[44:47], v[40:43], v[168:171], v[44:47]
s_waitcnt vmcnt(4)
v_mfma_f32_16x16x32_bf16 v[44:47], v[40:43], v[172:175], v[44:47]
s_waitcnt vmcnt(3)
v_mfma_f32_16x16x32_bf16 v[44:47], v[40:43], v[176:179], v[44:47]
s_waitcnt vmcnt(2)
v_mfma_f32_16x16x32_bf16 v[44:47], v[40:43], v[180:183], v[44:47]
s_waitcnt vmcnt(1)
v_mfma_f32_16x16x32_bf16 v[44:47], v[40:43], v[184:187], v[44:47]
s_waitcnt vmcnt(0)
v_mfma_f32_16x16x32_bf16 v[44:47], v[40:43], v[188:191], v[44:47]
v_max3_u32 v48, v160, v164, v168
v_max3_u32 v49, v172, v176, v180
v_max3_u32 v48, v184, v188, v48
v_max_u32 v48, v48, v49
s_add_u32 s24, s24, 1
s_cmp_gt_u32 s24, 1048576
s_cbranch_scc1 L_af_fail
v_cmp_eq_u32 vcc, -1, v48
s_cbranch_vccnz L_af_lre
L_af_sum:
s_nop 6
v_cvt_pk_bf16_f32 v48, v44, v45
v_cvt_pk_bf16_f32 v49, v46, v47
s_mov_b32 exec_hi, 0
buffer_store_dwordx2 v[48:49], v16, s[64:67], s93 offen
s_mov_b32 exec_hi, -1
s_add_u32 s35, s35, 5
s_add_u32 s93, s93, 163840
s_add_u32 s40, s40, 1310720
s_addc_u32 s41, s41, 0
s_add_u32 s42, s42, 1310720
s_addc_u32 s43, s43, 0
s_add_u32 s44, s44, 655360
s_addc_u32 s45, s45, 0
s_add_u32 s46, s46, 655360
s_addc_u32 s47, s47, 0
s_xor_b32 s51, s51, 0x100000
s_cmp_ge_u32 s35, 59
s_cselect_b32 s51, 0x200000, s51
s_add_u32 s36, s36, 1
s_add_u32 s22, s22, 1
s_cmp_lt_u32 s35, 64
s_cbranch_scc1 L_af_seg
s_branch L_af_fin
L_af_fail:
s_mov_b64 exec, -1
s_mov_b32 s26, 1
L_af_fin:
s_waitcnt vmcnt(0)
s_endpgm
L_overflow:
s_cmp_lg_u32 s21, 0
s_cbranch_scc1 L_fallback
v_mov_b32 v2, 192
v_mov_b32 v3, 65536
s_mov_b64 exec, 1
global_atomic_or v2, v3, s[8:9] sc1
L_fallback:
s_mov_b64 exec, -1
s_waitcnt vmcnt(0) lgkmcnt(0)
s_barrier
v_mov_b32 v2, 200
v_mov_b32 v3, 1
s_cmp_lg_u32 s21, 0
s_cbranch_scc1 L_fb_nt
s_mov_b64 exec, 1
global_atomic_add v4, v2, v3, s[8:9] sc0 sc1
s_waitcnt vmcnt(0)
v_mov_b32 v2, 0
ds_write_b32 v2, v4
s_waitcnt lgkmcnt(0)
s_mov_b64 exec, -1
L_fb_nt:
s_barrier
v_mov_b32 v2, 0
ds_read_b32 v4, v2
s_waitcnt lgkmcnt(0)
v_readfirstlane_b32 s81, v4
s_cmp_lg_u32 s81, 0
s_cbranch_scc1 L_exit
s_load_dwordx4 s[84:87], s[0:1], 0
s_load_dwordx8 s[88:95], s[0:1], 16
s_load_dwordx4 s[96:99], s[0:1], 64
v_mbcnt_lo_u32_b32 v0, -1, 0
v_mbcnt_hi_u32_b32 v0, -1, v0
v_and_b32 v1, 15, v0
v_lshrrev_b32 v2, 4, v0
s_lshl_b32 s81, s21, 6
v_add_u32 v4, s81, v0
v_lshlrev_b32 v4, 4, v4
s_add_u32 s81, s48, 167772160
s_addc_u32 s82, s49, 0
s_waitcnt lgkmcnt(0)
s_mov_b32 s24, s81
s_and_b32 s25, s82, 0xffff
s_mov_b32 s26, 2359296
s_mov_b32 s27, 0x00020000
s_mov_b32 s28, s84
s_and_b32 s29, s85, 0xffff
s_mov_b32 s30, 2097152
s_mov_b32 s31, 0x00020000
s_mov_b32 s72, s86
s_and_b32 s73, s87, 0xffff
s_mov_b32 s74, 8192
s_mov_b32 s75, 0x00020000
s_mov_b32 s32, s88
s_and_b32 s33, s89, 0xffff
s_mov_b32 s34, 4194304
s_mov_b32 s35, 0x00020000
s_mov_b32 s36, s90
s_and_b32 s37, s91, 0xffff
s_mov_b32 s38, 4194304
s_mov_b32 s39, 0x00020000
s_mov_b32 s40, s92
s_and_b32 s41, s93, 0xffff
s_mov_b32 s42, 4194304
s_mov_b32 s43, 0x00020000
s_mov_b32 s44, s94
s_and_b32 s45, s95, 0xffff
s_mov_b32 s46, 4194304
s_mov_b32 s47, 0x00020000
s_mov_b32 s52, s96
s_and_b32 s53, s97, 0xffff
s_mov_b32 s54, 1409024
s_mov_b32 s55, 0x00020000
s_mov_b32 s56, s98
s_and_b32 s57, s99, 0xffff
s_mov_b32 s58, 1409024
s_mov_b32 s59, 0x00020000
s_load_dwordx2 s[84:85], s[0:1], 80
s_load_dwordx4 s[88:91], s[0:1], 88
s_waitcnt lgkmcnt(0)
s_mov_b32 s60, s84
s_and_b32 s61, s85, 0xffff
s_mov_b32 s62, 1409024
s_mov_b32 s63, 0x00020000
s_mov_b32 s64, s88
s_and_b32 s65, s89, 0xffff
s_mov_b32 s66, 1024
s_mov_b32 s67, 0x00020000
s_mov_b32 s68, s90
s_and_b32 s69, s91, 0xffff
s_mov_b32 s70, 2097152
s_mov_b32 s71, 0x00020000
buffer_load_dwordx4 v[32:35], v4, s[72:75], 0 offen offset:0
v_add_u32 v3, 4096, v4
buffer_load_dwordx4 v[36:39], v3, s[72:75], 0 offen
v_mov_b32 v40, 0
v_mov_b32 v41, 0
v_mov_b32 v42, 0
v_mov_b32 v43, 0
s_waitcnt vmcnt(0)
buffer_store_dwordx4 v[32:35], v4, s[24:27], 0 offen
buffer_store_dwordx4 v[36:39], v3, s[24:27], 0 offen
s_mov_b32 s81, 40960
buffer_store_dwordx4 v[40:43], v4, s[24:27], s81 offen
buffer_store_dwordx4 v[40:43], v3, s[24:27], s81 offen
s_mov_b32 s76, 0
L_fb_seg:
s_lshl_b32 s81, s76, 15
buffer_load_dwordx4 v[32:35], v4, s[28:31], s81 offen
s_add_u32 s81, s81, 4096
buffer_load_dwordx4 v[36:39], v4, s[28:31], s81 offen
s_add_u32 s81, s81, 4096
buffer_load_dwordx4 v[40:43], v4, s[28:31], s81 offen
s_add_u32 s81, s81, 4096
buffer_load_dwordx4 v[44:47], v4, s[28:31], s81 offen
s_add_u32 s81, s81, 4096
buffer_load_dwordx4 v[48:51], v4, s[28:31], s81 offen
s_add_u32 s81, s81, 4096
buffer_load_dwordx4 v[52:55], v4, s[28:31], s81 offen
s_add_u32 s81, s81, 4096
buffer_load_dwordx4 v[56:59], v4, s[28:31], s81 offen
s_add_u32 s81, s81, 4096
buffer_load_dwordx4 v[60:63], v4, s[28:31], s81 offen
s_add_u32 s81, s81, 4096
s_waitcnt vmcnt(0)
s_mov_b32 s81, 8192
buffer_store_dwordx4 v[32:35], v4, s[24:27], s81 offen
s_add_u32 s81, s81, 4096
buffer_store_dwordx4 v[36:39], v4, s[24:27], s81 offen
s_add_u32 s81, s81, 4096
buffer_store_dwordx4 v[40:43], v4, s[24:27], s81 offen
s_add_u32 s81, s81, 4096
buffer_store_dwordx4 v[44:47], v4, s[24:27], s81 offen
s_add_u32 s81, s81, 4096
buffer_store_dwordx4 v[48:51], v4, s[24:27], s81 offen
s_add_u32 s81, s81, 4096
buffer_store_dwordx4 v[52:55], v4, s[24:27], s81 offen
s_add_u32 s81, s81, 4096
buffer_store_dwordx4 v[56:59], v4, s[24:27], s81 offen
s_add_u32 s81, s81, 4096
buffer_store_dwordx4 v[60:63], v4, s[24:27], s81 offen
s_add_u32 s81, s81, 4096
s_waitcnt vmcnt(0) lgkmcnt(0)
s_barrier
v_add_u32 v3, 0, v1
s_mov_b32 s81, 8192
v_mul_lo_u32 v3, v3, s81
v_mul_u32_u24 v20, 8, v2
v_add_u32 v20, v20, v3
v_add_u32 v20, 65536, v20
v_add_u32 v3, 16, v1
s_mov_b32 s81, 8192
v_mul_lo_u32 v3, v3, s81
v_mul_u32_u24 v21, 8, v2
v_add_u32 v21, v21, v3
v_add_u32 v21, 65536, v21
v_add_u32 v3, 32, v1
s_mov_b32 s81, 8192
v_mul_lo_u32 v3, v3, s81
v_mul_u32_u24 v22, 8, v2
v_add_u32 v22, v22, v3
v_add_u32 v22, 65536, v22
v_add_u32 v3, 0, v1
s_mov_b32 s81, 1024
v_mul_lo_u32 v3, v3, s81
v_mul_u32_u24 v8, 16, v2
v_add_u32 v8, v8, v3
v_add_u32 v8, 0, v8
v_add_u32 v3, 16, v1
s_mov_b32 s81, 1024
v_mul_lo_u32 v3, v3, s81
v_mul_u32_u24 v9, 16, v2
v_add_u32 v9, v9, v3
v_add_u32 v9, 0, v9
v_add_u32 v3, 32, v1
s_mov_b32 s81, 1024
v_mul_lo_u32 v3, v3, s81
v_mul_u32_u24 v10, 16, v2
v_add_u32 v10, v10, v3
v_add_u32 v10, 0, v10
v_lshlrev_b32 v3, 3, v2
s_mov_b32 s81, 8192
v_mul_lo_u32 v3, v3, s81
v_lshl_add_u32 v12, v1, 1, v3
v_add_u32 v13, 8192, v12
v_add_u32 v14, 16384, v12
v_add_u32 v15, 24576, v12
v_add_u32 v16, 32768, v12
v_add_u32 v17, 40960, v12
v_add_u32 v18, 49152, v12
v_add_u32 v19, 57344, v12
s_mov_b32 s77, s21
L_fb_q_tile:
s_lshl_b32 s79, s77, 6
s_mov_b32 s80, 0
s_mov_b32 s78, 0
v_mov_b32 v96, 0
v_mov_b32 v97, 0
v_mov_b32 v98, 0
v_mov_b32 v99, 0
v_mov_b32 v100, 0
v_mov_b32 v101, 0
v_mov_b32 v102, 0
v_mov_b32 v103, 0
v_mov_b32 v104, 0
v_mov_b32 v105, 0
v_mov_b32 v106, 0
v_mov_b32 v107, 0
v_mov_b32 v108, 0
v_mov_b32 v109, 0
v_mov_b32 v110, 0
v_mov_b32 v111, 0
v_mov_b32 v112, 0
v_mov_b32 v113, 0
v_mov_b32 v114, 0
v_mov_b32 v115, 0
v_mov_b32 v116, 0
v_mov_b32 v117, 0
v_mov_b32 v118, 0
v_mov_b32 v119, 0
L_fb_q_k:
buffer_load_dwordx4 v[80:83], v8, s[24:27], s80 offen sc1
buffer_load_dwordx4 v[84:87], v9, s[24:27], s80 offen sc1
buffer_load_dwordx4 v[88:91], v10, s[24:27], s80 offen sc1
buffer_load_ushort v32, v12, s[32:35], s79 offen offset:0
buffer_load_ushort v33, v13, s[32:35], s79 offen offset:0
buffer_load_ushort v34, v14, s[32:35], s79 offen offset:0
buffer_load_ushort v35, v15, s[32:35], s79 offen offset:0
buffer_load_ushort v36, v16, s[32:35], s79 offen offset:0
buffer_load_ushort v37, v17, s[32:35], s79 offen offset:0
buffer_load_ushort v38, v18, s[32:35], s79 offen offset:0
buffer_load_ushort v39, v19, s[32:35], s79 offen offset:0
buffer_load_ushort v40, v12, s[32:35], s79 offen offset:32
buffer_load_ushort v41, v13, s[32:35], s79 offen offset:32
buffer_load_ushort v42, v14, s[32:35], s79 offen offset:32
buffer_load_ushort v43, v15, s[32:35], s79 offen offset:32
buffer_load_ushort v44, v16, s[32:35], s79 offen offset:32
buffer_load_ushort v45, v17, s[32:35], s79 offen offset:32
buffer_load_ushort v46, v18, s[32:35], s79 offen offset:32
buffer_load_ushort v47, v19, s[32:35], s79 offen offset:32
s_waitcnt vmcnt(0)
v_lshl_or_b32 v64, v33, 16, v32
v_lshl_or_b32 v65, v35, 16, v34
v_lshl_or_b32 v66, v37, 16, v36
v_lshl_or_b32 v67, v39, 16, v38
v_lshl_or_b32 v68, v41, 16, v40
v_lshl_or_b32 v69, v43, 16, v42
v_lshl_or_b32 v70, v45, 16, v44
v_lshl_or_b32 v71, v47, 16, v46
s_nop 1
v_mfma_f32_16x16x32_bf16 v[96:99], v[64:67], v[80:83], v[96:99]
v_mfma_f32_16x16x32_bf16 v[100:103], v[68:71], v[80:83], v[100:103]
v_mfma_f32_16x16x32_bf16 v[104:107], v[64:67], v[84:87], v[104:107]
v_mfma_f32_16x16x32_bf16 v[108:111], v[68:71], v[84:87], v[108:111]
v_mfma_f32_16x16x32_bf16 v[112:115], v[64:67], v[88:91], v[112:115]
v_mfma_f32_16x16x32_bf16 v[116:119], v[68:71], v[88:91], v[116:119]
s_add_u32 s79, s79, 262144
s_add_u32 s80, s80, 64
s_add_u32 s78, s78, 1
s_cmp_lt_u32 s78, 16
s_cbranch_scc1 L_fb_q_k
s_nop 7
s_nop 7
s_lshl_b32 s82, s77, 6
v_cvt_pk_bf16_f32 v32, v96, v97
v_cvt_pk_bf16_f32 v33, v98, v99
buffer_store_dwordx2 v[32:33], v20, s[24:27], s82 offen offset:0
s_nop 1
v_cvt_pk_bf16_f32 v32, v100, v101
v_cvt_pk_bf16_f32 v33, v102, v103
buffer_store_dwordx2 v[32:33], v20, s[24:27], s82 offen offset:32
s_nop 1
v_cvt_pk_bf16_f32 v32, v104, v105
v_cvt_pk_bf16_f32 v33, v106, v107
buffer_store_dwordx2 v[32:33], v21, s[24:27], s82 offen offset:0
s_nop 1
v_cvt_pk_bf16_f32 v32, v108, v109
v_cvt_pk_bf16_f32 v33, v110, v111
buffer_store_dwordx2 v[32:33], v21, s[24:27], s82 offen offset:32
s_nop 1
v_cvt_pk_bf16_f32 v32, v112, v113
v_cvt_pk_bf16_f32 v33, v114, v115
buffer_store_dwordx2 v[32:33], v22, s[24:27], s82 offen offset:0
s_nop 1
v_cvt_pk_bf16_f32 v32, v116, v117
v_cvt_pk_bf16_f32 v33, v118, v119
buffer_store_dwordx2 v[32:33], v22, s[24:27], s82 offen offset:32
s_nop 1
s_add_u32 s77, s77, 4
s_cmp_lt_u32 s77, 128
s_cbranch_scc1 L_fb_q_tile
v_add_u32 v3, 0, v1
s_mov_b32 s81, 8192
v_mul_lo_u32 v3, v3, s81
v_mul_u32_u24 v20, 8, v2
v_add_u32 v20, v20, v3
v_add_u32 v20, 524288, v20
v_add_u32 v3, 16, v1
s_mov_b32 s81, 8192
v_mul_lo_u32 v3, v3, s81
v_mul_u32_u24 v21, 8, v2
v_add_u32 v21, v21, v3
v_add_u32 v21, 524288, v21
v_add_u32 v3, 32, v1
s_mov_b32 s81, 8192
v_mul_lo_u32 v3, v3, s81
v_mul_u32_u24 v22, 8, v2
v_add_u32 v22, v22, v3
v_add_u32 v22, 524288, v22
v_add_u32 v3, 0, v1
s_mov_b32 s81, 1024
v_mul_lo_u32 v3, v3, s81
v_mul_u32_u24 v8, 16, v2
v_add_u32 v8, v8, v3
v_add_u32 v8, 0, v8
v_add_u32 v3, 16, v1
s_mov_b32 s81, 1024
v_mul_lo_u32 v3, v3, s81
v_mul_u32_u24 v9, 16, v2
v_add_u32 v9, v9, v3
v_add_u32 v9, 0, v9
v_add_u32 v3, 32, v1
s_mov_b32 s81, 1024
v_mul_lo_u32 v3, v3, s81
v_mul_u32_u24 v10, 16, v2
v_add_u32 v10, v10, v3
v_add_u32 v10, 0, v10
v_lshlrev_b32 v3, 3, v2
s_mov_b32 s81, 8192
v_mul_lo_u32 v3, v3, s81
v_lshl_add_u32 v12, v1, 1, v3
v_add_u32 v13, 8192, v12
v_add_u32 v14, 16384, v12
v_add_u32 v15, 24576, v12
v_add_u32 v16, 32768, v12
v_add_u32 v17, 40960, v12
v_add_u32 v18, 49152, v12
v_add_u32 v19, 57344, v12
s_mov_b32 s77, s21
L_fb_k_tile:
s_lshl_b32 s79, s77, 6
s_mov_b32 s80, 0
s_mov_b32 s78, 0
v_mov_b32 v96, 0
v_mov_b32 v97, 0
v_mov_b32 v98, 0
v_mov_b32 v99, 0
v_mov_b32 v100, 0
v_mov_b32 v101, 0
v_mov_b32 v102, 0
v_mov_b32 v103, 0
v_mov_b32 v104, 0
v_mov_b32 v105, 0
v_mov_b32 v106, 0
v_mov_b32 v107, 0
v_mov_b32 v108, 0
v_mov_b32 v109, 0
v_mov_b32 v110, 0
v_mov_b32 v111, 0
v_mov_b32 v112, 0
v_mov_b32 v113, 0
v_mov_b32 v114, 0
v_mov_b32 v115, 0
v_mov_b32 v116, 0
v_mov_b32 v117, 0
v_mov_b32 v118, 0
v_mov_b32 v119, 0
L_fb_k_k:
buffer_load_dwordx4 v[80:83], v8, s[24:27], s80 offen sc1
buffer_load_dwordx4 v[84:87], v9, s[24:27], s80 offen sc1
buffer_load_dwordx4 v[88:91], v10, s[24:27], s80 offen sc1
buffer_load_ushort v32, v12, s[36:39], s79 offen offset:0
buffer_load_ushort v33, v13, s[36:39], s79 offen offset:0
buffer_load_ushort v34, v14, s[36:39], s79 offen offset:0
buffer_load_ushort v35, v15, s[36:39], s79 offen offset:0
buffer_load_ushort v36, v16, s[36:39], s79 offen offset:0
buffer_load_ushort v37, v17, s[36:39], s79 offen offset:0
buffer_load_ushort v38, v18, s[36:39], s79 offen offset:0
buffer_load_ushort v39, v19, s[36:39], s79 offen offset:0
buffer_load_ushort v40, v12, s[36:39], s79 offen offset:32
buffer_load_ushort v41, v13, s[36:39], s79 offen offset:32
buffer_load_ushort v42, v14, s[36:39], s79 offen offset:32
buffer_load_ushort v43, v15, s[36:39], s79 offen offset:32
buffer_load_ushort v44, v16, s[36:39], s79 offen offset:32
buffer_load_ushort v45, v17, s[36:39], s79 offen offset:32
buffer_load_ushort v46, v18, s[36:39], s79 offen offset:32
buffer_load_ushort v47, v19, s[36:39], s79 offen offset:32
s_waitcnt vmcnt(0)
v_lshl_or_b32 v64, v33, 16, v32
v_lshl_or_b32 v65, v35, 16, v34
v_lshl_or_b32 v66, v37, 16, v36
v_lshl_or_b32 v67, v39, 16, v38
v_lshl_or_b32 v68, v41, 16, v40
v_lshl_or_b32 v69, v43, 16, v42
v_lshl_or_b32 v70, v45, 16, v44
v_lshl_or_b32 v71, v47, 16, v46
s_nop 1
v_mfma_f32_16x16x32_bf16 v[96:99], v[64:67], v[80:83], v[96:99]
v_mfma_f32_16x16x32_bf16 v[100:103], v[68:71], v[80:83], v[100:103]
v_mfma_f32_16x16x32_bf16 v[104:107], v[64:67], v[84:87], v[104:107]
v_mfma_f32_16x16x32_bf16 v[108:111], v[68:71], v[84:87], v[108:111]
v_mfma_f32_16x16x32_bf16 v[112:115], v[64:67], v[88:91], v[112:115]
v_mfma_f32_16x16x32_bf16 v[116:119], v[68:71], v[88:91], v[116:119]
s_add_u32 s79, s79, 262144
s_add_u32 s80, s80, 64
s_add_u32 s78, s78, 1
s_cmp_lt_u32 s78, 16
s_cbranch_scc1 L_fb_k_k
s_nop 7
s_nop 7
s_lshl_b32 s82, s77, 6
v_cvt_pk_bf16_f32 v32, v96, v97
v_cvt_pk_bf16_f32 v33, v98, v99
buffer_store_dwordx2 v[32:33], v20, s[24:27], s82 offen offset:0
s_nop 1
v_cvt_pk_bf16_f32 v32, v100, v101
v_cvt_pk_bf16_f32 v33, v102, v103
buffer_store_dwordx2 v[32:33], v20, s[24:27], s82 offen offset:32
s_nop 1
v_cvt_pk_bf16_f32 v32, v104, v105
v_cvt_pk_bf16_f32 v33, v106, v107
buffer_store_dwordx2 v[32:33], v21, s[24:27], s82 offen offset:0
s_nop 1
v_cvt_pk_bf16_f32 v32, v108, v109
v_cvt_pk_bf16_f32 v33, v110, v111
buffer_store_dwordx2 v[32:33], v21, s[24:27], s82 offen offset:32
s_nop 1
v_cvt_pk_bf16_f32 v32, v112, v113
v_cvt_pk_bf16_f32 v33, v114, v115
buffer_store_dwordx2 v[32:33], v22, s[24:27], s82 offen offset:0
s_nop 1
v_cvt_pk_bf16_f32 v32, v116, v117
v_cvt_pk_bf16_f32 v33, v118, v119
buffer_store_dwordx2 v[32:33], v22, s[24:27], s82 offen offset:32
s_nop 1
s_add_u32 s77, s77, 4
s_cmp_lt_u32 s77, 128
s_cbranch_scc1 L_fb_k_tile
v_mul_u32_u24 v20, 96, v1
v_lshl_add_u32 v20, v2, 3, v20
v_add_u32 v20, 1048576, v20
v_add_u32 v3, 0, v1
s_mov_b32 s81, 1024
v_mul_lo_u32 v3, v3, s81
v_mul_u32_u24 v8, 16, v2
v_add_u32 v8, v8, v3
v_add_u32 v8, 0, v8
v_add_u32 v3, 16, v1
s_mov_b32 s81, 1024
v_mul_lo_u32 v3, v3, s81
v_mul_u32_u24 v9, 16, v2
v_add_u32 v9, v9, v3
v_add_u32 v9, 0, v9
v_add_u32 v3, 32, v1
s_mov_b32 s81, 1024
v_mul_lo_u32 v3, v3, s81
v_mul_u32_u24 v10, 16, v2
v_add_u32 v10, v10, v3
v_add_u32 v10, 0, v10
v_lshlrev_b32 v3, 3, v2
s_mov_b32 s81, 8192
v_mul_lo_u32 v3, v3, s81
v_lshl_add_u32 v12, v1, 1, v3
v_add_u32 v13, 8192, v12
v_add_u32 v14, 16384, v12
v_add_u32 v15, 24576, v12
v_add_u32 v16, 32768, v12
v_add_u32 v17, 40960, v12
v_add_u32 v18, 49152, v12
v_add_u32 v19, 57344, v12
s_mov_b32 s77, s21
L_fb_v_tile:
s_lshl_b32 s79, s77, 6
s_mov_b32 s80, 0
s_mov_b32 s78, 0
v_mov_b32 v96, 0
v_mov_b32 v97, 0
v_mov_b32 v98, 0
v_mov_b32 v99, 0
v_mov_b32 v100, 0
v_mov_b32 v101, 0
v_mov_b32 v102, 0
v_mov_b32 v103, 0
v_mov_b32 v104, 0
v_mov_b32 v105, 0
v_mov_b32 v106, 0
v_mov_b32 v107, 0
v_mov_b32 v108, 0
v_mov_b32 v109, 0
v_mov_b32 v110, 0
v_mov_b32 v111, 0
v_mov_b32 v112, 0
v_mov_b32 v113, 0
v_mov_b32 v114, 0
v_mov_b32 v115, 0
v_mov_b32 v116, 0
v_mov_b32 v117, 0
v_mov_b32 v118, 0
v_mov_b32 v119, 0
L_fb_v_k:
buffer_load_dwordx4 v[80:83], v8, s[24:27], s80 offen sc1
buffer_load_dwordx4 v[84:87], v9, s[24:27], s80 offen sc1
buffer_load_dwordx4 v[88:91], v10, s[24:27], s80 offen sc1
buffer_load_ushort v32, v12, s[40:43], s79 offen offset:0
buffer_load_ushort v33, v13, s[40:43], s79 offen offset:0
buffer_load_ushort v34, v14, s[40:43], s79 offen offset:0
buffer_load_ushort v35, v15, s[40:43], s79 offen offset:0
buffer_load_ushort v36, v16, s[40:43], s79 offen offset:0
buffer_load_ushort v37, v17, s[40:43], s79 offen offset:0
buffer_load_ushort v38, v18, s[40:43], s79 offen offset:0
buffer_load_ushort v39, v19, s[40:43], s79 offen offset:0
buffer_load_ushort v40, v12, s[40:43], s79 offen offset:32
buffer_load_ushort v41, v13, s[40:43], s79 offen offset:32
buffer_load_ushort v42, v14, s[40:43], s79 offen offset:32
buffer_load_ushort v43, v15, s[40:43], s79 offen offset:32
buffer_load_ushort v44, v16, s[40:43], s79 offen offset:32
buffer_load_ushort v45, v17, s[40:43], s79 offen offset:32
buffer_load_ushort v46, v18, s[40:43], s79 offen offset:32
buffer_load_ushort v47, v19, s[40:43], s79 offen offset:32
s_waitcnt vmcnt(0)
v_lshl_or_b32 v64, v33, 16, v32
v_lshl_or_b32 v65, v35, 16, v34
v_lshl_or_b32 v66, v37, 16, v36
v_lshl_or_b32 v67, v39, 16, v38
v_lshl_or_b32 v68, v41, 16, v40
v_lshl_or_b32 v69, v43, 16, v42
v_lshl_or_b32 v70, v45, 16, v44
v_lshl_or_b32 v71, v47, 16, v46
s_nop 1
v_mfma_f32_16x16x32_bf16 v[96:99], v[80:83], v[64:67], v[96:99]
v_mfma_f32_16x16x32_bf16 v[100:103], v[80:83], v[68:71], v[100:103]
v_mfma_f32_16x16x32_bf16 v[104:107], v[84:87], v[64:67], v[104:107]
v_mfma_f32_16x16x32_bf16 v[108:111], v[84:87], v[68:71], v[108:111]
v_mfma_f32_16x16x32_bf16 v[112:115], v[88:91], v[64:67], v[112:115]
v_mfma_f32_16x16x32_bf16 v[116:119], v[88:91], v[68:71], v[116:119]
s_add_u32 s79, s79, 262144
s_add_u32 s80, s80, 64
s_add_u32 s78, s78, 1
s_cmp_lt_u32 s78, 16
s_cbranch_scc1 L_fb_v_k
s_nop 7
s_nop 7
s_mul_i32 s82, s77, 3072
v_cvt_pk_bf16_f32 v32, v96, v97
v_cvt_pk_bf16_f32 v33, v98, v99
buffer_store_dwordx2 v[32:33], v20, s[24:27], s82 offen offset:0
s_nop 1
v_cvt_pk_bf16_f32 v32, v100, v101
v_cvt_pk_bf16_f32 v33, v102, v103
buffer_store_dwordx2 v[32:33], v20, s[24:27], s82 offen offset:1536
s_nop 1
v_cvt_pk_bf16_f32 v32, v104, v105
v_cvt_pk_bf16_f32 v33, v106, v107
buffer_store_dwordx2 v[32:33], v20, s[24:27], s82 offen offset:32
s_nop 1
v_cvt_pk_bf16_f32 v32, v108, v109
v_cvt_pk_bf16_f32 v33, v110, v111
buffer_store_dwordx2 v[32:33], v20, s[24:27], s82 offen offset:1568
s_nop 1
v_cvt_pk_bf16_f32 v32, v112, v113
v_cvt_pk_bf16_f32 v33, v114, v115
buffer_store_dwordx2 v[32:33], v20, s[24:27], s82 offen offset:64
s_nop 1
v_cvt_pk_bf16_f32 v32, v116, v117
v_cvt_pk_bf16_f32 v33, v118, v119
buffer_store_dwordx2 v[32:33], v20, s[24:27], s82 offen offset:1600
s_nop 1
s_add_u32 s77, s77, 4
s_cmp_lt_u32 s77, 128
s_cbranch_scc1 L_fb_v_tile
s_waitcnt vmcnt(0) lgkmcnt(0)
s_barrier
v_add_u32 v3, 0, v1
s_mov_b32 s81, 8192
v_mul_lo_u32 v3, v3, s81
v_mul_u32_u24 v8, 16, v2
v_add_u32 v8, v8, v3
v_add_u32 v8, 0, v8
v_add_u32 v3, 16, v1
s_mov_b32 s81, 8192
v_mul_lo_u32 v3, v3, s81
v_mul_u32_u24 v9, 16, v2
v_add_u32 v9, v9, v3
v_add_u32 v9, 0, v9
v_add_u32 v3, 32, v1
s_mov_b32 s81, 8192
v_mul_lo_u32 v3, v3, s81
v_mul_u32_u24 v10, 16, v2
v_add_u32 v10, v10, v3
v_add_u32 v10, 0, v10
v_add_u32 v3, 0, v1
s_mov_b32 s81, 8192
v_mul_lo_u32 v3, v3, s81
v_mul_u32_u24 v16, 8, v2
v_add_u32 v16, v16, v3
v_add_u32 v16, 1572864, v16
v_add_u32 v3, 16, v1
s_mov_b32 s81, 8192
v_mul_lo_u32 v3, v3, s81
v_mul_u32_u24 v17, 8, v2
v_add_u32 v17, v17, v3
v_add_u32 v17, 1572864, v17
v_add_u32 v3, 32, v1
s_mov_b32 s81, 8192
v_mul_lo_u32 v3, v3, s81
v_mul_u32_u24 v18, 8, v2
v_add_u32 v18, v18, v3
v_add_u32 v18, 1572864, v18
v_mul_u32_u24 v15, 96, v1
v_lshl_add_u32 v15, v2, 3, v15
v_add_u32 v15, 1048576, v15
v_lshlrev_b32 v19, 2, v2
v_add_u32 v3, 0, v1
v_min_u32 v12, 39, v3
v_cmp_gt_u32 vcc, 8, v3
v_mov_b32 v3, 39
s_nop 0
v_cndmask_b32 v12, v12, v3, vcc
v_add_u32 v3, 16, v1
v_min_u32 v13, 39, v3
v_cmp_gt_u32 vcc, 8, v3
v_mov_b32 v3, 39
s_nop 0
v_cndmask_b32 v13, v13, v3, vcc
v_add_u32 v3, 32, v1
v_min_u32 v14, 39, v3
v_cmp_gt_u32 vcc, 8, v3
v_mov_b32 v3, 39
s_nop 0
v_cndmask_b32 v14, v14, v3, vcc
s_mov_b32 s83, s21
L_fb_head:
s_lshl_b32 s81, s83, 8
s_add_u32 s82, s81, 65536
s_add_u32 s81, s81, 524288
buffer_load_dwordx4 v[32:35], v8, s[24:27], s81 offen offset:0 sc1
buffer_load_dwordx4 v[80:83], v8, s[24:27], s82 offen offset:0 sc1
buffer_load_dwordx4 v[36:39], v8, s[24:27], s81 offen offset:64 sc1
buffer_load_dwordx4 v[84:87], v8, s[24:27], s82 offen offset:64 sc1
buffer_load_dwordx4 v[40:43], v8, s[24:27], s81 offen offset:128 sc1
buffer_load_dwordx4 v[88:91], v8, s[24:27], s82 offen offset:128 sc1
buffer_load_dwordx4 v[44:47], v8, s[24:27], s81 offen offset:192 sc1
buffer_load_dwordx4 v[92:95], v8, s[24:27], s82 offen offset:192 sc1
buffer_load_dwordx4 v[48:51], v9, s[24:27], s81 offen offset:0 sc1
buffer_load_dwordx4 v[96:99], v9, s[24:27], s82 offen offset:0 sc1
buffer_load_dwordx4 v[52:55], v9, s[24:27], s81 offen offset:64 sc1
buffer_load_dwordx4 v[100:103], v9, s[24:27], s82 offen offset:64 sc1
buffer_load_dwordx4 v[56:59], v9, s[24:27], s81 offen offset:128 sc1
buffer_load_dwordx4 v[104:107], v9, s[24:27], s82 offen offset:128 sc1
buffer_load_dwordx4 v[60:63], v9, s[24:27], s81 offen offset:192 sc1
buffer_load_dwordx4 v[108:111], v9, s[24:27], s82 offen offset:192 sc1
buffer_load_dwordx4 v[64:67], v10, s[24:27], s81 offen offset:0 sc1
buffer_load_dwordx4 v[112:115], v10, s[24:27], s82 offen offset:0 sc1
buffer_load_dwordx4 v[68:71], v10, s[24:27], s81 offen offset:64 sc1
buffer_load_dwordx4 v[116:119], v10, s[24:27], s82 offen offset:64 sc1
buffer_load_dwordx4 v[72:75], v10, s[24:27], s81 offen offset:128 sc1
buffer_load_dwordx4 v[120:123], v10, s[24:27], s82 offen offset:128 sc1
buffer_load_dwordx4 v[76:79], v10, s[24:27], s81 offen offset:192 sc1
buffer_load_dwordx4 v[124:127], v10, s[24:27], s82 offen offset:192 sc1
s_waitcnt vmcnt(0)
v_mfma_f32_16x16x32_bf16 v[128:131], v[32:35], v[80:83], 0
v_mfma_f32_16x16x32_bf16 v[132:135], v[48:51], v[80:83], 0
v_mfma_f32_16x16x32_bf16 v[136:139], v[64:67], v[80:83], 0
v_mfma_f32_16x16x32_bf16 v[140:143], v[32:35], v[96:99], 0
v_mfma_f32_16x16x32_bf16 v[144:147], v[48:51], v[96:99], 0
v_mfma_f32_16x16x32_bf16 v[148:151], v[64:67], v[96:99], 0
v_mfma_f32_16x16x32_bf16 v[152:155], v[32:35], v[112:115], 0
v_mfma_f32_16x16x32_bf16 v[156:159], v[48:51], v[112:115], 0
v_mfma_f32_16x16x32_bf16 v[160:163], v[64:67], v[112:115], 0
v_mfma_f32_16x16x32_bf16 v[128:131], v[36:39], v[84:87], v[128:131]
v_mfma_f32_16x16x32_bf16 v[132:135], v[52:55], v[84:87], v[132:135]
v_mfma_f32_16x16x32_bf16 v[136:139], v[68:71], v[84:87], v[136:139]
v_mfma_f32_16x16x32_bf16 v[140:143], v[36:39], v[100:103], v[140:143]
v_mfma_f32_16x16x32_bf16 v[144:147], v[52:55], v[100:103], v[144:147]
v_mfma_f32_16x16x32_bf16 v[148:151], v[68:71], v[100:103], v[148:151]
v_mfma_f32_16x16x32_bf16 v[152:155], v[36:39], v[116:119], v[152:155]
v_mfma_f32_16x16x32_bf16 v[156:159], v[52:55], v[116:119], v[156:159]
v_mfma_f32_16x16x32_bf16 v[160:163], v[68:71], v[116:119], v[160:163]
v_mfma_f32_16x16x32_bf16 v[128:131], v[40:43], v[88:91], v[128:131]
v_mfma_f32_16x16x32_bf16 v[132:135], v[56:59], v[88:91], v[132:135]
v_mfma_f32_16x16x32_bf16 v[136:139], v[72:75], v[88:91], v[136:139]
v_mfma_f32_16x16x32_bf16 v[140:143], v[40:43], v[104:107], v[140:143]
v_mfma_f32_16x16x32_bf16 v[144:147], v[56:59], v[104:107], v[144:147]
v_mfma_f32_16x16x32_bf16 v[148:151], v[72:75], v[104:107], v[148:151]
v_mfma_f32_16x16x32_bf16 v[152:155], v[40:43], v[120:123], v[152:155]
v_mfma_f32_16x16x32_bf16 v[156:159], v[56:59], v[120:123], v[156:159]
v_mfma_f32_16x16x32_bf16 v[160:163], v[72:75], v[120:123], v[160:163]
v_mfma_f32_16x16x32_bf16 v[128:131], v[44:47], v[92:95], v[128:131]
v_mfma_f32_16x16x32_bf16 v[132:135], v[60:63], v[92:95], v[132:135]
v_mfma_f32_16x16x32_bf16 v[136:139], v[76:79], v[92:95], v[136:139]
v_mfma_f32_16x16x32_bf16 v[140:143], v[44:47], v[108:111], v[140:143]
v_mfma_f32_16x16x32_bf16 v[144:147], v[60:63], v[108:111], v[144:147]
v_mfma_f32_16x16x32_bf16 v[148:151], v[76:79], v[108:111], v[148:151]
v_mfma_f32_16x16x32_bf16 v[152:155], v[44:47], v[124:127], v[152:155]
v_mfma_f32_16x16x32_bf16 v[156:159], v[60:63], v[124:127], v[156:159]
v_mfma_f32_16x16x32_bf16 v[160:163], v[76:79], v[124:127], v[160:163]
s_nop 7
s_nop 7
s_mov_b32 s81, 0x3e0293ee
v_mov_b32 v203, 0xff7fffff
v_mul_f32 v128, s81, v128
v_add_u32 v200, 0, v19
v_cmp_le_u32 vcc, v200, v12
s_nop 1
v_cndmask_b32 v128, v203, v128, vcc
v_mul_f32 v129, s81, v129
v_add_u32 v200, 1, v19
v_cmp_le_u32 vcc, v200, v12
s_nop 1
v_cndmask_b32 v129, v203, v129, vcc
v_mul_f32 v130, s81, v130
v_add_u32 v200, 2, v19
v_cmp_le_u32 vcc, v200, v12
s_nop 1
v_cndmask_b32 v130, v203, v130, vcc
v_mul_f32 v131, s81, v131
v_add_u32 v200, 3, v19
v_cmp_le_u32 vcc, v200, v12
s_nop 1
v_cndmask_b32 v131, v203, v131, vcc
v_mul_f32 v132, s81, v132
v_add_u32 v200, 16, v19
v_cmp_le_u32 vcc, v200, v12
s_nop 1
v_cndmask_b32 v132, v203, v132, vcc
v_mul_f32 v133, s81, v133
v_add_u32 v200, 17, v19
v_cmp_le_u32 vcc, v200, v12
s_nop 1
v_cndmask_b32 v133, v203, v133, vcc
v_mul_f32 v134, s81, v134
v_add_u32 v200, 18, v19
v_cmp_le_u32 vcc, v200, v12
s_nop 1
v_cndmask_b32 v134, v203, v134, vcc
v_mul_f32 v135, s81, v135
v_add_u32 v200, 19, v19
v_cmp_le_u32 vcc, v200, v12
s_nop 1
v_cndmask_b32 v135, v203, v135, vcc
v_mul_f32 v136, s81, v136
v_add_u32 v200, 32, v19
v_cmp_le_u32 vcc, v200, v12
s_nop 1
v_cndmask_b32 v136, v203, v136, vcc
v_mul_f32 v137, s81, v137
v_add_u32 v200, 33, v19
v_cmp_le_u32 vcc, v200, v12
s_nop 1
v_cndmask_b32 v137, v203, v137, vcc
v_mul_f32 v138, s81, v138
v_add_u32 v200, 34, v19
v_cmp_le_u32 vcc, v200, v12
s_nop 1
v_cndmask_b32 v138, v203, v138, vcc
v_mul_f32 v139, s81, v139
v_add_u32 v200, 35, v19
v_cmp_le_u32 vcc, v200, v12
s_nop 1
v_cndmask_b32 v139, v203, v139, vcc
v_mov_b32 v200, v128
v_max_f32 v200, v200, v129
v_max_f32 v200, v200, v130
v_max_f32 v200, v200, v131
v_max_f32 v200, v200, v132
v_max_f32 v200, v200, v133
v_max_f32 v200, v200, v134
v_max_f32 v200, v200, v135
v_max_f32 v200, v200, v136
v_max_f32 v200, v200, v137
v_max_f32 v200, v200, v138
v_max_f32 v200, v200, v139
v_mov_b32 v201, v200
s_nop 1
v_permlane32_swap_b32 v200, v201
s_nop 1
v_max_f32 v200, v200, v201
v_mov_b32 v201, v200
s_nop 1
v_permlane16_swap_b32 v200, v201
s_nop 1
v_max_f32 v200, v200, v201
v_sub_f32 v128, v128, v200
v_sub_f32 v129, v129, v200
v_sub_f32 v130, v130, v200
v_sub_f32 v131, v131, v200
v_sub_f32 v132, v132, v200
v_sub_f32 v133, v133, v200
v_sub_f32 v134, v134, v200
v_sub_f32 v135, v135, v200
v_sub_f32 v136, v136, v200
v_sub_f32 v137, v137, v200
v_sub_f32 v138, v138, v200
v_sub_f32 v139, v139, v200
v_exp_f32 v128, v128
v_exp_f32 v129, v129
v_exp_f32 v130, v130
v_exp_f32 v131, v131
v_exp_f32 v132, v132
v_exp_f32 v133, v133
v_exp_f32 v134, v134
v_exp_f32 v135, v135
v_exp_f32 v136, v136
v_exp_f32 v137, v137
v_exp_f32 v138, v138
v_exp_f32 v139, v139
s_nop 1
v_mov_b32 v200, v128
v_add_f32 v200, v200, v129
v_add_f32 v200, v200, v130
v_add_f32 v200, v200, v131
v_add_f32 v200, v200, v132
v_add_f32 v200, v200, v133
v_add_f32 v200, v200, v134
v_add_f32 v200, v200, v135
v_add_f32 v200, v200, v136
v_add_f32 v200, v200, v137
v_add_f32 v200, v200, v138
v_add_f32 v200, v200, v139
v_mov_b32 v201, v200
s_nop 1
v_permlane32_swap_b32 v200, v201
s_nop 1
v_add_f32 v200, v200, v201
v_mov_b32 v201, v200
s_nop 1
v_permlane16_swap_b32 v200, v201
s_nop 1
v_add_f32 v200, v200, v201
v_rcp_f32 v200, v200
s_nop 1
v_mul_f32 v128, v200, v128
v_mul_f32 v129, v200, v129
v_mul_f32 v130, v200, v130
v_mul_f32 v131, v200, v131
v_mul_f32 v132, v200, v132
v_mul_f32 v133, v200, v133
v_mul_f32 v134, v200, v134
v_mul_f32 v135, v200, v135
v_mul_f32 v136, v200, v136
v_mul_f32 v137, v200, v137
v_mul_f32 v138, v200, v138
v_mul_f32 v139, v200, v139
v_cvt_pk_bf16_f32 v212, v128, v129
v_cvt_pk_bf16_f32 v213, v130, v131
v_cvt_pk_bf16_f32 v214, v132, v133
v_cvt_pk_bf16_f32 v215, v134, v135
v_cvt_pk_bf16_f32 v216, v136, v137
v_cvt_pk_bf16_f32 v217, v138, v139
v_mov_b32 v218, 0
v_mov_b32 v219, 0
v_mul_f32 v140, s81, v140
v_add_u32 v200, 0, v19
v_cmp_le_u32 vcc, v200, v13
s_nop 1
v_cndmask_b32 v140, v203, v140, vcc
v_mul_f32 v141, s81, v141
v_add_u32 v200, 1, v19
v_cmp_le_u32 vcc, v200, v13
s_nop 1
v_cndmask_b32 v141, v203, v141, vcc
v_mul_f32 v142, s81, v142
v_add_u32 v200, 2, v19
v_cmp_le_u32 vcc, v200, v13
s_nop 1
v_cndmask_b32 v142, v203, v142, vcc
v_mul_f32 v143, s81, v143
v_add_u32 v200, 3, v19
v_cmp_le_u32 vcc, v200, v13
s_nop 1
v_cndmask_b32 v143, v203, v143, vcc
v_mul_f32 v144, s81, v144
v_add_u32 v200, 16, v19
v_cmp_le_u32 vcc, v200, v13
s_nop 1
v_cndmask_b32 v144, v203, v144, vcc
v_mul_f32 v145, s81, v145
v_add_u32 v200, 17, v19
v_cmp_le_u32 vcc, v200, v13
s_nop 1
v_cndmask_b32 v145, v203, v145, vcc
v_mul_f32 v146, s81, v146
v_add_u32 v200, 18, v19
v_cmp_le_u32 vcc, v200, v13
s_nop 1
v_cndmask_b32 v146, v203, v146, vcc
v_mul_f32 v147, s81, v147
v_add_u32 v200, 19, v19
v_cmp_le_u32 vcc, v200, v13
s_nop 1
v_cndmask_b32 v147, v203, v147, vcc
v_mul_f32 v148, s81, v148
v_add_u32 v200, 32, v19
v_cmp_le_u32 vcc, v200, v13
s_nop 1
v_cndmask_b32 v148, v203, v148, vcc
v_mul_f32 v149, s81, v149
v_add_u32 v200, 33, v19
v_cmp_le_u32 vcc, v200, v13
s_nop 1
v_cndmask_b32 v149, v203, v149, vcc
v_mul_f32 v150, s81, v150
v_add_u32 v200, 34, v19
v_cmp_le_u32 vcc, v200, v13
s_nop 1
v_cndmask_b32 v150, v203, v150, vcc
v_mul_f32 v151, s81, v151
v_add_u32 v200, 35, v19
v_cmp_le_u32 vcc, v200, v13
s_nop 1
v_cndmask_b32 v151, v203, v151, vcc
v_mov_b32 v200, v140
v_max_f32 v200, v200, v141
v_max_f32 v200, v200, v142
v_max_f32 v200, v200, v143
v_max_f32 v200, v200, v144
v_max_f32 v200, v200, v145
v_max_f32 v200, v200, v146
v_max_f32 v200, v200, v147
v_max_f32 v200, v200, v148
v_max_f32 v200, v200, v149
v_max_f32 v200, v200, v150
v_max_f32 v200, v200, v151
v_mov_b32 v201, v200
s_nop 1
v_permlane32_swap_b32 v200, v201
s_nop 1
v_max_f32 v200, v200, v201
v_mov_b32 v201, v200
s_nop 1
v_permlane16_swap_b32 v200, v201
s_nop 1
v_max_f32 v200, v200, v201
v_sub_f32 v140, v140, v200
v_sub_f32 v141, v141, v200
v_sub_f32 v142, v142, v200
v_sub_f32 v143, v143, v200
v_sub_f32 v144, v144, v200
v_sub_f32 v145, v145, v200
v_sub_f32 v146, v146, v200
v_sub_f32 v147, v147, v200
v_sub_f32 v148, v148, v200
v_sub_f32 v149, v149, v200
v_sub_f32 v150, v150, v200
v_sub_f32 v151, v151, v200
v_exp_f32 v140, v140
v_exp_f32 v141, v141
v_exp_f32 v142, v142
v_exp_f32 v143, v143
v_exp_f32 v144, v144
v_exp_f32 v145, v145
v_exp_f32 v146, v146
v_exp_f32 v147, v147
v_exp_f32 v148, v148
v_exp_f32 v149, v149
v_exp_f32 v150, v150
v_exp_f32 v151, v151
s_nop 1
v_mov_b32 v200, v140
v_add_f32 v200, v200, v141
v_add_f32 v200, v200, v142
v_add_f32 v200, v200, v143
v_add_f32 v200, v200, v144
v_add_f32 v200, v200, v145
v_add_f32 v200, v200, v146
v_add_f32 v200, v200, v147
v_add_f32 v200, v200, v148
v_add_f32 v200, v200, v149
v_add_f32 v200, v200, v150
v_add_f32 v200, v200, v151
v_mov_b32 v201, v200
s_nop 1
v_permlane32_swap_b32 v200, v201
s_nop 1
v_add_f32 v200, v200, v201
v_mov_b32 v201, v200
s_nop 1
v_permlane16_swap_b32 v200, v201
s_nop 1
v_add_f32 v200, v200, v201
v_rcp_f32 v200, v200
s_nop 1
v_mul_f32 v140, v200, v140
v_mul_f32 v141, v200, v141
v_mul_f32 v142, v200, v142
v_mul_f32 v143, v200, v143
v_mul_f32 v144, v200, v144
v_mul_f32 v145, v200, v145
v_mul_f32 v146, v200, v146
v_mul_f32 v147, v200, v147
v_mul_f32 v148, v200, v148
v_mul_f32 v149, v200, v149
v_mul_f32 v150, v200, v150
v_mul_f32 v151, v200, v151
v_cvt_pk_bf16_f32 v220, v140, v141
v_cvt_pk_bf16_f32 v221, v142, v143
v_cvt_pk_bf16_f32 v222, v144, v145
v_cvt_pk_bf16_f32 v223, v146, v147
v_cvt_pk_bf16_f32 v224, v148, v149
v_cvt_pk_bf16_f32 v225, v150, v151
v_mov_b32 v226, 0
v_mov_b32 v227, 0
v_mul_f32 v152, s81, v152
v_add_u32 v200, 0, v19
v_cmp_le_u32 vcc, v200, v14
s_nop 1
v_cndmask_b32 v152, v203, v152, vcc
v_mul_f32 v153, s81, v153
v_add_u32 v200, 1, v19
v_cmp_le_u32 vcc, v200, v14
s_nop 1
v_cndmask_b32 v153, v203, v153, vcc
v_mul_f32 v154, s81, v154
v_add_u32 v200, 2, v19
v_cmp_le_u32 vcc, v200, v14
s_nop 1
v_cndmask_b32 v154, v203, v154, vcc
v_mul_f32 v155, s81, v155
v_add_u32 v200, 3, v19
v_cmp_le_u32 vcc, v200, v14
s_nop 1
v_cndmask_b32 v155, v203, v155, vcc
v_mul_f32 v156, s81, v156
v_add_u32 v200, 16, v19
v_cmp_le_u32 vcc, v200, v14
s_nop 1
v_cndmask_b32 v156, v203, v156, vcc
v_mul_f32 v157, s81, v157
v_add_u32 v200, 17, v19
v_cmp_le_u32 vcc, v200, v14
s_nop 1
v_cndmask_b32 v157, v203, v157, vcc
v_mul_f32 v158, s81, v158
v_add_u32 v200, 18, v19
v_cmp_le_u32 vcc, v200, v14
s_nop 1
v_cndmask_b32 v158, v203, v158, vcc
v_mul_f32 v159, s81, v159
v_add_u32 v200, 19, v19
v_cmp_le_u32 vcc, v200, v14
s_nop 1
v_cndmask_b32 v159, v203, v159, vcc
v_mul_f32 v160, s81, v160
v_add_u32 v200, 32, v19
v_cmp_le_u32 vcc, v200, v14
s_nop 1
v_cndmask_b32 v160, v203, v160, vcc
v_mul_f32 v161, s81, v161
v_add_u32 v200, 33, v19
v_cmp_le_u32 vcc, v200, v14
s_nop 1
v_cndmask_b32 v161, v203, v161, vcc
v_mul_f32 v162, s81, v162
v_add_u32 v200, 34, v19
v_cmp_le_u32 vcc, v200, v14
s_nop 1
v_cndmask_b32 v162, v203, v162, vcc
v_mul_f32 v163, s81, v163
v_add_u32 v200, 35, v19
v_cmp_le_u32 vcc, v200, v14
s_nop 1
v_cndmask_b32 v163, v203, v163, vcc
v_mov_b32 v200, v152
v_max_f32 v200, v200, v153
v_max_f32 v200, v200, v154
v_max_f32 v200, v200, v155
v_max_f32 v200, v200, v156
v_max_f32 v200, v200, v157
v_max_f32 v200, v200, v158
v_max_f32 v200, v200, v159
v_max_f32 v200, v200, v160
v_max_f32 v200, v200, v161
v_max_f32 v200, v200, v162
v_max_f32 v200, v200, v163
v_mov_b32 v201, v200
s_nop 1
v_permlane32_swap_b32 v200, v201
s_nop 1
v_max_f32 v200, v200, v201
v_mov_b32 v201, v200
s_nop 1
v_permlane16_swap_b32 v200, v201
s_nop 1
v_max_f32 v200, v200, v201
v_sub_f32 v152, v152, v200
v_sub_f32 v153, v153, v200
v_sub_f32 v154, v154, v200
v_sub_f32 v155, v155, v200
v_sub_f32 v156, v156, v200
v_sub_f32 v157, v157, v200
v_sub_f32 v158, v158, v200
v_sub_f32 v159, v159, v200
v_sub_f32 v160, v160, v200
v_sub_f32 v161, v161, v200
v_sub_f32 v162, v162, v200
v_sub_f32 v163, v163, v200
v_exp_f32 v152, v152
v_exp_f32 v153, v153
v_exp_f32 v154, v154
v_exp_f32 v155, v155
v_exp_f32 v156, v156
v_exp_f32 v157, v157
v_exp_f32 v158, v158
v_exp_f32 v159, v159
v_exp_f32 v160, v160
v_exp_f32 v161, v161
v_exp_f32 v162, v162
v_exp_f32 v163, v163
s_nop 1
v_mov_b32 v200, v152
v_add_f32 v200, v200, v153
v_add_f32 v200, v200, v154
v_add_f32 v200, v200, v155
v_add_f32 v200, v200, v156
v_add_f32 v200, v200, v157
v_add_f32 v200, v200, v158
v_add_f32 v200, v200, v159
v_add_f32 v200, v200, v160
v_add_f32 v200, v200, v161
v_add_f32 v200, v200, v162
v_add_f32 v200, v200, v163
v_mov_b32 v201, v200
s_nop 1
v_permlane32_swap_b32 v200, v201
s_nop 1
v_add_f32 v200, v200, v201
v_mov_b32 v201, v200
s_nop 1
v_permlane16_swap_b32 v200, v201
s_nop 1
v_add_f32 v200, v200, v201
v_rcp_f32 v200, v200
s_nop 1
v_mul_f32 v152, v200, v152
v_mul_f32 v153, v200, v153
v_mul_f32 v154, v200, v154
v_mul_f32 v155, v200, v155
v_mul_f32 v156, v200, v156
v_mul_f32 v157, v200, v157
v_mul_f32 v158, v200, v158
v_mul_f32 v159, v200, v159
v_mul_f32 v160, v200, v160
v_mul_f32 v161, v200, v161
v_mul_f32 v162, v200, v162
v_mul_f32 v163, v200, v163
v_cvt_pk_bf16_f32 v228, v152, v153
v_cvt_pk_bf16_f32 v229, v154, v155
v_cvt_pk_bf16_f32 v230, v156, v157
v_cvt_pk_bf16_f32 v231, v158, v159
v_cvt_pk_bf16_f32 v232, v160, v161
v_cvt_pk_bf16_f32 v233, v162, v163
v_mov_b32 v234, 0
v_mov_b32 v235, 0
v_mov_b32 v190, 0
v_mov_b32 v191, 0
s_mul_i32 s81, s83, 12288
s_lshl_b32 s82, s83, 8
buffer_load_dwordx2 v[184:185], v15, s[24:27], s81 offen offset:0 sc1
buffer_load_dwordx2 v[186:187], v15, s[24:27], s81 offen offset:32 sc1
buffer_load_dwordx2 v[188:189], v15, s[24:27], s81 offen offset:64 sc1
s_add_u32 s81, s81, 1536
s_waitcnt vmcnt(0)
v_mfma_f32_16x16x32_bf16 v[192:195], v[184:187], v[212:215], 0
v_mfma_f32_16x16x32_bf16 v[192:195], v[188:191], v[216:219], v[192:195]
v_mfma_f32_16x16x32_bf16 v[196:199], v[184:187], v[220:223], 0
v_mfma_f32_16x16x32_bf16 v[196:199], v[188:191], v[224:227], v[196:199]
v_mfma_f32_16x16x32_bf16 v[200:203], v[184:187], v[228:231], 0
v_mfma_f32_16x16x32_bf16 v[200:203], v[188:191], v[232:235], v[200:203]
s_nop 7
s_nop 7
v_cvt_pk_bf16_f32 v204, v192, v193
v_cvt_pk_bf16_f32 v205, v194, v195
buffer_store_dwordx2 v[204:205], v16, s[24:27], s82 offen offset:0
v_cvt_pk_bf16_f32 v206, v196, v197
v_cvt_pk_bf16_f32 v207, v198, v199
buffer_store_dwordx2 v[206:207], v17, s[24:27], s82 offen offset:0
v_cvt_pk_bf16_f32 v208, v200, v201
v_cvt_pk_bf16_f32 v209, v202, v203
buffer_store_dwordx2 v[208:209], v18, s[24:27], s82 offen offset:0
s_nop 1
buffer_load_dwordx2 v[184:185], v15, s[24:27], s81 offen offset:0 sc1
buffer_load_dwordx2 v[186:187], v15, s[24:27], s81 offen offset:32 sc1
buffer_load_dwordx2 v[188:189], v15, s[24:27], s81 offen offset:64 sc1
s_add_u32 s81, s81, 1536
s_waitcnt vmcnt(0)
v_mfma_f32_16x16x32_bf16 v[192:195], v[184:187], v[212:215], 0
v_mfma_f32_16x16x32_bf16 v[192:195], v[188:191], v[216:219], v[192:195]
v_mfma_f32_16x16x32_bf16 v[196:199], v[184:187], v[220:223], 0
v_mfma_f32_16x16x32_bf16 v[196:199], v[188:191], v[224:227], v[196:199]
v_mfma_f32_16x16x32_bf16 v[200:203], v[184:187], v[228:231], 0
v_mfma_f32_16x16x32_bf16 v[200:203], v[188:191], v[232:235], v[200:203]
s_nop 7
s_nop 7
v_cvt_pk_bf16_f32 v204, v192, v193
v_cvt_pk_bf16_f32 v205, v194, v195
buffer_store_dwordx2 v[204:205], v16, s[24:27], s82 offen offset:32
v_cvt_pk_bf16_f32 v206, v196, v197
v_cvt_pk_bf16_f32 v207, v198, v199
buffer_store_dwordx2 v[206:207], v17, s[24:27], s82 offen offset:32
v_cvt_pk_bf16_f32 v208, v200, v201
v_cvt_pk_bf16_f32 v209, v202, v203
buffer_store_dwordx2 v[208:209], v18, s[24:27], s82 offen offset:32
s_nop 1
buffer_load_dwordx2 v[184:185], v15, s[24:27], s81 offen offset:0 sc1
buffer_load_dwordx2 v[186:187], v15, s[24:27], s81 offen offset:32 sc1
buffer_load_dwordx2 v[188:189], v15, s[24:27], s81 offen offset:64 sc1
s_add_u32 s81, s81, 1536
s_waitcnt vmcnt(0)
v_mfma_f32_16x16x32_bf16 v[192:195], v[184:187], v[212:215], 0
v_mfma_f32_16x16x32_bf16 v[192:195], v[188:191], v[216:219], v[192:195]
v_mfma_f32_16x16x32_bf16 v[196:199], v[184:187], v[220:223], 0
v_mfma_f32_16x16x32_bf16 v[196:199], v[188:191], v[224:227], v[196:199]
v_mfma_f32_16x16x32_bf16 v[200:203], v[184:187], v[228:231], 0
v_mfma_f32_16x16x32_bf16 v[200:203], v[188:191], v[232:235], v[200:203]
s_nop 7
s_nop 7
v_cvt_pk_bf16_f32 v204, v192, v193
v_cvt_pk_bf16_f32 v205, v194, v195
buffer_store_dwordx2 v[204:205], v16, s[24:27], s82 offen offset:64
v_cvt_pk_bf16_f32 v206, v196, v197
v_cvt_pk_bf16_f32 v207, v198, v199
buffer_store_dwordx2 v[206:207], v17, s[24:27], s82 offen offset:64
v_cvt_pk_bf16_f32 v208, v200, v201
v_cvt_pk_bf16_f32 v209, v202, v203
buffer_store_dwordx2 v[208:209], v18, s[24:27], s82 offen offset:64
s_nop 1
buffer_load_dwordx2 v[184:185], v15, s[24:27], s81 offen offset:0 sc1
buffer_load_dwordx2 v[186:187], v15, s[24:27], s81 offen offset:32 sc1
buffer_load_dwordx2 v[188:189], v15, s[24:27], s81 offen offset:64 sc1
s_add_u32 s81, s81, 1536
s_waitcnt vmcnt(0)
v_mfma_f32_16x16x32_bf16 v[192:195], v[184:187], v[212:215], 0
v_mfma_f32_16x16x32_bf16 v[192:195], v[188:191], v[216:219], v[192:195]
v_mfma_f32_16x16x32_bf16 v[196:199], v[184:187], v[220:223], 0
v_mfma_f32_16x16x32_bf16 v[196:199], v[188:191], v[224:227], v[196:199]
v_mfma_f32_16x16x32_bf16 v[200:203], v[184:187], v[228:231], 0
v_mfma_f32_16x16x32_bf16 v[200:203], v[188:191], v[232:235], v[200:203]
s_nop 7
s_nop 7
v_cvt_pk_bf16_f32 v204, v192, v193
v_cvt_pk_bf16_f32 v205, v194, v195
buffer_store_dwordx2 v[204:205], v16, s[24:27], s82 offen offset:96
v_cvt_pk_bf16_f32 v206, v196, v197
v_cvt_pk_bf16_f32 v207, v198, v199
buffer_store_dwordx2 v[206:207], v17, s[24:27], s82 offen offset:96
v_cvt_pk_bf16_f32 v208, v200, v201
v_cvt_pk_bf16_f32 v209, v202, v203
buffer_store_dwordx2 v[208:209], v18, s[24:27], s82 offen offset:96
s_nop 1
buffer_load_dwordx2 v[184:185], v15, s[24:27], s81 offen offset:0 sc1
buffer_load_dwordx2 v[186:187], v15, s[24:27], s81 offen offset:32 sc1
buffer_load_dwordx2 v[188:189], v15, s[24:27], s81 offen offset:64 sc1
s_add_u32 s81, s81, 1536
s_waitcnt vmcnt(0)
v_mfma_f32_16x16x32_bf16 v[192:195], v[184:187], v[212:215], 0
v_mfma_f32_16x16x32_bf16 v[192:195], v[188:191], v[216:219], v[192:195]
v_mfma_f32_16x16x32_bf16 v[196:199], v[184:187], v[220:223], 0
v_mfma_f32_16x16x32_bf16 v[196:199], v[188:191], v[224:227], v[196:199]
v_mfma_f32_16x16x32_bf16 v[200:203], v[184:187], v[228:231], 0
v_mfma_f32_16x16x32_bf16 v[200:203], v[188:191], v[232:235], v[200:203]
s_nop 7
s_nop 7
v_cvt_pk_bf16_f32 v204, v192, v193
v_cvt_pk_bf16_f32 v205, v194, v195
buffer_store_dwordx2 v[204:205], v16, s[24:27], s82 offen offset:128
v_cvt_pk_bf16_f32 v206, v196, v197
v_cvt_pk_bf16_f32 v207, v198, v199
buffer_store_dwordx2 v[206:207], v17, s[24:27], s82 offen offset:128
v_cvt_pk_bf16_f32 v208, v200, v201
v_cvt_pk_bf16_f32 v209, v202, v203
buffer_store_dwordx2 v[208:209], v18, s[24:27], s82 offen offset:128
s_nop 1
buffer_load_dwordx2 v[184:185], v15, s[24:27], s81 offen offset:0 sc1
buffer_load_dwordx2 v[186:187], v15, s[24:27], s81 offen offset:32 sc1
buffer_load_dwordx2 v[188:189], v15, s[24:27], s81 offen offset:64 sc1
s_add_u32 s81, s81, 1536
s_waitcnt vmcnt(0)
v_mfma_f32_16x16x32_bf16 v[192:195], v[184:187], v[212:215], 0
v_mfma_f32_16x16x32_bf16 v[192:195], v[188:191], v[216:219], v[192:195]
v_mfma_f32_16x16x32_bf16 v[196:199], v[184:187], v[220:223], 0
v_mfma_f32_16x16x32_bf16 v[196:199], v[188:191], v[224:227], v[196:199]
v_mfma_f32_16x16x32_bf16 v[200:203], v[184:187], v[228:231], 0
v_mfma_f32_16x16x32_bf16 v[200:203], v[188:191], v[232:235], v[200:203]
s_nop 7
s_nop 7
v_cvt_pk_bf16_f32 v204, v192, v193
v_cvt_pk_bf16_f32 v205, v194, v195
buffer_store_dwordx2 v[204:205], v16, s[24:27], s82 offen offset:160
v_cvt_pk_bf16_f32 v206, v196, v197
v_cvt_pk_bf16_f32 v207, v198, v199
buffer_store_dwordx2 v[206:207], v17, s[24:27], s82 offen offset:160
v_cvt_pk_bf16_f32 v208, v200, v201
v_cvt_pk_bf16_f32 v209, v202, v203
buffer_store_dwordx2 v[208:209], v18, s[24:27], s82 offen offset:160
s_nop 1
buffer_load_dwordx2 v[184:185], v15, s[24:27], s81 offen offset:0 sc1
buffer_load_dwordx2 v[186:187], v15, s[24:27], s81 offen offset:32 sc1
buffer_load_dwordx2 v[188:189], v15, s[24:27], s81 offen offset:64 sc1
s_add_u32 s81, s81, 1536
s_waitcnt vmcnt(0)
v_mfma_f32_16x16x32_bf16 v[192:195], v[184:187], v[212:215], 0
v_mfma_f32_16x16x32_bf16 v[192:195], v[188:191], v[216:219], v[192:195]
v_mfma_f32_16x16x32_bf16 v[196:199], v[184:187], v[220:223], 0
v_mfma_f32_16x16x32_bf16 v[196:199], v[188:191], v[224:227], v[196:199]
v_mfma_f32_16x16x32_bf16 v[200:203], v[184:187], v[228:231], 0
v_mfma_f32_16x16x32_bf16 v[200:203], v[188:191], v[232:235], v[200:203]
s_nop 7
s_nop 7
v_cvt_pk_bf16_f32 v204, v192, v193
v_cvt_pk_bf16_f32 v205, v194, v195
buffer_store_dwordx2 v[204:205], v16, s[24:27], s82 offen offset:192
v_cvt_pk_bf16_f32 v206, v196, v197
v_cvt_pk_bf16_f32 v207, v198, v199
buffer_store_dwordx2 v[206:207], v17, s[24:27], s82 offen offset:192
v_cvt_pk_bf16_f32 v208, v200, v201
v_cvt_pk_bf16_f32 v209, v202, v203
buffer_store_dwordx2 v[208:209], v18, s[24:27], s82 offen offset:192
s_nop 1
buffer_load_dwordx2 v[184:185], v15, s[24:27], s81 offen offset:0 sc1
buffer_load_dwordx2 v[186:187], v15, s[24:27], s81 offen offset:32 sc1
buffer_load_dwordx2 v[188:189], v15, s[24:27], s81 offen offset:64 sc1
s_add_u32 s81, s81, 1536
s_waitcnt vmcnt(0)
v_mfma_f32_16x16x32_bf16 v[192:195], v[184:187], v[212:215], 0
v_mfma_f32_16x16x32_bf16 v[192:195], v[188:191], v[216:219], v[192:195]
v_mfma_f32_16x16x32_bf16 v[196:199], v[184:187], v[220:223], 0
v_mfma_f32_16x16x32_bf16 v[196:199], v[188:191], v[224:227], v[196:199]
v_mfma_f32_16x16x32_bf16 v[200:203], v[184:187], v[228:231], 0
v_mfma_f32_16x16x32_bf16 v[200:203], v[188:191], v[232:235], v[200:203]
s_nop 7
s_nop 7
v_cvt_pk_bf16_f32 v204, v192, v193
v_cvt_pk_bf16_f32 v205, v194, v195
buffer_store_dwordx2 v[204:205], v16, s[24:27], s82 offen offset:224
v_cvt_pk_bf16_f32 v206, v196, v197
v_cvt_pk_bf16_f32 v207, v198, v199
buffer_store_dwordx2 v[206:207], v17, s[24:27], s82 offen offset:224
v_cvt_pk_bf16_f32 v208, v200, v201
v_cvt_pk_bf16_f32 v209, v202, v203
buffer_store_dwordx2 v[208:209], v18, s[24:27], s82 offen offset:224
s_nop 1
s_add_u32 s83, s83, 4
s_cmp_lt_u32 s83, 32
s_cbranch_scc1 L_fb_head
s_waitcnt vmcnt(0) lgkmcnt(0)
s_barrier
v_add_u32 v3, 0, v1
s_mov_b32 s81, 1024
v_mul_lo_u32 v3, v3, s81
v_mul_u32_u24 v20, 8, v2
v_add_u32 v20, v20, v3
v_add_u32 v20, 2097152, v20
v_add_u32 v3, 16, v1
s_mov_b32 s81, 1024
v_mul_lo_u32 v3, v3, s81
v_mul_u32_u24 v21, 8, v2
v_add_u32 v21, v21, v3
v_add_u32 v21, 2097152, v21
v_add_u32 v3, 32, v1
s_mov_b32 s81, 1024
v_mul_lo_u32 v3, v3, s81
v_mul_u32_u24 v22, 8, v2
v_add_u32 v22, v22, v3
v_add_u32 v22, 2097152, v22
v_add_u32 v3, 0, v1
s_mov_b32 s81, 8192
v_mul_lo_u32 v3, v3, s81
v_mul_u32_u24 v8, 16, v2
v_add_u32 v8, v8, v3
v_add_u32 v8, 1572864, v8
v_add_u32 v3, 16, v1
s_mov_b32 s81, 8192
v_mul_lo_u32 v3, v3, s81
v_mul_u32_u24 v9, 16, v2
v_add_u32 v9, v9, v3
v_add_u32 v9, 1572864, v9
v_add_u32 v3, 32, v1
s_mov_b32 s81, 8192
v_mul_lo_u32 v3, v3, s81
v_mul_u32_u24 v10, 16, v2
v_add_u32 v10, v10, v3
v_add_u32 v10, 1572864, v10
v_lshlrev_b32 v3, 3, v2
s_mov_b32 s81, 1024
v_mul_lo_u32 v3, v3, s81
v_lshl_add_u32 v12, v1, 1, v3
v_add_u32 v13, 1024, v12
v_add_u32 v14, 2048, v12
v_add_u32 v15, 3072, v12
v_add_u32 v16, 4096, v12
v_add_u32 v17, 5120, v12
v_add_u32 v18, 6144, v12
v_add_u32 v19, 7168, v12
s_mov_b32 s77, s21
L_fb_o_tile:
s_lshl_b32 s79, s77, 6
s_mov_b32 s80, 0
s_mov_b32 s78, 0
v_mov_b32 v96, 0
v_mov_b32 v97, 0
v_mov_b32 v98, 0
v_mov_b32 v99, 0
v_mov_b32 v100, 0
v_mov_b32 v101, 0
v_mov_b32 v102, 0
v_mov_b32 v103, 0
v_mov_b32 v104, 0
v_mov_b32 v105, 0
v_mov_b32 v106, 0
v_mov_b32 v107, 0
v_mov_b32 v108, 0
v_mov_b32 v109, 0
v_mov_b32 v110, 0
v_mov_b32 v111, 0
v_mov_b32 v112, 0
v_mov_b32 v113, 0
v_mov_b32 v114, 0
v_mov_b32 v115, 0
v_mov_b32 v116, 0
v_mov_b32 v117, 0
v_mov_b32 v118, 0
v_mov_b32 v119, 0
L_fb_o_k:
buffer_load_dwordx4 v[80:83], v8, s[24:27], s80 offen sc1
buffer_load_dwordx4 v[84:87], v9, s[24:27], s80 offen sc1
buffer_load_dwordx4 v[88:91], v10, s[24:27], s80 offen sc1
buffer_load_ushort v32, v12, s[44:47], s79 offen offset:0
buffer_load_ushort v33, v13, s[44:47], s79 offen offset:0
buffer_load_ushort v34, v14, s[44:47], s79 offen offset:0
buffer_load_ushort v35, v15, s[44:47], s79 offen offset:0
buffer_load_ushort v36, v16, s[44:47], s79 offen offset:0
buffer_load_ushort v37, v17, s[44:47], s79 offen offset:0
buffer_load_ushort v38, v18, s[44:47], s79 offen offset:0
buffer_load_ushort v39, v19, s[44:47], s79 offen offset:0
buffer_load_ushort v40, v12, s[44:47], s79 offen offset:32
buffer_load_ushort v41, v13, s[44:47], s79 offen offset:32
buffer_load_ushort v42, v14, s[44:47], s79 offen offset:32
buffer_load_ushort v43, v15, s[44:47], s79 offen offset:32
buffer_load_ushort v44, v16, s[44:47], s79 offen offset:32
buffer_load_ushort v45, v17, s[44:47], s79 offen offset:32
buffer_load_ushort v46, v18, s[44:47], s79 offen offset:32
buffer_load_ushort v47, v19, s[44:47], s79 offen offset:32
s_waitcnt vmcnt(0)
v_lshl_or_b32 v64, v33, 16, v32
v_lshl_or_b32 v65, v35, 16, v34
v_lshl_or_b32 v66, v37, 16, v36
v_lshl_or_b32 v67, v39, 16, v38
v_lshl_or_b32 v68, v41, 16, v40
v_lshl_or_b32 v69, v43, 16, v42
v_lshl_or_b32 v70, v45, 16, v44
v_lshl_or_b32 v71, v47, 16, v46
s_nop 1
v_mfma_f32_16x16x32_bf16 v[96:99], v[64:67], v[80:83], v[96:99]
v_mfma_f32_16x16x32_bf16 v[100:103], v[68:71], v[80:83], v[100:103]
v_mfma_f32_16x16x32_bf16 v[104:107], v[64:67], v[84:87], v[104:107]
v_mfma_f32_16x16x32_bf16 v[108:111], v[68:71], v[84:87], v[108:111]
v_mfma_f32_16x16x32_bf16 v[112:115], v[64:67], v[88:91], v[112:115]
v_mfma_f32_16x16x32_bf16 v[116:119], v[68:71], v[88:91], v[116:119]
s_add_u32 s79, s79, 32768
s_add_u32 s80, s80, 64
s_add_u32 s78, s78, 1
s_cmp_lt_u32 s78, 128
s_cbranch_scc1 L_fb_o_k
s_nop 7
s_nop 7
s_lshl_b32 s82, s77, 6
v_cvt_pk_bf16_f32 v32, v96, v97
v_cvt_pk_bf16_f32 v33, v98, v99
buffer_store_dwordx2 v[32:33], v20, s[24:27], s82 offen offset:0
v_subrev_u32 v3, 2097152, v20
s_mov_b32 exec_lo, 0x00ff00ff
s_mov_b32 exec_hi, 0x00ff00ff
buffer_store_dwordx2 v[32:33], v3, s[24:27], s82 offen offset:0
s_mov_b64 exec, -1
s_nop 1
v_cvt_pk_bf16_f32 v32, v100, v101
v_cvt_pk_bf16_f32 v33, v102, v103
buffer_store_dwordx2 v[32:33], v20, s[24:27], s82 offen offset:32
v_subrev_u32 v3, 2097152, v20
s_mov_b32 exec_lo, 0x00ff00ff
s_mov_b32 exec_hi, 0x00ff00ff
buffer_store_dwordx2 v[32:33], v3, s[24:27], s82 offen offset:32
s_mov_b64 exec, -1
s_nop 1
v_cvt_pk_bf16_f32 v32, v104, v105
v_cvt_pk_bf16_f32 v33, v106, v107
buffer_store_dwordx2 v[32:33], v21, s[24:27], s82 offen offset:0
s_nop 1
v_cvt_pk_bf16_f32 v32, v108, v109
v_cvt_pk_bf16_f32 v33, v110, v111
buffer_store_dwordx2 v[32:33], v21, s[24:27], s82 offen offset:32
s_nop 1
v_cvt_pk_bf16_f32 v32, v112, v113
v_cvt_pk_bf16_f32 v33, v114, v115
buffer_store_dwordx2 v[32:33], v22, s[24:27], s82 offen offset:0
s_nop 1
v_cvt_pk_bf16_f32 v32, v116, v117
v_cvt_pk_bf16_f32 v33, v118, v119
buffer_store_dwordx2 v[32:33], v22, s[24:27], s82 offen offset:32
s_nop 1
s_add_u32 s77, s77, 4
s_cmp_lt_u32 s77, 16
s_cbranch_scc1 L_fb_o_tile
v_add_u32 v3, 0, v1
s_mov_b32 s81, 2752
v_mul_lo_u32 v3, v3, s81
v_mul_u32_u24 v20, 8, v2
v_add_u32 v20, v20, v3
v_add_u32 v20, 2162688, v20
v_add_u32 v3, 16, v1
s_mov_b32 s81, 2752
v_mul_lo_u32 v3, v3, s81
v_mul_u32_u24 v21, 8, v2
v_add_u32 v21, v21, v3
v_add_u32 v21, 2162688, v21
v_add_u32 v3, 0, v1
s_mov_b32 s81, 1024
v_mul_lo_u32 v3, v3, s81
v_mul_u32_u24 v8, 16, v2
v_add_u32 v8, v8, v3
v_add_u32 v8, 8192, v8
v_add_u32 v3, 16, v1
s_mov_b32 s81, 1024
v_mul_lo_u32 v3, v3, s81
v_mul_u32_u24 v9, 16, v2
v_add_u32 v9, v9, v3
v_add_u32 v9, 8192, v9
v_lshlrev_b32 v3, 3, v2
s_mov_b32 s81, 2752
v_mul_lo_u32 v3, v3, s81
v_lshl_add_u32 v12, v1, 1, v3
v_add_u32 v13, 2752, v12
v_add_u32 v14, 5504, v12
v_add_u32 v15, 8256, v12
v_add_u32 v16, 11008, v12
v_add_u32 v17, 13760, v12
v_add_u32 v18, 16512, v12
v_add_u32 v19, 19264, v12
s_mov_b32 s77, s21
L_fb_g_tile:
s_lshl_b32 s79, s77, 6
s_mov_b32 s80, 0
s_mov_b32 s78, 0
v_mov_b32 v96, 0
v_mov_b32 v97, 0
v_mov_b32 v98, 0
v_mov_b32 v99, 0
v_mov_b32 v100, 0
v_mov_b32 v101, 0
v_mov_b32 v102, 0
v_mov_b32 v103, 0
v_mov_b32 v104, 0
v_mov_b32 v105, 0
v_mov_b32 v106, 0
v_mov_b32 v107, 0
v_mov_b32 v108, 0
v_mov_b32 v109, 0
v_mov_b32 v110, 0
v_mov_b32 v111, 0
v_mov_b32 v112, 0
v_mov_b32 v113, 0
v_mov_b32 v114, 0
v_mov_b32 v115, 0
v_mov_b32 v116, 0
v_mov_b32 v117, 0
v_mov_b32 v118, 0
v_mov_b32 v119, 0
v_mov_b32 v120, 0
v_mov_b32 v121, 0
v_mov_b32 v122, 0
v_mov_b32 v123, 0
v_mov_b32 v124, 0
v_mov_b32 v125, 0
v_mov_b32 v126, 0
v_mov_b32 v127, 0
L_fb_g_k:
buffer_load_dwordx4 v[80:83], v8, s[24:27], s80 offen sc1
buffer_load_dwordx4 v[84:87], v9, s[24:27], s80 offen sc1
buffer_load_ushort v32, v12, s[52:55], s79 offen offset:0
buffer_load_ushort v33, v13, s[52:55], s79 offen offset:0
buffer_load_ushort v34, v14, s[52:55], s79 offen offset:0
buffer_load_ushort v35, v15, s[52:55], s79 offen offset:0
buffer_load_ushort v36, v16, s[52:55], s79 offen offset:0
buffer_load_ushort v37, v17, s[52:55], s79 offen offset:0
buffer_load_ushort v38, v18, s[52:55], s79 offen offset:0
buffer_load_ushort v39, v19, s[52:55], s79 offen offset:0
buffer_load_ushort v40, v12, s[52:55], s79 offen offset:32
buffer_load_ushort v41, v13, s[52:55], s79 offen offset:32
buffer_load_ushort v42, v14, s[52:55], s79 offen offset:32
buffer_load_ushort v43, v15, s[52:55], s79 offen offset:32
buffer_load_ushort v44, v16, s[52:55], s79 offen offset:32
buffer_load_ushort v45, v17, s[52:55], s79 offen offset:32
buffer_load_ushort v46, v18, s[52:55], s79 offen offset:32
buffer_load_ushort v47, v19, s[52:55], s79 offen offset:32
buffer_load_ushort v48, v12, s[56:59], s79 offen offset:0
buffer_load_ushort v49, v13, s[56:59], s79 offen offset:0
buffer_load_ushort v50, v14, s[56:59], s79 offen offset:0
buffer_load_ushort v51, v15, s[56:59], s79 offen offset:0
buffer_load_ushort v52, v16, s[56:59], s79 offen offset:0
buffer_load_ushort v53, v17, s[56:59], s79 offen offset:0
buffer_load_ushort v54, v18, s[56:59], s79 offen offset:0
buffer_load_ushort v55, v19, s[56:59], s79 offen offset:0
buffer_load_ushort v56, v12, s[56:59], s79 offen offset:32
buffer_load_ushort v57, v13, s[56:59], s79 offen offset:32
buffer_load_ushort v58, v14, s[56:59], s79 offen offset:32
buffer_load_ushort v59, v15, s[56:59], s79 offen offset:32
buffer_load_ushort v60, v16, s[56:59], s79 offen offset:32
buffer_load_ushort v61, v17, s[56:59], s79 offen offset:32
buffer_load_ushort v62, v18, s[56:59], s79 offen offset:32
buffer_load_ushort v63, v19, s[56:59], s79 offen offset:32
s_waitcnt vmcnt(0)
v_lshl_or_b32 v64, v33, 16, v32
v_lshl_or_b32 v65, v35, 16, v34
v_lshl_or_b32 v66, v37, 16, v36
v_lshl_or_b32 v67, v39, 16, v38
v_lshl_or_b32 v68, v41, 16, v40
v_lshl_or_b32 v69, v43, 16, v42
v_lshl_or_b32 v70, v45, 16, v44
v_lshl_or_b32 v71, v47, 16, v46
v_lshl_or_b32 v72, v49, 16, v48
v_lshl_or_b32 v73, v51, 16, v50
v_lshl_or_b32 v74, v53, 16, v52
v_lshl_or_b32 v75, v55, 16, v54
v_lshl_or_b32 v76, v57, 16, v56
v_lshl_or_b32 v77, v59, 16, v58
v_lshl_or_b32 v78, v61, 16, v60
v_lshl_or_b32 v79, v63, 16, v62
s_nop 1
v_mfma_f32_16x16x32_bf16 v[96:99], v[64:67], v[80:83], v[96:99]
v_mfma_f32_16x16x32_bf16 v[100:103], v[68:71], v[80:83], v[100:103]
v_mfma_f32_16x16x32_bf16 v[104:107], v[64:67], v[84:87], v[104:107]
v_mfma_f32_16x16x32_bf16 v[108:111], v[68:71], v[84:87], v[108:111]
v_mfma_f32_16x16x32_bf16 v[112:115], v[72:75], v[80:83], v[112:115]
v_mfma_f32_16x16x32_bf16 v[116:119], v[76:79], v[80:83], v[116:119]
v_mfma_f32_16x16x32_bf16 v[120:123], v[72:75], v[84:87], v[120:123]
v_mfma_f32_16x16x32_bf16 v[124:127], v[76:79], v[84:87], v[124:127]
s_add_u32 s79, s79, 88064
s_add_u32 s80, s80, 64
s_add_u32 s78, s78, 1
s_cmp_lt_u32 s78, 16
s_cbranch_scc1 L_fb_g_k
s_nop 7
s_nop 7
s_lshl_b32 s82, s77, 6
s_mov_b32 s81, 0xbfb8aa3b
v_mul_f32 v96, s81, v96
v_mul_f32 v97, s81, v97
v_mul_f32 v98, s81, v98
v_mul_f32 v99, s81, v99
v_mul_f32 v100, s81, v100
v_mul_f32 v101, s81, v101
v_mul_f32 v102, s81, v102
v_mul_f32 v103, s81, v103
v_mul_f32 v104, s81, v104
v_mul_f32 v105, s81, v105
v_mul_f32 v106, s81, v106
v_mul_f32 v107, s81, v107
v_mul_f32 v108, s81, v108
v_mul_f32 v109, s81, v109
v_mul_f32 v110, s81, v110
v_mul_f32 v111, s81, v111
v_exp_f32 v96, v96
v_exp_f32 v97, v97
v_exp_f32 v98, v98
v_exp_f32 v99, v99
v_exp_f32 v100, v100
v_exp_f32 v101, v101
v_exp_f32 v102, v102
v_exp_f32 v103, v103
v_exp_f32 v104, v104
v_exp_f32 v105, v105
v_exp_f32 v106, v106
v_exp_f32 v107, v107
v_exp_f32 v108, v108
v_exp_f32 v109, v109
v_exp_f32 v110, v110
v_exp_f32 v111, v111
v_add_f32 v96, 1.0, v96
v_add_f32 v97, 1.0, v97
v_add_f32 v98, 1.0, v98
v_add_f32 v99, 1.0, v99
v_add_f32 v100, 1.0, v100
v_add_f32 v101, 1.0, v101
v_add_f32 v102, 1.0, v102
v_add_f32 v103, 1.0, v103
v_add_f32 v104, 1.0, v104
v_add_f32 v105, 1.0, v105
v_add_f32 v106, 1.0, v106
v_add_f32 v107, 1.0, v107
v_add_f32 v108, 1.0, v108
v_add_f32 v109, 1.0, v109
v_add_f32 v110, 1.0, v110
v_add_f32 v111, 1.0, v111
v_rcp_f32 v96, v96
v_rcp_f32 v97, v97
v_rcp_f32 v98, v98
v_rcp_f32 v99, v99
v_rcp_f32 v100, v100
v_rcp_f32 v101, v101
v_rcp_f32 v102, v102
v_rcp_f32 v103, v103
v_rcp_f32 v104, v104
v_rcp_f32 v105, v105
v_rcp_f32 v106, v106
v_rcp_f32 v107, v107
v_rcp_f32 v108, v108
v_rcp_f32 v109, v109
v_rcp_f32 v110, v110
v_rcp_f32 v111, v111
s_nop 1
v_mul_f32 v96, v96, v112
v_mul_f32 v97, v97, v113
v_mul_f32 v98, v98, v114
v_mul_f32 v99, v99, v115
v_cvt_pk_bf16_f32 v32, v96, v97
v_cvt_pk_bf16_f32 v33, v98, v99
buffer_store_dwordx2 v[32:33], v20, s[24:27], s82 offen offset:0
s_nop 1
v_mul_f32 v100, v100, v116
v_mul_f32 v101, v101, v117
v_mul_f32 v102, v102, v118
v_mul_f32 v103, v103, v119
v_cvt_pk_bf16_f32 v32, v100, v101
v_cvt_pk_bf16_f32 v33, v102, v103
buffer_store_dwordx2 v[32:33], v20, s[24:27], s82 offen offset:32
s_nop 1
v_mul_f32 v104, v104, v120
v_mul_f32 v105, v105, v121
v_mul_f32 v106, v106, v122
v_mul_f32 v107, v107, v123
v_cvt_pk_bf16_f32 v32, v104, v105
v_cvt_pk_bf16_f32 v33, v106, v107
buffer_store_dwordx2 v[32:33], v21, s[24:27], s82 offen offset:0
s_nop 1
v_mul_f32 v108, v108, v124
v_mul_f32 v109, v109, v125
v_mul_f32 v110, v110, v126
v_mul_f32 v111, v111, v127
v_cvt_pk_bf16_f32 v32, v108, v109
v_cvt_pk_bf16_f32 v33, v110, v111
buffer_store_dwordx2 v[32:33], v21, s[24:27], s82 offen offset:32
s_nop 1
s_add_u32 s77, s77, 4
s_cmp_lt_u32 s77, 43
s_cbranch_scc1 L_fb_g_tile
s_waitcnt vmcnt(0) lgkmcnt(0)
s_barrier
v_add_u32 v3, 0, v1
s_mov_b32 s81, 1024
v_mul_lo_u32 v3, v3, s81
v_mul_u32_u24 v8, 16, v2
v_add_u32 v8, v8, v3
v_add_u32 v8, 8192, v8
v_add_u32 v3, 16, v1
s_mov_b32 s81, 1024
v_mul_lo_u32 v3, v3, s81
v_mul_u32_u24 v9, 16, v2
v_add_u32 v9, v9, v3
v_add_u32 v9, 8192, v9
v_lshlrev_b32 v3, 4, v2
s_mov_b32 s80, 0
v_mov_b32 v160, 0
v_mov_b32 v161, 0
v_mov_b32 v162, 0
v_mov_b32 v163, 0
v_mov_b32 v164, 0
v_mov_b32 v165, 0
v_mov_b32 v166, 0
v_mov_b32 v167, 0
L_fb_gate:
buffer_load_dwordx4 v[80:83], v8, s[24:27], s80 offen sc1
buffer_load_dwordx4 v[84:87], v9, s[24:27], s80 offen sc1
buffer_load_dwordx4 v[64:67], v3, s[64:67], s80 offen
s_waitcnt vmcnt(0)
v_mfma_f32_16x16x32_bf16 v[160:163], v[64:67], v[80:83], v[160:163]
v_mfma_f32_16x16x32_bf16 v[164:167], v[64:67], v[84:87], v[164:167]
s_add_u32 s80, s80, 64
s_cmp_lt_u32 s80, 1024
s_cbranch_scc1 L_fb_gate
s_nop 7
s_nop 7
s_mov_b32 s81, 0xbfb8aa3b
v_mul_f32 v160, s81, v160
v_mul_f32 v164, s81, v164
v_exp_f32 v160, v160
v_exp_f32 v164, v164
v_add_f32 v160, 1.0, v160
v_add_f32 v164, 1.0, v164
v_rcp_f32 v160, v160
v_rcp_f32 v164, v164
s_nop 1
v_add_u32 v3, 0, v1
s_mov_b32 s81, 1024
v_mul_lo_u32 v3, v3, s81
v_mul_u32_u24 v24, 8, v2
v_add_u32 v24, v24, v3
v_add_u32 v24, 2105344, v24
v_add_u32 v3, 16, v1
s_mov_b32 s81, 1024
v_mul_lo_u32 v3, v3, s81
v_mul_u32_u24 v25, 8, v2
v_add_u32 v25, v25, v3
v_add_u32 v25, 2105344, v25
v_add_u32 v3, 0, v1
s_mov_b32 s81, 1024
v_mul_lo_u32 v3, v3, s81
v_mul_u32_u24 v20, 8, v2
v_add_u32 v20, v20, v3
v_add_u32 v20, 0, v20
v_add_u32 v3, 16, v1
s_mov_b32 s81, 1024
v_mul_lo_u32 v3, v3, s81
v_mul_u32_u24 v21, 8, v2
v_add_u32 v21, v21, v3
v_add_u32 v21, 0, v21
v_add_u32 v3, 0, v1
s_mov_b32 s81, 2752
v_mul_lo_u32 v3, v3, s81
v_mul_u32_u24 v8, 16, v2
v_add_u32 v8, v8, v3
v_add_u32 v8, 2162688, v8
v_add_u32 v3, 16, v1
s_mov_b32 s81, 2752
v_mul_lo_u32 v3, v3, s81
v_mul_u32_u24 v9, 16, v2
v_add_u32 v9, v9, v3
v_add_u32 v9, 2162688, v9
v_lshlrev_b32 v3, 3, v2
s_mov_b32 s81, 1024
v_mul_lo_u32 v3, v3, s81
v_lshl_add_u32 v12, v1, 1, v3
v_add_u32 v13, 1024, v12
v_add_u32 v14, 2048, v12
v_add_u32 v15, 3072, v12
v_add_u32 v16, 4096, v12
v_add_u32 v17, 5120, v12
v_add_u32 v18, 6144, v12
v_add_u32 v19, 7168, v12
s_mov_b32 s77, s21
L_fb_d_tile:
s_lshl_b32 s79, s77, 6
s_mov_b32 s80, 0
s_mov_b32 s78, 0
v_mov_b32 v96, 0
v_mov_b32 v97, 0
v_mov_b32 v98, 0
v_mov_b32 v99, 0
v_mov_b32 v100, 0
v_mov_b32 v101, 0
v_mov_b32 v102, 0
v_mov_b32 v103, 0
v_mov_b32 v104, 0
v_mov_b32 v105, 0
v_mov_b32 v106, 0
v_mov_b32 v107, 0
v_mov_b32 v108, 0
v_mov_b32 v109, 0
v_mov_b32 v110, 0
v_mov_b32 v111, 0
L_fb_d_k:
buffer_load_dwordx4 v[80:83], v8, s[24:27], s80 offen sc1
buffer_load_dwordx4 v[84:87], v9, s[24:27], s80 offen sc1
buffer_load_ushort v32, v12, s[60:63], s79 offen offset:0
buffer_load_ushort v33, v13, s[60:63], s79 offen offset:0
buffer_load_ushort v34, v14, s[60:63], s79 offen offset:0
buffer_load_ushort v35, v15, s[60:63], s79 offen offset:0
buffer_load_ushort v36, v16, s[60:63], s79 offen offset:0
buffer_load_ushort v37, v17, s[60:63], s79 offen offset:0
buffer_load_ushort v38, v18, s[60:63], s79 offen offset:0
buffer_load_ushort v39, v19, s[60:63], s79 offen offset:0
buffer_load_ushort v40, v12, s[60:63], s79 offen offset:32
buffer_load_ushort v41, v13, s[60:63], s79 offen offset:32
buffer_load_ushort v42, v14, s[60:63], s79 offen offset:32
buffer_load_ushort v43, v15, s[60:63], s79 offen offset:32
buffer_load_ushort v44, v16, s[60:63], s79 offen offset:32
buffer_load_ushort v45, v17, s[60:63], s79 offen offset:32
buffer_load_ushort v46, v18, s[60:63], s79 offen offset:32
buffer_load_ushort v47, v19, s[60:63], s79 offen offset:32
s_waitcnt vmcnt(0)
v_lshl_or_b32 v64, v33, 16, v32
v_lshl_or_b32 v65, v35, 16, v34
v_lshl_or_b32 v66, v37, 16, v36
v_lshl_or_b32 v67, v39, 16, v38
v_lshl_or_b32 v68, v41, 16, v40
v_lshl_or_b32 v69, v43, 16, v42
v_lshl_or_b32 v70, v45, 16, v44
v_lshl_or_b32 v71, v47, 16, v46
s_nop 1
v_mfma_f32_16x16x32_bf16 v[96:99], v[64:67], v[80:83], v[96:99]
v_mfma_f32_16x16x32_bf16 v[100:103], v[68:71], v[80:83], v[100:103]
v_mfma_f32_16x16x32_bf16 v[104:107], v[64:67], v[84:87], v[104:107]
v_mfma_f32_16x16x32_bf16 v[108:111], v[68:71], v[84:87], v[108:111]
s_add_u32 s79, s79, 32768
s_add_u32 s80, s80, 64
s_add_u32 s78, s78, 1
s_cmp_lt_u32 s78, 43
s_cbranch_scc1 L_fb_d_k
s_nop 7
s_nop 7
s_lshl_b32 s82, s77, 6
s_lshl_b32 s81, s76, 15
s_add_u32 s81, s81, s82
buffer_load_dwordx2 v[32:33], v24, s[24:27], s82 offen offset:0 sc1
buffer_load_dwordx2 v[34:35], v24, s[24:27], s82 offen offset:32 sc1
buffer_load_dwordx2 v[36:37], v25, s[24:27], s82 offen offset:0 sc1
buffer_load_dwordx2 v[38:39], v25, s[24:27], s82 offen offset:32 sc1
s_waitcnt vmcnt(0)
v_lshlrev_b32 v40, 16, v32
v_and_b32 v41, 0xffff0000, v32
v_lshlrev_b32 v42, 16, v33
v_and_b32 v43, 0xffff0000, v33
v_sub_f32 v40, v40, v96
v_fma_f32 v96, v160, v40, v96
v_sub_f32 v41, v41, v97
v_fma_f32 v97, v160, v41, v97
v_sub_f32 v42, v42, v98
v_fma_f32 v98, v160, v42, v98
v_sub_f32 v43, v43, v99
v_fma_f32 v99, v160, v43, v99
v_cvt_pk_bf16_f32 v44, v96, v97
v_cvt_pk_bf16_f32 v45, v98, v99
buffer_store_dwordx2 v[44:45], v20, s[68:71], s81 offen offset:0
s_nop 1
v_lshlrev_b32 v40, 16, v34
v_and_b32 v41, 0xffff0000, v34
v_lshlrev_b32 v42, 16, v35
v_and_b32 v43, 0xffff0000, v35
v_sub_f32 v40, v40, v100
v_fma_f32 v100, v160, v40, v100
v_sub_f32 v41, v41, v101
v_fma_f32 v101, v160, v41, v101
v_sub_f32 v42, v42, v102
v_fma_f32 v102, v160, v42, v102
v_sub_f32 v43, v43, v103
v_fma_f32 v103, v160, v43, v103
v_cvt_pk_bf16_f32 v44, v100, v101
v_cvt_pk_bf16_f32 v45, v102, v103
buffer_store_dwordx2 v[44:45], v20, s[68:71], s81 offen offset:32
s_nop 1
v_lshlrev_b32 v40, 16, v36
v_and_b32 v41, 0xffff0000, v36
v_lshlrev_b32 v42, 16, v37
v_and_b32 v43, 0xffff0000, v37
v_sub_f32 v40, v40, v104
v_fma_f32 v104, v164, v40, v104
v_sub_f32 v41, v41, v105
v_fma_f32 v105, v164, v41, v105
v_sub_f32 v42, v42, v106
v_fma_f32 v106, v164, v42, v106
v_sub_f32 v43, v43, v107
v_fma_f32 v107, v164, v43, v107
v_cvt_pk_bf16_f32 v44, v104, v105
v_cvt_pk_bf16_f32 v45, v106, v107
buffer_store_dwordx2 v[44:45], v21, s[68:71], s81 offen offset:0
s_nop 1
v_lshlrev_b32 v40, 16, v38
v_and_b32 v41, 0xffff0000, v38
v_lshlrev_b32 v42, 16, v39
v_and_b32 v43, 0xffff0000, v39
v_sub_f32 v40, v40, v108
v_fma_f32 v108, v164, v40, v108
v_sub_f32 v41, v41, v109
v_fma_f32 v109, v164, v41, v109
v_sub_f32 v42, v42, v110
v_fma_f32 v110, v164, v42, v110
v_sub_f32 v43, v43, v111
v_fma_f32 v111, v164, v43, v111
v_cvt_pk_bf16_f32 v44, v108, v109
v_cvt_pk_bf16_f32 v45, v110, v111
buffer_store_dwordx2 v[44:45], v21, s[68:71], s81 offen offset:32
s_nop 1
s_add_u32 s77, s77, 4
s_cmp_lt_u32 s77, 16
s_cbranch_scc1 L_fb_d_tile
s_waitcnt vmcnt(0) lgkmcnt(0)
s_barrier
s_add_u32 s76, s76, 1
s_cmp_lt_u32 s76, 64
s_cbranch_scc1 L_fb_seg
s_branch L_exit
L_code_end:
.section .rodata,"a"
.p2align 6
.amdhsa_kernel gated_mix__memory_aug_recurrent_mem_tr__glu_gated_glu__prompt_kernel
  .amdhsa_next_free_vgpr 512
  .amdhsa_next_free_sgpr 102
  .amdhsa_accum_offset 256
  .amdhsa_group_segment_fixed_size 0
  .amdhsa_kernarg_size 120
  .amdhsa_user_sgpr_count 2
  .amdhsa_user_sgpr_kernarg_segment_ptr 1
  .amdhsa_system_sgpr_workgroup_id_x 1
.end_amdhsa_kernel
```
